```python
import torch

def _softmax(x, axis=-1):
    return torch.softmax(x, dim=axis)
def _gelu(x):
    return torch.nn.functional.gelu(x, approximate="tanh")
def _silu(x):
    return torch.nn.functional.silu(x)
def _sigmoid(x):
    return torch.sigmoid(x)
def _layernorm(x, axis=-1, eps=1e-5):
    m = x.mean(dim=axis, keepdim=True)
    v = x.var(dim=axis, keepdim=True, unbiased=False)
    return (x - m) / torch.sqrt(v + eps)
def _scatter_add(tgt, idx, src, axis=0):
    return tgt.clone().index_add_(axis, idx, src)
def _segment_sum(src, seg, n):
    out = torch.zeros((n,) + src.shape[1:], dtype=src.dtype)
    return out.index_add_(0, seg, src)
def _pad(x, pw):
    flat = tuple(v for pair in reversed(pw) for v in pair)
    return torch.nn.functional.pad(x, flat)

kernel_name = 'standalone__paged_block_table_kv_pagedattention__prompt'

def setup_inputs():

    _w = (lambda a: (lambda t: t.to(torch.bfloat16) if t.is_floating_point() else t)(torch.as_tensor(a)))
    B, Hq, Hkv, Sq, Skv, D = 1, 32, 32, 2048, 2048, 128
    bs = 16
    nbps = max(1, Skv // bs)
    num_phys = B * nbps + 4
    bt = torch.randperm(num_phys)[: B * nbps].reshape(B, nbps).to(torch.int64)
    cl = (nbps * bs - (torch.arange(1, B + 1, dtype=torch.int64) * 2654435761) % max(1, nbps * bs // 2)).to(torch.int64)
    return {
        "q": _w((lambda *s: torch.randn(*s, dtype=torch.bfloat16) * 0.8)(B, Hq, Sq, D)),
        "k_cache": _w((lambda *s: torch.randn(*s, dtype=torch.bfloat16) * 0.8)(num_phys, bs, Hkv, D)),
        "v_cache": _w((lambda *s: torch.randn(*s, dtype=torch.bfloat16) * 0.05)(num_phys, bs, Hkv, D)),
        "block_table": _w(bt),
        "context_lens": _w(cl),
    }

def reference(q, k_cache, v_cache, block_table, context_lens):
    B, Hq, Sq, D = q.shape
    bs = k_cache.shape[1]
    Hkv = k_cache.shape[2]
    nbps = block_table.shape[1]
    Skv = nbps * bs
    bt = block_table.reshape(-1)
    k = (lambda x, *d: x.permute(*d))(k_cache[bt].reshape(B, Skv, Hkv, D), 0, 2, 1, 3)
    v = (lambda x, *d: x.permute(*d))(v_cache[bt].reshape(B, Skv, Hkv, D), 0, 2, 1, 3)
    g = Hq // Hkv
    qg = q.reshape(B, Hkv, g, Sq, D)
    scores = torch.einsum("bhgqd,bhkd->bhgqk", qg, k) * (D ** -0.5)
    pos = torch.arange(Skv)
    msk = pos[None, :] < context_lens[:, None]
    scores = torch.where(msk[:, None, None, None, :], scores, -1e9)
    p = _softmax(scores, axis=-1)
    out = torch.einsum("bhgqk,bhkd->bhgqd", p, v)
    return out.reshape(B, Hq, Sq, D)
```

```asm
; @launch grid=(256,1,1) block=(256,1,1) lds=163840
.amdgcn_target "amdgcn-amd-amdhsa--gfx950"
.text
.globl standalone__paged_block_table_kv_pagedattention__prompt_kernel
.p2align 8
.type standalone__paged_block_table_kv_pagedattention__prompt_kernel,@function
standalone__paged_block_table_kv_pagedattention__prompt_kernel:
    s_cmpk_ge_u32 s2, 256
    s_cbranch_scc1 L_end
    s_load_dwordx2 s[20:21], s[0:1], 0
    s_load_dwordx16 s[4:19], s[0:1], 0
    s_getpc_b64 s[74:75]
L_pc:
    s_lshl_b32 s64, s2, 8
    s_min_u32 s64, s64, L_general-L_pc
    v_lshl_add_u32 v234, v0, 3, s64
    v_mov_b32 v235, 0
    v_lshl_add_u64 v[234:235], v[234:235], 0, s[74:75]
    global_load_ubyte v239, v[234:235], off
    v_readfirstlane_b32 s48, v0
    v_lshlrev_b32 v194, 4, v0
    s_and_b32 s64, s2, 7
    s_bfe_u32 s56, s2, 0x20003
    s_lshl2_add_u32 s49, s64, s56
    s_lshr_b32 s65, s2, 5
    s_lshl3_add_u32 s65, s49, s65
    s_lshl_b32 s53, s65, 16
    s_mul_i32 s65, s48, 240
    s_add_u32 s53, s53, s65
    s_lshl_b32 s56, s48, 6
    s_add_u32 s50, s53, s56
    s_lshl_b32 s22, 1, 24
    s_mov_b32 s23, 0x20000
    s_lshr_b32 s60, s48, 4
    s_and_b32 s60, s60, 4
    s_waitcnt lgkmcnt(0)
    s_load_dword s62, s[12:13], 0
    s_load_dwordx16 s[32:47], s[10:11], s60
    buffer_load_dwordx4 v[64:67], v194, s[20:23], s50 offen offset:0 nt
    buffer_load_dwordx4 v[68:71], v194, s[20:23], s50 offen offset:1024 nt
    buffer_load_dwordx4 v[72:75], v194, s[20:23], s50 offen offset:2048 nt
    buffer_load_dwordx4 v[76:79], v194, s[20:23], s50 offen offset:3072 nt
    s_xor_b32 s65, s56, 4096
    s_add_u32 s51, s53, s65
    s_xor_b32 s65, s56, 8192
    s_add_u32 s52, s53, s65
    s_xor_b32 s65, s56, 12288
    s_add_u32 s53, s53, s65
    s_lshr_b32 s48, s48, 6
    s_lshl_b32 s49, s49, 8
    v_and_b32 v193, 63, v0
    v_and_b32 v232, 15, v0
    v_lshrrev_b32 v233, 4, v193
    s_sub_u32 s26, 17301504, s49
    s_mov_b32 s27, 0x20000
    s_cmp_ge_u32 s48, 2
    s_cselect_b32 s24, s8, s6
    s_cselect_b32 s25, s9, s7
    s_cselect_b32 s26, 0, s26
    s_cselect_b32 s65, 65536, 0
    s_cselect_b32 s3, 1, 0
    s_cselect_b32 s55, 40, 48
    s_cselect_b32 s70, 128, 64
    s_cselect_b32 s71, 0, 128
    s_xor_b32 s72, s70, s71
    s_add_u32 s24, s24, s49
    s_addc_u32 s25, s25, 0
    s_and_b32 s25, s25, 0xffff
    s_add_u32 s55, s55, s60
    s_lshl_b32 s64, s60, 10
    s_add_u32 s65, s65, s64
    s_sub_u32 s64, 5, s3
    s_lshl_b32 s64, s64, 13
    s_add_u32 m0, s65, s64
    v_lshlrev_b32 v235, s3, v233
    v_xor_b32 v235, v232, v235
    v_lshlrev_b32 v235, 4, v235
    v_lshl_add_u32 v216, v233, 13, v235
    v_xor_b32 v217, s70, v216
    v_add_u32 v217, 31744, v217
    v_xor_b32 v218, s71, v216
    v_add_u32 v218, 63488, v218
    v_xor_b32 v219, s72, v216
    v_add_u32 v219, 95232, v219
    s_cmp_ge_u32 s48, 2
    s_cselect_b32 s66, 4, 0
    s_cselect_b32 s67, 0, 1
    s_cselect_b32 s68, 1, 2
    s_cselect_b32 s69, 2, 3
    s_cselect_b32 s16, 3, 4
    s_lshl_b32 s66, s66, 13
    s_add_u32 s66, s66, s65
    s_lshl_b32 s67, s67, 13
    s_add_u32 s67, s67, s65
    s_lshl_b32 s68, s68, 13
    s_add_u32 s68, s68, s65
    s_lshl_b32 s69, s69, 13
    s_add_u32 s69, s69, s65
    s_lshl_b32 s16, s16, 13
    s_add_u32 s16, s16, s65
    s_lshl_b32 s63, s48, 13
    s_add_u32 s63, s63, 131072
    s_mov_b32 s28, s14
    s_and_b32 s29, s15, 0xffff
    s_mov_b32 s30, 16777216
    s_mov_b32 s31, 0x20000
    v_xor_b32 v234, v232, v233
    v_lshlrev_b32 v234, 4, v234
    v_lshl_add_u32 v220, v233, 8, v234
    v_add_u32 v220, s63, v220
    v_xor_b32 v221, 64, v220
    v_xor_b32 v222, 128, v220
    v_xor_b32 v223, 192, v220
    v_accvgpr_write_b32 a196, 0
    v_accvgpr_write_b32 a197, 0
    v_accvgpr_write_b32 a198, 0
    v_accvgpr_write_b32 a199, 0
    v_lshrrev_b32 v235, 1, v232
    v_lshrrev_b32 v236, 1, v233
    v_cmp_eq_u32 vcc, v235, v236
    v_mov_b32 v236, 0x3f803f80
    v_and_b32 v235, 1, v193
    v_accvgpr_write_b32 a232, v236
    v_accvgpr_write_b32 a233, v236
    v_accvgpr_write_b32 a234, v236
    v_accvgpr_write_b32 a235, v236
    v_cndmask_b32 v236, 0, v236, vcc
    v_cmp_eq_u32 vcc, 0, v235
    v_accvgpr_write_b32 a192, v236
    v_accvgpr_write_b32 a193, v236
    v_accvgpr_write_b32 a194, v236
    v_accvgpr_write_b32 a195, v236
    v_mov_b32 v235, 0x44444444
    v_mov_b32 v236, 0xeeeeeeee
    v_cndmask_b32 v192, v236, v235, vcc
    v_mfma_f32_32x32x16_bf16 v[176:191], a[196:199], a[196:199], 0
    v_lshl_add_u32 v196, v232, 8, v234
    v_xor_b32 v197, 64, v196
    v_xor_b32 v198, 128, v196
    v_xor_b32 v199, 192, v196
    v_and_b32 v235, 3, v193
    v_lshrrev_b32 v236, 2, v193
    v_and_b32 v228, 8, v236
    v_mad_u32_u24 v228, v228, 7, v236
    v_lshlrev_b32 v228, 4, v228
    v_lshl_add_u32 v228, v235, 8, v228
    s_lshl_b32 s3, s48, 10
    v_add_u32 v228, s3, v228
    v_lshlrev_b32 v200, 8, v236
    v_and_b32 v236, 7, v236
    v_lshl_add_u32 v200, v236, 5, v200
    v_lshl_add_u32 v200, v235, 3, v200
    v_add_u32 v200, 65536, v200
    v_xor_b32 v201, 32, v200
    v_xor_b32 v202, 64, v200
    v_xor_b32 v203, 96, v200
    v_xor_b32 v204, 128, v200
    v_xor_b32 v205, 160, v200
    v_xor_b32 v206, 192, v200
    v_xor_b32 v207, 224, v200
    v_mfma_f32_32x32x16_bf16 v[48:63], a[196:199], a[196:199], 0
    v_and_b32 v236, 3, v236
    v_lshlrev_b32 v236, 3, v236
    v_lshl_add_u32 v236, v235, 6, v236
    v_mfma_f32_32x32x16_bf16 v[32:47], a[196:199], a[196:199], 0
    v_lshl_add_u32 v236, v233, 8, v236
    v_and_b32 v235, 2, v233
    v_lshl_add_u32 v236, v235, 8, v236
    v_and_b32 v235, 1, v233
    v_lshl_add_u32 v236, v235, 5, v236
    v_add_u32 v226, s63, v236
    v_xor_b32 v227, 32, v226
    v_lshlrev_b32 v235, 3, v232
    v_lshl_add_u32 v235, v233, 10, v235
    v_mfma_f32_32x32x16_bf16 v[16:31], a[196:199], a[196:199], 0
    v_add_u32 v224, s63, v235
    v_xor_b32 v225, 32, v224
    v_lshlrev_b32 v229, 4, v233
    v_mfma_f32_32x32x16_bf16 v[0:15], a[196:199], a[196:199], 0
    s_waitcnt lgkmcnt(0)
    s_cmp_le_i32 s62, 0
    s_cselect_b32 s61, 0, 0x3e0293ee
    s_cselect_b32 s62, 2048, s62
    s_min_i32 s62, s62, 2048
    s_add_u32 s54, s62, 31
    s_lshr_b32 s54, s54, 5
    s_sub_u32 s64, s54, 1
    s_lshl3_add_u32 s59, s64, s60
    s_load_dword s58, s[10:11], s59
    s_lshl_b32 s33, s32, 17
    buffer_load_dwordx4 v216, s[24:27], s33 offen offset:0 lds
    buffer_load_dwordx4 v217, s[24:27], s33 offen offset:1024 lds
    buffer_load_dwordx4 v218, s[24:27], s33 offen offset:2048 lds
    buffer_load_dwordx4 v219, s[24:27], s33 offen offset:3072 lds
    s_sub_u32 s26, 17301504, s49
    s_cmp_ge_u32 s48, 2
    s_cselect_b32 s35, s32, s34
    s_cselect_b32 s72, 5, 6
    s_lshl_b32 s35, s35, 17
    s_lshl_b32 s72, s72, 13
    s_add_u32 s72, s72, s65
    s_mov_b32 m0, s72
    s_nop 0
    buffer_load_dwordx4 v216, s[24:27], s35 offen offset:0 lds
    buffer_load_dwordx4 v217, s[24:27], s35 offen offset:1024 lds
    s_sub_u32 s56, s54, 3
    s_lshl3_add_u32 s56, s56, s55
    s_sub_u32 s3, s64, 3
    s_mul_i32 s73, s3, 52
    s_lshr_b32 s73, s73, 8
    s_mul_i32 s73, s73, 5
    s_sub_u32 s3, s3, s73
    s_lshl_b32 s3, s3, 13
    v_add_u32 v211, s3, v203
    v_add_u32 v212, s3, v204
    v_add_u32 v213, s3, v205
    v_add_u32 v214, s3, v206
    v_add_u32 v215, s3, v207
    s_lshl_b32 s3, s64, 5
    s_sub_u32 s3, s62, s3
    v_mov_b32 v238, 0xf149f2ca
    v_lshlrev_b32 v237, 2, v233
    v_sub_u32 v237, s3, v237
    v_cmp_lt_i32 s[70:71], 0, v237
    v_cmp_lt_i32 s[72:73], 1, v237
    v_cmp_lt_i32 s[74:75], 2, v237
    v_cmp_lt_i32 s[76:77], 3, v237
    v_cndmask_b32 v248, v238, 4.0, s[70:71]
    v_cndmask_b32 v249, v238, 4.0, s[72:73]
    v_cndmask_b32 v250, v238, 4.0, s[74:75]
    v_cndmask_b32 v251, v238, 4.0, s[76:77]
    v_cmp_lt_i32 s[70:71], 16, v237
    v_cmp_lt_i32 s[72:73], 17, v237
    v_cmp_lt_i32 s[74:75], 18, v237
    v_cmp_lt_i32 s[76:77], 19, v237
    v_cndmask_b32 v252, v238, 4.0, s[70:71]
    v_cndmask_b32 v253, v238, 4.0, s[72:73]
    v_cndmask_b32 v254, v238, 4.0, s[74:75]
    v_cndmask_b32 v255, v238, 4.0, s[76:77]
    v_add_u32 v232, s63, v196
    v_add_u32 v233, s63, v197
    v_add_u32 v234, s63, v198
    v_add_u32 v235, s63, v199
    s_mov_b32 s70, s61
    s_mov_b32 s71, s61
    s_sub_u32 s59, s59, 8
    s_cmp_ge_u32 s48, 2
    s_cselect_b32 s37, s34, s36
    s_cselect_b32 s73, 6, 7
    s_cselect_b32 s43, s38, s40
    s_cselect_b32 s76, 1, 2
    s_cselect_b32 s45, s40, s42
    s_cselect_b32 s77, 2, 3
    s_lshl_b32 s37, s37, 17
    s_lshl_b32 s73, s73, 13
    s_add_u32 s73, s73, s65
    s_lshl_b32 s43, s43, 17
    s_lshl_b32 s76, s76, 13
    s_add_u32 s76, s76, s65
    s_lshl_b32 s45, s45, 17
    s_lshl_b32 s77, s77, 13
    s_add_u32 s77, s77, s65
    s_cmp_le_u32 s54, 3
    s_cbranch_scc1 L_general
    s_mov_b64 vcc, -1
    s_cmp_eq_u32 s48, 0
    s_cbranch_scc1 L_hop0
    s_cmp_eq_u32 s48, 1
    s_cbranch_scc1 L_hop1
    s_cmp_eq_u32 s48, 2
    s_cbranch_scc1 L_hop2
    s_bitcmp1_b32 s54, 0
    s_cbranch_scc1 L_hop4
    s_branch L_hop3
.p2align 12
L_main:
    s_mov_b64 vcc, 0
    buffer_load_dwordx4 v[80:83], v194, s[20:23], s51 offen offset:0 nt
    s_waitcnt vmcnt(10)
    v_lshlrev_b32 v240, 16, v64
    v_and_b32 v241, 0xffff0000, v64
    v_lshlrev_b32 v242, 16, v65
    v_and_b32 v243, 0xffff0000, v65
    v_lshlrev_b32 v244, 16, v66
    v_and_b32 v245, 0xffff0000, v66
    v_lshlrev_b32 v246, 16, v67
    v_and_b32 v247, 0xffff0000, v67
    v_pk_mul_f32 v[240:241], v[240:241], s[70:71]
    v_pk_mul_f32 v[242:243], v[242:243], s[70:71]
    v_pk_mul_f32 v[244:245], v[244:245], s[70:71]
    v_pk_mul_f32 v[246:247], v[246:247], s[70:71]
    buffer_load_dwordx4 v218, s[24:27], s35 offen offset:2048 lds
    v_cvt_pk_bf16_f32 v64, v240, v241
    v_cvt_pk_bf16_f32 v65, v242, v243
    v_cvt_pk_bf16_f32 v66, v244, v245
    v_cvt_pk_bf16_f32 v67, v246, v247
    s_waitcnt vmcnt(10)
    v_lshlrev_b32 v240, 16, v68
    v_and_b32 v241, 0xffff0000, v68
    v_lshlrev_b32 v242, 16, v69
    v_and_b32 v243, 0xffff0000, v69
    v_lshlrev_b32 v244, 16, v70
    v_and_b32 v245, 0xffff0000, v70
    buffer_load_dwordx4 v[84:87], v194, s[20:23], s51 offen offset:1024 nt
    ds_write_b128 v220, v[64:67] offset:0
    v_lshlrev_b32 v246, 16, v71
    v_and_b32 v247, 0xffff0000, v71
    v_pk_mul_f32 v[240:241], v[240:241], s[70:71]
    v_pk_mul_f32 v[242:243], v[242:243], s[70:71]
    v_pk_mul_f32 v[244:245], v[244:245], s[70:71]
    v_pk_mul_f32 v[246:247], v[246:247], s[70:71]
    v_cvt_pk_bf16_f32 v68, v240, v241
    v_cvt_pk_bf16_f32 v69, v242, v243
    v_cvt_pk_bf16_f32 v70, v244, v245
    buffer_load_dwordx4 v219, s[24:27], s35 offen offset:3072 lds
    s_mov_b32 m0, s73
    v_cvt_pk_bf16_f32 v71, v246, v247
    ds_write_b128 v221, v[68:71] offset:1024
    s_waitcnt vmcnt(11)
    v_lshlrev_b32 v240, 16, v72
    buffer_load_dwordx4 v[88:91], v194, s[20:23], s51 offen offset:2048 nt
    v_and_b32 v241, 0xffff0000, v72
    v_lshlrev_b32 v242, 16, v73
    v_and_b32 v243, 0xffff0000, v73
    v_lshlrev_b32 v244, 16, v74
    v_and_b32 v245, 0xffff0000, v74
    v_lshlrev_b32 v246, 16, v75
    v_and_b32 v247, 0xffff0000, v75
    v_pk_mul_f32 v[240:241], v[240:241], s[70:71]
    v_pk_mul_f32 v[242:243], v[242:243], s[70:71]
    v_pk_mul_f32 v[244:245], v[244:245], s[70:71]
    v_pk_mul_f32 v[246:247], v[246:247], s[70:71]
    v_cvt_pk_bf16_f32 v72, v240, v241
    v_cvt_pk_bf16_f32 v73, v242, v243
    v_cvt_pk_bf16_f32 v74, v244, v245
    v_cvt_pk_bf16_f32 v75, v246, v247
    ds_write_b128 v222, v[72:75] offset:2048
    buffer_load_dwordx4 v[92:95], v194, s[20:23], s51 offen offset:3072 nt
    s_waitcnt vmcnt(12)
    v_lshlrev_b32 v240, 16, v76
    v_and_b32 v241, 0xffff0000, v76
    v_lshlrev_b32 v242, 16, v77
    v_and_b32 v243, 0xffff0000, v77
    v_lshlrev_b32 v244, 16, v78
    v_and_b32 v245, 0xffff0000, v78
    v_lshlrev_b32 v246, 16, v79
    v_and_b32 v247, 0xffff0000, v79
    v_pk_mul_f32 v[240:241], v[240:241], s[70:71]
    v_pk_mul_f32 v[242:243], v[242:243], s[70:71]
    v_pk_mul_f32 v[244:245], v[244:245], s[70:71]
    v_pk_mul_f32 v[246:247], v[246:247], s[70:71]
    v_cvt_pk_bf16_f32 v76, v240, v241
    buffer_load_dwordx4 v216, s[24:27], s37 offen offset:0 lds
    v_cvt_pk_bf16_f32 v77, v242, v243
    v_cvt_pk_bf16_f32 v78, v244, v245
    v_cvt_pk_bf16_f32 v79, v246, v247
    ds_write_b128 v223, v[76:79] offset:3072
    ds_read_b128 a[0:3], v232 offset:0
    ds_read_b128 a[4:7], v233 offset:0
    ds_read_b128 a[8:11], v234 offset:0
    buffer_load_dwordx4 v217, s[24:27], s37 offen offset:1024 lds
    ds_read_b128 a[12:15], v235 offset:0
    buffer_load_dwordx4 v218, s[24:27], s37 offen offset:2048 lds
    s_waitcnt vmcnt(11) lgkmcnt(0)
    s_barrier
    s_cmp_ge_u32 s48, 2
    s_cselect_b32 s39, s36, s58
    s_cselect_b32 s74, 7, 0
    s_cselect_b32 s41, s58, s38
    s_cselect_b32 s75, 0, 1
    s_lshl_b32 s39, s39, 17
    s_lshl_b32 s74, s74, 13
    buffer_load_dwordx4 v219, s[24:27], s37 offen offset:3072 lds
    s_add_u32 s74, s74, s65
    s_lshl_b32 s41, s41, 17
    s_lshl_b32 s75, s75, 13
    ds_read_b128 a[96:99], v196 offset:40960
    ds_read_b128 a[100:103], v197 offset:40960
    s_add_u32 s75, s75, s65
    s_min_u32 s60, s55, s59
    ds_read_b128 a[104:107], v198 offset:40960
    ds_read_b128 a[108:111], v199 offset:40960
    s_load_dword s58, s[10:11], s60
    s_mov_b32 m0, s74
    ds_read_b128 a[112:115], v196 offset:45056
    buffer_load_dwordx4 v[96:99], v194, s[20:23], s52 offen offset:0 nt
    ds_read_b128 a[116:119], v197 offset:45056
    ds_read_b128 a[120:123], v198 offset:45056
    ds_read_b128 a[124:127], v199 offset:45056
    s_waitcnt lgkmcnt(7)
    v_mfma_f32_16x16x32_bf16 v[144:147], a[96:99], a[0:3], 4.0
    s_waitcnt lgkmcnt(6)
    buffer_load_dwordx4 v216, s[24:27], s39 offen offset:0 lds
    v_mfma_f32_16x16x32_bf16 v[144:147], a[100:103], a[4:7], v[144:147]
    s_waitcnt lgkmcnt(5)
    v_mfma_f32_16x16x32_bf16 v[144:147], a[104:107], a[8:11], v[144:147]
    s_waitcnt lgkmcnt(4)
    v_mfma_f32_16x16x32_bf16 v[144:147], a[108:111], a[12:15], v[144:147]
    s_waitcnt lgkmcnt(0)
    v_mfma_f32_16x16x32_bf16 v[148:151], a[124:127], a[12:15], 4.0
    v_mfma_f32_16x16x32_bf16 v[148:151], a[120:123], a[8:11], v[148:151]
    s_nop 4
    v_exp_f32 v144, v144
    v_mfma_f32_16x16x32_bf16 v[148:151], a[116:119], a[4:7], v[148:151]
    v_add_f32 v176, v176, v144
    v_exp_f32 v145, v145
    v_mfma_f32_16x16x32_bf16 v[148:151], a[112:115], a[0:3], v[148:151]
    v_add_f32 v177, v177, v145
    v_cvt_pk_bf16_f32 v168, v144, v145
    v_exp_f32 v146, v146
    v_exp_f32 v147, v147
    v_add_f32 v176, v176, v146
    v_add_f32 v177, v177, v147
    v_cvt_pk_bf16_f32 v169, v146, v147
    s_nop 0
    v_exp_f32 v148, v148
    v_exp_f32 v149, v149
    v_add_f32 v176, v176, v148
    v_add_f32 v177, v177, v149
    v_cvt_pk_bf16_f32 v170, v148, v149
    v_exp_f32 v150, v150
    v_exp_f32 v151, v151
    v_add_f32 v176, v176, v150
    v_add_f32 v177, v177, v151
    v_cvt_pk_bf16_f32 v171, v150, v151
    buffer_load_dwordx4 v[100:103], v194, s[20:23], s52 offen offset:1024 nt
    s_waitcnt vmcnt(12)
    v_lshlrev_b32 v240, 16, v80
    v_and_b32 v241, 0xffff0000, v80
    v_lshlrev_b32 v242, 16, v81
    v_and_b32 v243, 0xffff0000, v81
    v_lshlrev_b32 v244, 16, v82
    v_and_b32 v245, 0xffff0000, v82
    v_lshlrev_b32 v246, 16, v83
    v_and_b32 v247, 0xffff0000, v83
    v_pk_mul_f32 v[240:241], v[240:241], s[70:71]
    v_pk_mul_f32 v[242:243], v[242:243], s[70:71]
    v_pk_mul_f32 v[244:245], v[244:245], s[70:71]
    v_pk_mul_f32 v[246:247], v[246:247], s[70:71]
    v_cvt_pk_bf16_f32 v80, v240, v241
    v_cvt_pk_bf16_f32 v81, v242, v243
    v_cvt_pk_bf16_f32 v82, v244, v245
    v_cvt_pk_bf16_f32 v83, v246, v247
    ds_write_b128 v220, v[80:83] offset:4096
    buffer_load_dwordx4 v217, s[24:27], s39 offen offset:1024 lds
    buffer_load_dwordx4 v[104:107], v194, s[20:23], s52 offen offset:2048 nt
    s_waitcnt vmcnt(12)
    v_lshlrev_b32 v240, 16, v84
    v_and_b32 v241, 0xffff0000, v84
    v_lshlrev_b32 v242, 16, v85
    v_and_b32 v243, 0xffff0000, v85
    v_lshlrev_b32 v244, 16, v86
    v_and_b32 v245, 0xffff0000, v86
    v_lshlrev_b32 v246, 16, v87
    v_and_b32 v247, 0xffff0000, v87
    v_pk_mul_f32 v[240:241], v[240:241], s[70:71]
    v_pk_mul_f32 v[242:243], v[242:243], s[70:71]
    v_pk_mul_f32 v[244:245], v[244:245], s[70:71]
    v_pk_mul_f32 v[246:247], v[246:247], s[70:71]
    v_cvt_pk_bf16_f32 v84, v240, v241
    v_cvt_pk_bf16_f32 v85, v242, v243
    v_cvt_pk_bf16_f32 v86, v244, v245
    v_cvt_pk_bf16_f32 v87, v246, v247
    ds_write_b128 v221, v[84:87] offset:5120
    s_waitcnt vmcnt(11)
    s_barrier
    buffer_load_dwordx4 v218, s[24:27], s39 offen offset:2048 lds
    ds_read_b128 a[64:67], v196 offset:49152
    ds_read_b128 a[68:71], v197 offset:49152
    ds_read_b128 a[72:75], v198 offset:49152
    ds_read_b128 a[76:79], v199 offset:49152
    ds_read_b128 a[80:83], v196 offset:53248
    ds_read_b128 a[84:87], v197 offset:53248
    ds_read_b128 a[88:91], v198 offset:53248
    ds_read_b128 a[92:95], v199 offset:53248
    ds_read_b64_tr_b16 a[160:161], v200 offset:40960
    ds_read_b64_tr_b16 a[162:163], v200 offset:45056
    ds_read_b64_tr_b16 a[164:165], v201 offset:40960
    ds_read_b64_tr_b16 a[166:167], v201 offset:45056
    ds_read_b64_tr_b16 a[168:169], v202 offset:40960
    ds_read_b64_tr_b16 a[170:171], v202 offset:45056
    ds_read_b64_tr_b16 a[172:173], v203 offset:40960
    ds_read_b64_tr_b16 a[174:175], v203 offset:45056
    ds_read_b64_tr_b16 a[176:177], v204 offset:40960
    s_waitcnt lgkmcnt(14)
    v_mfma_f32_16x16x32_bf16 v[128:131], a[64:67], a[0:3], 4.0
    ds_read_b64_tr_b16 a[178:179], v204 offset:45056
    ds_read_b64_tr_b16 a[180:181], v205 offset:40960
    v_mfma_f32_16x16x32_bf16 v[128:131], a[68:71], a[4:7], v[128:131]
    ds_read_b64_tr_b16 a[182:183], v205 offset:45056
    ds_read_b64_tr_b16 a[184:185], v206 offset:40960
    v_mfma_f32_16x16x32_bf16 v[128:131], a[72:75], a[8:11], v[128:131]
    s_waitcnt lgkmcnt(14)
    ds_read_b64_tr_b16 a[186:187], v206 offset:45056
    ds_read_b64_tr_b16 a[188:189], v207 offset:40960
    v_mfma_f32_16x16x32_bf16 v[128:131], a[76:79], a[12:15], v[128:131]
    ds_read_b64_tr_b16 a[190:191], v207 offset:45056
    buffer_load_dwordx4 v[108:111], v194, s[20:23], s52 offen offset:3072 nt
    s_waitcnt vmcnt(12)
    v_lshlrev_b32 v240, 16, v88
    s_waitcnt lgkmcnt(14)
    v_mfma_f32_16x16x32_bf16 v[132:135], a[92:95], a[12:15], 4.0
    v_and_b32 v241, 0xffff0000, v88
    v_lshlrev_b32 v242, 16, v89
    v_mfma_f32_16x16x32_bf16 v[132:135], a[88:91], a[8:11], v[132:135]
    v_and_b32 v243, 0xffff0000, v89
    v_lshlrev_b32 v244, 16, v90
    v_mfma_f32_16x16x32_bf16 v[132:135], a[84:87], a[4:7], v[132:135]
    v_and_b32 v245, 0xffff0000, v90
    v_lshlrev_b32 v246, 16, v91
    v_mfma_f32_16x16x32_bf16 v[132:135], a[80:83], a[0:3], v[132:135]
    v_and_b32 v247, 0xffff0000, v91
    v_exp_f32 v128, v128
    v_exp_f32 v129, v129
    v_pk_mul_f32 v[240:241], v[240:241], s[70:71]
    v_pk_mul_f32 v[242:243], v[242:243], s[70:71]
    v_pk_mul_f32 v[244:245], v[244:245], s[70:71]
    v_pk_mul_f32 v[246:247], v[246:247], s[70:71]
    v_mfma_f32_16x16x32_bf16 v[0:3], v[168:171], a[160:163], v[0:3]
    s_waitcnt lgkmcnt(12)
    v_cvt_pk_bf16_f32 v88, v240, v241
    v_cvt_pk_bf16_f32 v89, v242, v243
    v_mfma_f32_16x16x32_bf16 v[4:7], v[168:171], a[164:167], v[4:7]
    s_waitcnt lgkmcnt(10)
    v_cvt_pk_bf16_f32 v90, v244, v245
    v_cvt_pk_bf16_f32 v91, v246, v247
    v_mfma_f32_16x16x32_bf16 v[8:11], v[168:171], a[168:171], v[8:11]
    s_waitcnt lgkmcnt(8)
    ds_write_b128 v222, v[88:91] offset:6144
    v_add_f32 v176, v176, v128
    v_mfma_f32_16x16x32_bf16 v[12:15], v[168:171], a[172:175], v[12:15]
    s_waitcnt lgkmcnt(7)
    v_add_f32 v177, v177, v129
    v_cvt_pk_bf16_f32 v160, v128, v129
    v_mfma_f32_16x16x32_bf16 v[16:19], v[168:171], a[176:179], v[16:19]
    s_waitcnt lgkmcnt(5)
    v_exp_f32 v130, v130
    v_mfma_f32_16x16x32_bf16 v[20:23], v[168:171], a[180:183], v[20:23]
    s_waitcnt lgkmcnt(3)
    v_add_f32 v176, v176, v130
    v_exp_f32 v131, v131
    v_mfma_f32_16x16x32_bf16 v[24:27], v[168:171], a[184:187], v[24:27]
    s_waitcnt lgkmcnt(1)
    v_add_f32 v177, v177, v131
    v_cvt_pk_bf16_f32 v161, v130, v131
    v_mfma_f32_16x16x32_bf16 v[28:31], v[168:171], a[188:191], v[28:31]
    v_exp_f32 v132, v132
    v_exp_f32 v133, v133
    v_add_f32 v176, v176, v132
    v_add_f32 v177, v177, v133
    v_cvt_pk_bf16_f32 v162, v132, v133
    v_exp_f32 v134, v134
    buffer_load_dwordx4 v219, s[24:27], s39 offen offset:3072 lds
    s_mov_b32 m0, s75
    s_waitcnt vmcnt(12)
    v_lshlrev_b32 v240, 16, v92
    v_and_b32 v241, 0xffff0000, v92
    v_lshlrev_b32 v242, 16, v93
    v_and_b32 v243, 0xffff0000, v93
    v_lshlrev_b32 v244, 16, v94
    v_and_b32 v245, 0xffff0000, v94
    v_lshlrev_b32 v246, 16, v95
    v_and_b32 v247, 0xffff0000, v95
    v_pk_mul_f32 v[240:241], v[240:241], s[70:71]
    v_pk_mul_f32 v[242:243], v[242:243], s[70:71]
    v_pk_mul_f32 v[244:245], v[244:245], s[70:71]
    v_pk_mul_f32 v[246:247], v[246:247], s[70:71]
    v_cvt_pk_bf16_f32 v92, v240, v241
    v_cvt_pk_bf16_f32 v93, v242, v243
    v_cvt_pk_bf16_f32 v94, v244, v245
    v_cvt_pk_bf16_f32 v95, v246, v247
    ds_write_b128 v223, v[92:95] offset:7168
    ds_read_b128 a[16:19], v232 offset:4096
    ds_read_b128 a[20:23], v233 offset:4096
    v_add_f32 v176, v176, v134
    v_exp_f32 v135, v135
    buffer_load_dwordx4 v[112:115], v194, s[20:23], s53 offen offset:0 nt
    ds_read_b128 a[24:27], v234 offset:4096
    ds_read_b128 a[28:31], v235 offset:4096
    v_add_f32 v177, v177, v135
    v_cvt_pk_bf16_f32 v163, v134, v135
    buffer_load_dwordx4 v216, s[24:27], s41 offen offset:0 lds
    s_waitcnt lgkmcnt(3)
    v_mfma_f32_16x16x32_bf16 v[156:159], a[112:115], a[16:19], 4.0
    s_waitcnt lgkmcnt(2)
    v_mfma_f32_16x16x32_bf16 v[156:159], a[116:119], a[20:23], v[156:159]
    v_mfma_f32_16x16x32_bf16 v[140:143], a[80:83], a[16:19], 4.0
    s_waitcnt lgkmcnt(0)
    v_mfma_f32_16x16x32_bf16 v[152:155], a[108:111], a[28:31], 4.0
    v_mfma_f32_16x16x32_bf16 v[152:155], a[104:107], a[24:27], v[152:155]
    v_mfma_f32_16x16x32_bf16 v[152:155], a[100:103], a[20:23], v[152:155]
    v_mfma_f32_16x16x32_bf16 v[152:155], a[96:99], a[16:19], v[152:155]
    buffer_load_dwordx4 v[116:119], v194, s[20:23], s53 offen offset:1024 nt
    v_mfma_f32_16x16x32_bf16 v[156:159], a[120:123], a[24:27], v[156:159]
    v_mfma_f32_16x16x32_bf16 v[156:159], a[124:127], a[28:31], v[156:159]
    v_mfma_f32_16x16x32_bf16 v[136:139], a[76:79], a[28:31], 4.0
    s_nop 3
    v_exp_f32 v152, v152
    v_mfma_f32_16x16x32_bf16 v[136:139], a[72:75], a[24:27], v[136:139]
    v_add_f32 v178, v178, v152
    v_exp_f32 v153, v153
    v_mfma_f32_16x16x32_bf16 v[136:139], a[68:71], a[20:23], v[136:139]
    v_add_f32 v179, v179, v153
    v_cvt_pk_bf16_f32 v172, v152, v153
    v_mfma_f32_16x16x32_bf16 v[136:139], a[64:67], a[16:19], v[136:139]
    v_exp_f32 v154, v154
    v_mfma_f32_16x16x32_bf16 v[140:143], a[84:87], a[20:23], v[140:143]
    s_waitcnt vmcnt(11)
    s_barrier
    v_mfma_f32_16x16x32_bf16 v[140:143], a[88:91], a[24:27], v[140:143]
    buffer_load_dwordx4 v217, s[24:27], s41 offen offset:1024 lds
    v_mfma_f32_16x16x32_bf16 v[140:143], a[92:95], a[28:31], v[140:143]
    ds_read_b128 a[96:99], v196 offset:57344
    ds_read_b128 a[100:103], v197 offset:57344
    v_mfma_f32_32x32x16_bf16 v[64:79], a[196:199], a[196:199], 0
    ds_read_b128 a[104:107], v198 offset:57344
    ds_read_b128 a[108:111], v199 offset:57344
    ds_read_b128 a[112:115], v196 offset:61440
    v_add_f32 v178, v178, v154
    v_exp_f32 v155, v155
    v_mfma_f32_32x32x16_bf16 v[80:95], a[196:199], a[196:199], 0
    ds_read_b128 a[116:119], v197 offset:61440
    v_add_f32 v179, v179, v155
    v_cvt_pk_bf16_f32 v173, v154, v155
    v_exp_f32 v156, v156
    v_exp_f32 v157, v157
    v_add_f32 v178, v178, v156
    v_add_f32 v179, v179, v157
    v_cvt_pk_bf16_f32 v174, v156, v157
    v_exp_f32 v158, v158
    v_exp_f32 v159, v159
    v_add_f32 v178, v178, v158
    v_add_f32 v179, v179, v159
    v_cvt_pk_bf16_f32 v175, v158, v159
    v_exp_f32 v136, v136
    s_nop 0
    v_mfma_f32_16x16x32_bf16 v[32:35], v[172:175], a[160:163], v[32:35]
    ds_read_b128 a[120:123], v198 offset:61440
    ds_read_b128 a[124:127], v199 offset:61440
    v_mfma_f32_16x16x32_bf16 v[36:39], v[172:175], a[164:167], v[36:39]
    ds_read_b64_tr_b16 a[128:129], v200 offset:49152
    ds_read_b64_tr_b16 a[130:131], v200 offset:53248
    v_mfma_f32_16x16x32_bf16 v[40:43], v[172:175], a[168:171], v[40:43]
    ds_read_b64_tr_b16 a[132:133], v201 offset:49152
    ds_read_b64_tr_b16 a[134:135], v201 offset:53248
    v_mfma_f32_16x16x32_bf16 v[44:47], v[172:175], a[172:175], v[44:47]
    ds_read_b64_tr_b16 a[136:137], v202 offset:49152
    ds_read_b64_tr_b16 a[138:139], v202 offset:53248
    v_mfma_f32_16x16x32_bf16 v[48:51], v[172:175], a[176:179], v[48:51]
    ds_read_b64_tr_b16 a[140:141], v203 offset:49152
    ds_read_b64_tr_b16 a[142:143], v203 offset:53248
    v_mfma_f32_16x16x32_bf16 v[52:55], v[172:175], a[180:183], v[52:55]
    buffer_load_dwordx4 v[120:123], v194, s[20:23], s53 offen offset:2048 nt
    v_mfma_f32_16x16x32_bf16 v[56:59], v[172:175], a[184:187], v[56:59]
    ds_read_b64_tr_b16 a[144:145], v204 offset:49152
    ds_read_b64_tr_b16 a[146:147], v204 offset:53248
    v_mfma_f32_16x16x32_bf16 v[60:63], v[172:175], a[188:191], v[60:63]
    s_waitcnt lgkmcnt(14)
    ds_read_b64_tr_b16 a[148:149], v205 offset:49152
    ds_read_b64_tr_b16 a[150:151], v205 offset:53248
    v_mfma_f32_16x16x32_bf16 v[144:147], a[96:99], a[0:3], 4.0
    ds_read_b64_tr_b16 a[152:153], v206 offset:49152
    ds_read_b64_tr_b16 a[154:155], v206 offset:53248
    v_mfma_f32_16x16x32_bf16 v[144:147], a[100:103], a[4:7], v[144:147]
    ds_read_b64_tr_b16 a[156:157], v207 offset:49152
    ds_read_b64_tr_b16 a[158:159], v207 offset:53248
    v_mfma_f32_16x16x32_bf16 v[144:147], a[104:107], a[8:11], v[144:147]
    s_waitcnt vmcnt(12)
    v_lshlrev_b32 v240, 16, v96
    v_and_b32 v241, 0xffff0000, v96
    v_mfma_f32_16x16x32_bf16 v[144:147], a[108:111], a[12:15], v[144:147]
    v_lshlrev_b32 v242, 16, v97
    v_and_b32 v243, 0xffff0000, v97
    v_mfma_f32_16x16x32_bf16 v[152:155], a[108:111], a[28:31], 4.0
    v_lshlrev_b32 v244, 16, v98
    v_and_b32 v245, 0xffff0000, v98
    v_mfma_f32_16x16x32_bf16 v[152:155], a[104:107], a[24:27], v[152:155]
    buffer_load_dwordx4 v218, s[24:27], s41 offen offset:2048 lds
    v_mfma_f32_16x16x32_bf16 v[152:155], a[100:103], a[20:23], v[152:155]
    v_lshlrev_b32 v246, 16, v99
    v_and_b32 v247, 0xffff0000, v99
    v_add_f32 v178, v178, v136
    v_exp_f32 v137, v137
    v_pk_mul_f32 v[240:241], v[240:241], s[70:71]
    v_pk_mul_f32 v[242:243], v[242:243], s[70:71]
    v_pk_mul_f32 v[244:245], v[244:245], s[70:71]
    v_pk_mul_f32 v[246:247], v[246:247], s[70:71]
    v_mfma_f32_16x16x32_bf16 v[152:155], a[96:99], a[16:19], v[152:155]
    s_waitcnt lgkmcnt(14)
    v_cvt_pk_bf16_f32 v96, v240, v241
    v_cvt_pk_bf16_f32 v97, v242, v243
    v_mfma_f32_16x16x32_bf16 v[156:159], a[112:115], a[16:19], 4.0
    v_cvt_pk_bf16_f32 v98, v244, v245
    v_cvt_pk_bf16_f32 v99, v246, v247
    v_mfma_f32_16x16x32_bf16 v[156:159], a[116:119], a[20:23], v[156:159]
    ds_write_b128 v220, v[96:99] offset:0
    v_add_f32 v179, v179, v137
    v_mfma_f32_16x16x32_bf16 v[156:159], a[120:123], a[24:27], v[156:159]
    v_cvt_pk_bf16_f32 v164, v136, v137
    v_exp_f32 v138, v138
    v_mfma_f32_16x16x32_bf16 v[156:159], a[124:127], a[28:31], v[156:159]
    v_add_f32 v178, v178, v138
    v_exp_f32 v139, v139
    v_mfma_f32_16x16x32_bf16 v[148:151], a[124:127], a[12:15], 4.0
    v_add_f32 v179, v179, v139
    v_cvt_pk_bf16_f32 v165, v138, v139
    v_mfma_f32_16x16x32_bf16 v[148:151], a[120:123], a[8:11], v[148:151]
    v_exp_f32 v140, v140
    v_mfma_f32_16x16x32_bf16 v[148:151], a[116:119], a[4:7], v[148:151]
    v_add_f32 v178, v178, v140
    v_exp_f32 v141, v141
    v_mfma_f32_16x16x32_bf16 v[148:151], a[112:115], a[0:3], v[148:151]
    v_add_f32 v179, v179, v141
    v_cvt_pk_bf16_f32 v166, v140, v141
    v_mfma_f32_16x16x32_bf16 v[0:3], v[160:163], a[128:131], v[0:3]
    s_waitcnt lgkmcnt(13)
    v_exp_f32 v142, v142
    v_mfma_f32_16x16x32_bf16 v[4:7], v[160:163], a[132:135], v[4:7]
    s_waitcnt lgkmcnt(11)
    v_add_f32 v178, v178, v142
    v_exp_f32 v143, v143
    v_mfma_f32_16x16x32_bf16 v[8:11], v[160:163], a[136:139], v[8:11]
    s_waitcnt lgkmcnt(9)
    buffer_load_dwordx4 v[124:127], v194, s[20:23], s53 offen offset:3072 nt
    v_mfma_f32_16x16x32_bf16 v[12:15], v[160:163], a[140:143], v[12:15]
    s_waitcnt vmcnt(12)
    v_lshlrev_b32 v240, 16, v100
    v_and_b32 v241, 0xffff0000, v100
    s_waitcnt lgkmcnt(7)
    v_mfma_f32_16x16x32_bf16 v[16:19], v[160:163], a[144:147], v[16:19]
    v_lshlrev_b32 v242, 16, v101
    v_and_b32 v243, 0xffff0000, v101
    s_waitcnt lgkmcnt(5)
    v_mfma_f32_16x16x32_bf16 v[20:23], v[160:163], a[148:151], v[20:23]
    v_lshlrev_b32 v244, 16, v102
    v_and_b32 v245, 0xffff0000, v102
    s_waitcnt lgkmcnt(3)
    v_mfma_f32_16x16x32_bf16 v[24:27], v[160:163], a[152:155], v[24:27]
    v_lshlrev_b32 v246, 16, v103
    v_and_b32 v247, 0xffff0000, v103
    v_add_f32 v179, v179, v143
    v_cvt_pk_bf16_f32 v167, v142, v143
    v_exp_f32 v144, v144
    v_pk_mul_f32 v[240:241], v[240:241], s[70:71]
    v_pk_mul_f32 v[242:243], v[242:243], s[70:71]
    v_pk_mul_f32 v[244:245], v[244:245], s[70:71]
    v_pk_mul_f32 v[246:247], v[246:247], s[70:71]
    v_mfma_f32_16x16x32_bf16 v[32:35], v[164:167], a[128:131], v[32:35]
    v_cvt_pk_bf16_f32 v100, v240, v241
    v_cvt_pk_bf16_f32 v101, v242, v243
    v_mfma_f32_16x16x32_bf16 v[36:39], v[164:167], a[132:135], v[36:39]
    buffer_load_dwordx4 v219, s[24:27], s41 offen offset:3072 lds
    v_mfma_f32_16x16x32_bf16 v[40:43], v[164:167], a[136:139], v[40:43]
    s_mov_b32 m0, s76
    v_cvt_pk_bf16_f32 v102, v244, v245
    v_cvt_pk_bf16_f32 v103, v246, v247
    v_mfma_f32_16x16x32_bf16 v[44:47], v[164:167], a[140:143], v[44:47]
    ds_write_b128 v221, v[100:103] offset:1024
    v_exp_f32 v145, v145
    v_mfma_f32_16x16x32_bf16 v[48:51], v[164:167], a[144:147], v[48:51]
    v_cvt_pk_bf16_f32 v168, v144, v145
    v_exp_f32 v146, v146
    v_mfma_f32_16x16x32_bf16 v[52:55], v[164:167], a[148:151], v[52:55]
    v_exp_f32 v147, v147
    v_mfma_f32_16x16x32_bf16 v[56:59], v[164:167], a[152:155], v[56:59]
    s_waitcnt lgkmcnt(2)
    v_cvt_pk_bf16_f32 v169, v146, v147
    v_exp_f32 v152, v152
    v_mfma_f32_16x16x32_bf16 v[28:31], v[160:163], a[156:159], v[28:31]
    v_exp_f32 v153, v153
    v_mfma_f32_16x16x32_bf16 v[60:63], v[164:167], a[156:159], v[60:63]
    v_cvt_pk_bf16_f32 v172, v152, v153
    v_exp_f32 v154, v154
    v_exp_f32 v155, v155
    v_exp_f32 v156, v156
    v_cvt_pk_bf16_f32 v173, v154, v155
    v_exp_f32 v157, v157
    v_exp_f32 v158, v158
    v_cvt_pk_bf16_f32 v174, v156, v157
    v_exp_f32 v159, v159
    v_exp_f32 v148, v148
    v_cvt_pk_bf16_f32 v175, v158, v159
    v_exp_f32 v149, v149
    v_exp_f32 v150, v150
    v_cvt_pk_bf16_f32 v170, v148, v149
    v_exp_f32 v151, v151
    s_nop 0
    v_cvt_pk_bf16_f32 v171, v150, v151
    buffer_load_dwordx4 v216, s[24:27], s43 offen offset:0 lds
    s_waitcnt vmcnt(12)
    v_lshlrev_b32 v240, 16, v104
    v_and_b32 v241, 0xffff0000, v104
    v_lshlrev_b32 v242, 16, v105
    v_and_b32 v243, 0xffff0000, v105
    v_lshlrev_b32 v244, 16, v106
    v_and_b32 v245, 0xffff0000, v106
    v_lshlrev_b32 v246, 16, v107
    v_and_b32 v247, 0xffff0000, v107
    v_pk_mul_f32 v[240:241], v[240:241], s[70:71]
    v_pk_mul_f32 v[242:243], v[242:243], s[70:71]
    v_pk_mul_f32 v[244:245], v[244:245], s[70:71]
    v_pk_mul_f32 v[246:247], v[246:247], s[70:71]
    v_cvt_pk_bf16_f32 v104, v240, v241
    v_cvt_pk_bf16_f32 v105, v242, v243
    v_cvt_pk_bf16_f32 v106, v244, v245
    v_cvt_pk_bf16_f32 v107, v246, v247
    ds_write_b128 v222, v[104:107] offset:2048
    buffer_load_dwordx4 v217, s[24:27], s43 offen offset:1024 lds
    buffer_load_dwordx4 v218, s[24:27], s43 offen offset:2048 lds
    s_waitcnt vmcnt(12)
    v_lshlrev_b32 v240, 16, v108
    v_and_b32 v241, 0xffff0000, v108
    v_lshlrev_b32 v242, 16, v109
    v_and_b32 v243, 0xffff0000, v109
    v_lshlrev_b32 v244, 16, v110
    v_and_b32 v245, 0xffff0000, v110
    v_lshlrev_b32 v246, 16, v111
    v_and_b32 v247, 0xffff0000, v111
    v_pk_mul_f32 v[240:241], v[240:241], s[70:71]
    v_pk_mul_f32 v[242:243], v[242:243], s[70:71]
    v_pk_mul_f32 v[244:245], v[244:245], s[70:71]
    v_pk_mul_f32 v[246:247], v[246:247], s[70:71]
    v_cvt_pk_bf16_f32 v108, v240, v241
    v_cvt_pk_bf16_f32 v109, v242, v243
    v_cvt_pk_bf16_f32 v110, v244, v245
    v_cvt_pk_bf16_f32 v111, v246, v247
    ds_write_b128 v223, v[108:111] offset:3072
    ds_read_b128 a[32:35], v232 offset:0
    ds_read_b128 a[36:39], v233 offset:0
    ds_read_b128 a[40:43], v234 offset:0
    ds_read_b128 a[44:47], v235 offset:0
    s_waitcnt vmcnt(11)
    s_barrier
    buffer_load_dwordx4 v219, s[24:27], s43 offen offset:3072 lds
    s_mov_b32 m0, s77
    ds_read_b128 a[64:67], v196 offset:0
    ds_read_b128 a[68:71], v197 offset:0
    ds_read_b128 a[72:75], v198 offset:0
    ds_read_b128 a[76:79], v199 offset:0
    ds_read_b128 a[80:83], v196 offset:4096
    ds_read_b128 a[84:87], v197 offset:4096
    ds_read_b128 a[88:91], v198 offset:4096
    ds_read_b128 a[92:95], v199 offset:4096
    ds_read_b64_tr_b16 a[160:161], v200 offset:57344
    ds_read_b64_tr_b16 a[162:163], v200 offset:61440
    ds_read_b64_tr_b16 a[164:165], v201 offset:57344
    ds_read_b64_tr_b16 a[166:167], v201 offset:61440
    ds_read_b64_tr_b16 a[168:169], v202 offset:57344
    ds_read_b64_tr_b16 a[170:171], v202 offset:61440
    ds_read_b64_tr_b16 a[172:173], v203 offset:57344
    ds_read_b64_tr_b16 a[174:175], v203 offset:61440
    s_waitcnt lgkmcnt(14)
    v_mfma_f32_16x16x32_bf16 v[128:131], a[64:67], a[0:3], v[248:251]
    ds_read_b64_tr_b16 a[176:177], v204 offset:57344
    ds_read_b64_tr_b16 a[178:179], v204 offset:61440
    v_mfma_f32_16x16x32_bf16 v[128:131], a[68:71], a[4:7], v[128:131]
    s_waitcnt lgkmcnt(14)
    ds_read_b64_tr_b16 a[180:181], v205 offset:57344
    ds_read_b64_tr_b16 a[182:183], v205 offset:61440
    v_mfma_f32_16x16x32_bf16 v[128:131], a[72:75], a[8:11], v[128:131]
    ds_read_b64_tr_b16 a[184:185], v206 offset:57344
    ds_read_b64_tr_b16 a[186:187], v206 offset:61440
    v_mfma_f32_16x16x32_bf16 v[128:131], a[76:79], a[12:15], v[128:131]
    buffer_load_dwordx4 v216, s[24:27], s45 offen offset:0 lds
    v_mfma_f32_16x16x32_bf16 v[136:139], a[76:79], a[28:31], v[248:251]
    ds_read_b64_tr_b16 a[188:189], v207 offset:57344
    ds_read_b64_tr_b16 a[190:191], v207 offset:61440
    v_mfma_f32_16x16x32_bf16 v[136:139], a[72:75], a[24:27], v[136:139]
    s_waitcnt vmcnt(12)
    v_lshlrev_b32 v240, 16, v112
    v_and_b32 v241, 0xffff0000, v112
    v_mfma_f32_16x16x32_bf16 v[136:139], a[68:71], a[20:23], v[136:139]
    v_lshlrev_b32 v242, 16, v113
    v_and_b32 v243, 0xffff0000, v113
    v_mfma_f32_16x16x32_bf16 v[136:139], a[64:67], a[16:19], v[136:139]
    v_lshlrev_b32 v244, 16, v114
    v_and_b32 v245, 0xffff0000, v114
    s_waitcnt lgkmcnt(14)
    v_mfma_f32_16x16x32_bf16 v[140:143], a[80:83], a[16:19], v[252:255]
    v_lshlrev_b32 v246, 16, v115
    v_and_b32 v247, 0xffff0000, v115
    v_exp_f32 v128, v128
    v_exp_f32 v129, v129
    v_pk_mul_f32 v[240:241], v[240:241], s[70:71]
    v_pk_mul_f32 v[242:243], v[242:243], s[70:71]
    v_pk_mul_f32 v[244:245], v[244:245], s[70:71]
    v_pk_mul_f32 v[246:247], v[246:247], s[70:71]
    v_mfma_f32_16x16x32_bf16 v[140:143], a[84:87], a[20:23], v[140:143]
    buffer_load_dwordx4 v217, s[24:27], s45 offen offset:1024 lds
    v_mfma_f32_16x16x32_bf16 v[140:143], a[88:91], a[24:27], v[140:143]
    v_cvt_pk_bf16_f32 v112, v240, v241
    v_cvt_pk_bf16_f32 v113, v242, v243
    v_mfma_f32_16x16x32_bf16 v[140:143], a[92:95], a[28:31], v[140:143]
L_hop0:
    s_cbranch_vccnz L_hop0_1
    v_cvt_pk_bf16_f32 v114, v244, v245
    v_cvt_pk_bf16_f32 v115, v246, v247
    v_mfma_f32_16x16x32_bf16 v[132:135], a[92:95], a[12:15], v[252:255]
    ds_write_b128 v220, v[112:115] offset:4096
    v_add_f32 v176, v176, v128
    v_mfma_f32_16x16x32_bf16 v[132:135], a[88:91], a[8:11], v[132:135]
    v_add_f32 v177, v177, v129
    v_cvt_pk_bf16_f32 v160, v128, v129
    v_mfma_f32_16x16x32_bf16 v[132:135], a[84:87], a[4:7], v[132:135]
    v_exp_f32 v130, v130
    v_mfma_f32_16x16x32_bf16 v[132:135], a[80:83], a[0:3], v[132:135]
    v_add_f32 v176, v176, v130
    v_exp_f32 v131, v131
    v_mfma_f32_16x16x32_bf16 v[144:147], a[64:67], a[32:35], v[248:251]
    v_add_f32 v177, v177, v131
    v_cvt_pk_bf16_f32 v161, v130, v131
    v_mfma_f32_16x16x32_bf16 v[144:147], a[68:71], a[36:39], v[144:147]
    v_exp_f32 v136, v136
    v_mfma_f32_16x16x32_bf16 v[144:147], a[72:75], a[40:43], v[144:147]
    v_add_f32 v178, v178, v136
    v_exp_f32 v137, v137
    v_mfma_f32_16x16x32_bf16 v[144:147], a[76:79], a[44:47], v[144:147]
    v_add_f32 v179, v179, v137
    v_cvt_pk_bf16_f32 v164, v136, v137
    v_mfma_f32_16x16x32_bf16 v[148:151], a[92:95], a[44:47], v[252:255]
    v_exp_f32 v138, v138
    v_mfma_f32_16x16x32_bf16 v[148:151], a[88:91], a[40:43], v[148:151]
    v_add_f32 v178, v178, v138
    v_exp_f32 v139, v139
    v_mfma_f32_16x16x32_bf16 v[148:151], a[84:87], a[36:39], v[148:151]
    v_add_f32 v179, v179, v139
    v_cvt_pk_bf16_f32 v165, v138, v139
    v_mfma_f32_16x16x32_bf16 v[148:151], a[80:83], a[32:35], v[148:151]
    v_exp_f32 v140, v140
    v_exp_f32 v141, v141
    buffer_load_dwordx4 v218, s[24:27], s45 offen offset:2048 lds
    s_waitcnt vmcnt(12)
    v_lshlrev_b32 v240, 16, v116
    v_and_b32 v241, 0xffff0000, v116
    v_lshlrev_b32 v242, 16, v117
    v_and_b32 v243, 0xffff0000, v117
    v_lshlrev_b32 v244, 16, v118
    v_and_b32 v245, 0xffff0000, v118
    v_lshlrev_b32 v246, 16, v119
    v_and_b32 v247, 0xffff0000, v119
    v_pk_mul_f32 v[240:241], v[240:241], s[70:71]
    v_pk_mul_f32 v[242:243], v[242:243], s[70:71]
    v_pk_mul_f32 v[244:245], v[244:245], s[70:71]
    v_pk_mul_f32 v[246:247], v[246:247], s[70:71]
    v_cvt_pk_bf16_f32 v116, v240, v241
    v_cvt_pk_bf16_f32 v117, v242, v243
    v_cvt_pk_bf16_f32 v118, v244, v245
    v_cvt_pk_bf16_f32 v119, v246, v247
    ds_write_b128 v221, v[116:119] offset:5120
    v_add_f32 v178, v178, v140
    v_add_f32 v179, v179, v141
    v_cvt_pk_bf16_f32 v166, v140, v141
    v_exp_f32 v142, v142
    v_exp_f32 v143, v143
    buffer_load_dwordx4 v219, s[24:27], s45 offen offset:3072 lds
    v_add_f32 v178, v178, v142
    v_add_f32 v179, v179, v143
    v_cvt_pk_bf16_f32 v167, v142, v143
    v_exp_f32 v132, v132
    v_exp_f32 v133, v133
    v_add_f32 v176, v176, v132
    v_add_f32 v177, v177, v133
    v_cvt_pk_bf16_f32 v162, v132, v133
    v_exp_f32 v134, v134
    v_exp_f32 v135, v135
    v_add_f32 v176, v176, v134
    v_add_f32 v177, v177, v135
    v_cvt_pk_bf16_f32 v163, v134, v135
    v_exp_f32 v144, v144
    v_exp_f32 v145, v145
    v_exp_f32 v146, v146
    v_exp_f32 v147, v147
    s_waitcnt vmcnt(11)
    v_lshlrev_b32 v240, 16, v120
    v_and_b32 v241, 0xffff0000, v120
    v_lshlrev_b32 v242, 16, v121
    v_and_b32 v243, 0xffff0000, v121
    v_lshlrev_b32 v244, 16, v122
    v_and_b32 v245, 0xffff0000, v122
    v_lshlrev_b32 v246, 16, v123
    v_and_b32 v247, 0xffff0000, v123
    v_pk_mul_f32 v[240:241], v[240:241], s[70:71]
    v_pk_mul_f32 v[242:243], v[242:243], s[70:71]
    v_pk_mul_f32 v[244:245], v[244:245], s[70:71]
    v_pk_mul_f32 v[246:247], v[246:247], s[70:71]
    v_cvt_pk_bf16_f32 v120, v240, v241
    v_cvt_pk_bf16_f32 v121, v242, v243
    v_cvt_pk_bf16_f32 v122, v244, v245
    v_cvt_pk_bf16_f32 v123, v246, v247
    ds_write_b128 v222, v[120:123] offset:6144
    s_waitcnt vmcnt(9)
    v_lshlrev_b32 v240, 16, v124
    v_and_b32 v241, 0xffff0000, v124
    v_lshlrev_b32 v242, 16, v125
    v_and_b32 v243, 0xffff0000, v125
    v_lshlrev_b32 v244, 16, v126
    v_and_b32 v245, 0xffff0000, v126
    v_lshlrev_b32 v246, 16, v127
    v_and_b32 v247, 0xffff0000, v127
    v_pk_mul_f32 v[240:241], v[240:241], s[70:71]
    v_pk_mul_f32 v[242:243], v[242:243], s[70:71]
    v_pk_mul_f32 v[244:245], v[244:245], s[70:71]
    v_pk_mul_f32 v[246:247], v[246:247], s[70:71]
    v_cvt_pk_bf16_f32 v124, v240, v241
    v_cvt_pk_bf16_f32 v125, v242, v243
    v_cvt_pk_bf16_f32 v126, v244, v245
    v_cvt_pk_bf16_f32 v127, v246, v247
    ds_write_b128 v223, v[124:127] offset:7168
    ds_read_b128 a[48:51], v232 offset:4096
    ds_read_b128 a[52:55], v233 offset:4096
    ds_read_b128 a[56:59], v234 offset:4096
    ds_read_b128 a[60:63], v235 offset:4096
    s_waitcnt vmcnt(8) lgkmcnt(0)
    s_barrier
    s_mov_b32 m0, s16
    s_lshl_b32 s57, s58, 17
    s_add_u32 s55, s55, 8
    ds_read_b128 a[96:99], v196 offset:8192
    ds_read_b128 a[100:103], v197 offset:8192
    s_min_u32 s60, s55, s59
    buffer_load_dwordx4 v216, s[24:27], s57 offen offset:0 lds
    s_load_dword s58, s[10:11], s60
    s_cmp_le_u32 s55, s59
    ds_read_b128 a[104:107], v198 offset:8192
    ds_read_b128 a[108:111], v199 offset:8192
    ds_read_b128 a[112:115], v196 offset:12288
    ds_read_b128 a[116:119], v197 offset:12288
    ds_read_b128 a[120:123], v198 offset:12288
    buffer_load_dwordx4 v217, s[24:27], s57 offen offset:1024 lds
    v_mfma_f32_16x16x32_bf16 v[156:159], a[80:83], a[48:51], v[252:255]
    ds_read_b128 a[124:127], v199 offset:12288
    v_mfma_f32_16x16x32_bf16 v[156:159], a[84:87], a[52:55], v[156:159]
    ds_read_b64_tr_b16 a[128:129], v200 offset:0
    ds_read_b64_tr_b16 a[130:131], v200 offset:4096
    v_mfma_f32_16x16x32_bf16 v[152:155], a[76:79], a[60:63], v[248:251]
    buffer_load_dwordx4 v218, s[24:27], s57 offen offset:2048 lds
    v_mfma_f32_16x16x32_bf16 v[152:155], a[72:75], a[56:59], v[152:155]
    ds_read_b64_tr_b16 a[132:133], v201 offset:0
    ds_read_b64_tr_b16 a[134:135], v201 offset:4096
    v_mfma_f32_16x16x32_bf16 v[152:155], a[68:71], a[52:55], v[152:155]
    ds_read_b64_tr_b16 a[136:137], v202 offset:0
    ds_read_b64_tr_b16 a[138:139], v202 offset:4096
    v_mfma_f32_16x16x32_bf16 v[152:155], a[64:67], a[48:51], v[152:155]
    buffer_load_dwordx4 v219, s[24:27], s57 offen offset:3072 lds
    v_mfma_f32_16x16x32_bf16 v[156:159], a[88:91], a[56:59], v[156:159]
    s_cselect_b32 s26, s26, 0
    ds_read_b64_tr_b16 a[140:141], v203 offset:0
    s_cmp_eq_u32 s55, s56
    v_mfma_f32_16x16x32_bf16 v[156:159], a[92:95], a[60:63], v[156:159]
    v_mfma_f32_32x32x16_bf16 v[96:111], a[196:199], a[196:199], 0
    s_nop 0
    v_exp_f32 v152, v152
    v_exp_f32 v153, v153
    v_exp_f32 v154, v154
    v_mfma_f32_32x32x16_bf16 v[112:127], a[196:199], a[196:199], 0
    v_exp_f32 v155, v155
    s_nop 0
    v_exp_f32 v156, v156
    s_waitcnt lgkmcnt(7)
    s_cbranch_scc1 L_tail0
    s_bitcmp1_b32 s48, 1
    s_cbranch_scc1 L_loop2
.p2alignl 5, 0xbf800000
    s_nop 0
L_loop:
    v_cvt_pk_bf16_f32 v163, v134, v135
    v_mfma_f32_16x16x32_bf16 v[128:131], a[96:99], a[32:35], 4.0
    ds_read_b64_tr_b16 a[142:143], v203 offset:4096
    v_cvt_pk_bf16_f32 v248, v144, v145
    v_mfma_f32_16x16x32_bf16 v[128:131], a[100:103], a[36:39], v[128:131]
    v_exp_f32 v157, v157
    v_mfma_f32_16x16x32_bf16 v[128:131], a[104:107], a[40:43], v[128:131]
    ds_read_b64_tr_b16 a[144:145], v204 offset:0
    v_cvt_pk_bf16_f32 v249, v146, v147
    v_mfma_f32_16x16x32_bf16 v[128:131], a[108:111], a[44:47], v[128:131]
    v_exp_f32 v158, v158
    v_mfma_f32_16x16x32_bf16 v[136:139], a[108:111], a[60:63], 4.0
    ds_read_b64_tr_b16 a[146:147], v204 offset:4096
    v_cvt_pk_bf16_f32 v252, v152, v153
    v_mfma_f32_16x16x32_bf16 v[136:139], a[104:107], a[56:59], v[136:139]
    v_exp_f32 v159, v159
    v_mfma_f32_16x16x32_bf16 v[136:139], a[100:103], a[52:55], v[136:139]
    ds_read_b64_tr_b16 a[148:149], v205 offset:0
    v_cvt_pk_bf16_f32 v253, v154, v155
    v_mfma_f32_16x16x32_bf16 v[136:139], a[96:99], a[48:51], v[136:139]
    v_exp_f32 v148, v148
    v_mfma_f32_16x16x32_bf16 v[140:143], a[112:115], a[48:51], 4.0
    ds_read_b64_tr_b16 a[150:151], v205 offset:4096
    v_cvt_pk_bf16_f32 v254, v156, v157
    v_mfma_f32_16x16x32_bf16 v[140:143], a[116:119], a[52:55], v[140:143]
    v_exp_f32 v149, v149
    v_mfma_f32_16x16x32_bf16 v[140:143], a[120:123], a[56:59], v[140:143]
    ds_read_b64_tr_b16 a[152:153], v206 offset:0
    v_cvt_pk_bf16_f32 v255, v158, v159
    v_mfma_f32_16x16x32_bf16 v[140:143], a[124:127], a[60:63], v[140:143]
    v_exp_f32 v150, v150
    v_mfma_f32_16x16x32_bf16 v[132:135], a[124:127], a[44:47], 4.0
    ds_read_b64_tr_b16 a[154:155], v206 offset:4096
    v_cvt_pk_bf16_f32 v250, v148, v149
    v_mfma_f32_16x16x32_bf16 v[132:135], a[120:123], a[40:43], v[132:135]
    v_exp_f32 v151, v151
    v_mfma_f32_16x16x32_bf16 v[132:135], a[116:119], a[36:39], v[132:135]
    ds_read_b64_tr_b16 a[156:157], v207 offset:0
    v_cvt_pk_bf16_f32 v251, v150, v151
    v_mfma_f32_16x16x32_bf16 v[132:135], a[112:115], a[32:35], v[132:135]
    s_waitcnt lgkmcnt(7)
    ds_read_b64_tr_b16 a[158:159], v207 offset:4096
    v_mfma_f32_16x16x32_bf16 v[0:3], v[168:171], a[160:163], v[0:3]
    v_exp_f32 v128, v128
    v_mfma_f32_16x16x32_bf16 v[0:3], v[160:163], a[128:131], v[0:3]
    v_exp_f32 v129, v129
    v_mfma_f32_16x16x32_bf16 v[32:35], v[164:167], a[128:131], v[32:35]
    v_add_f32 v180, v180, v128
    v_add_f32 v181, v181, v129
    v_mfma_f32_16x16x32_bf16 v[32:35], v[172:175], a[160:163], v[32:35]
    v_exp_f32 v130, v130
    v_mfma_f32_16x16x32_bf16 v[36:39], v[172:175], a[164:167], v[36:39]
    v_exp_f32 v131, v131
    v_mfma_f32_16x16x32_bf16 v[36:39], v[164:167], a[132:135], v[36:39]
    v_add_f32 v180, v180, v130
    v_add_f32 v181, v181, v131
    v_mfma_f32_16x16x32_bf16 v[4:7], v[160:163], a[132:135], v[4:7]
    v_exp_f32 v136, v136
    v_mfma_f32_16x16x32_bf16 v[4:7], v[168:171], a[164:167], v[4:7]
    v_exp_f32 v137, v137
    v_mfma_f32_16x16x32_bf16 v[8:11], v[168:171], a[168:171], v[8:11]
    s_waitcnt vmcnt(4) lgkmcnt(0)
    v_add_f32 v182, v182, v136
    v_add_f32 v183, v183, v137
    v_mfma_f32_16x16x32_bf16 v[8:11], v[160:163], a[136:139], v[8:11]
    s_barrier
    v_exp_f32 v138, v138
    v_mfma_f32_16x16x32_bf16 v[40:43], v[164:167], a[136:139], v[40:43]
    s_mov_b32 m0, s66
    v_exp_f32 v139, v139
    v_mfma_f32_16x16x32_bf16 v[40:43], v[172:175], a[168:171], v[40:43]
    s_lshl_b32 s57, s58, 17
    v_add_f32 v182, v182, v138
    v_add_f32 v183, v183, v139
    v_mfma_f32_16x16x32_bf16 v[44:47], v[172:175], a[172:175], v[44:47]
    ds_read_b128 a[64:67], v196 offset:16384
    ds_read_b128 a[68:71], v197 offset:16384
    v_mfma_f32_16x16x32_bf16 v[44:47], v[164:167], a[140:143], v[44:47]
    buffer_load_dwordx4 v216, s[24:27], s57 offen offset:0 lds
    v_mfma_f32_16x16x32_bf16 v[12:15], v[160:163], a[140:143], v[12:15]
    s_add_u32 s55, s55, 8
    v_exp_f32 v140, v140
    v_mfma_f32_16x16x32_bf16 v[12:15], v[168:171], a[172:175], v[12:15]
    s_min_u32 s60, s55, s59
    v_exp_f32 v141, v141
    v_mfma_f32_16x16x32_bf16 v[144:147], a[96:99], a[0:3], 4.0
    s_load_dword s58, s[10:11], s60
    v_add_f32 v182, v182, v140
    v_add_f32 v183, v183, v141
    v_mfma_f32_16x16x32_bf16 v[144:147], a[100:103], a[4:7], v[144:147]
    ds_read_b128 a[72:75], v198 offset:16384
    ds_read_b128 a[76:79], v199 offset:16384
    v_mfma_f32_16x16x32_bf16 v[144:147], a[104:107], a[8:11], v[144:147]
    buffer_load_dwordx4 v217, s[24:27], s57 offen offset:1024 lds
    v_mfma_f32_16x16x32_bf16 v[144:147], a[108:111], a[12:15], v[144:147]
    v_exp_f32 v142, v142
    v_mfma_f32_16x16x32_bf16 v[152:155], a[108:111], a[28:31], 4.0
    v_exp_f32 v143, v143
    v_mfma_f32_16x16x32_bf16 v[152:155], a[104:107], a[24:27], v[152:155]
    v_add_f32 v182, v182, v142
    v_add_f32 v183, v183, v143
    v_mfma_f32_16x16x32_bf16 v[152:155], a[100:103], a[20:23], v[152:155]
    ds_read_b128 a[80:83], v196 offset:20480
    ds_read_b128 a[84:87], v197 offset:20480
    v_mfma_f32_16x16x32_bf16 v[152:155], a[96:99], a[16:19], v[152:155]
    buffer_load_dwordx4 v218, s[24:27], s57 offen offset:2048 lds
    v_mfma_f32_16x16x32_bf16 v[156:159], a[112:115], a[16:19], 4.0
    v_exp_f32 v132, v132
    v_mfma_f32_16x16x32_bf16 v[156:159], a[116:119], a[20:23], v[156:159]
    v_exp_f32 v133, v133
    v_mfma_f32_16x16x32_bf16 v[156:159], a[120:123], a[24:27], v[156:159]
    v_add_f32 v180, v180, v132
    v_add_f32 v181, v181, v133
    v_mfma_f32_16x16x32_bf16 v[156:159], a[124:127], a[28:31], v[156:159]
    ds_read_b128 a[88:91], v198 offset:20480
    ds_read_b128 a[92:95], v199 offset:20480
    v_mfma_f32_16x16x32_bf16 v[148:151], a[124:127], a[12:15], 4.0
    buffer_load_dwordx4 v219, s[24:27], s57 offen offset:3072 lds
    v_mfma_f32_16x16x32_bf16 v[148:151], a[120:123], a[8:11], v[148:151]
    v_exp_f32 v134, v134
    v_mfma_f32_16x16x32_bf16 v[148:151], a[116:119], a[4:7], v[148:151]
    v_exp_f32 v135, v135
    v_mfma_f32_16x16x32_bf16 v[148:151], a[112:115], a[0:3], v[148:151]
    v_add_f32 v180, v180, v134
    v_add_f32 v181, v181, v135
    v_mfma_f32_16x16x32_bf16 v[16:19], v[168:171], a[176:179], v[16:19]
    v_exp_f32 v144, v144
    v_mfma_f32_16x16x32_bf16 v[16:19], v[160:163], a[144:147], v[16:19]
    v_exp_f32 v145, v145
    v_mfma_f32_16x16x32_bf16 v[48:51], v[164:167], a[144:147], v[48:51]
    ds_read_b64_tr_b16 a[160:161], v200 offset:8192
    v_cvt_pk_bf16_f32 v240, v128, v129
    v_mfma_f32_16x16x32_bf16 v[48:51], v[172:175], a[176:179], v[48:51]
    s_cmp_le_u32 s55, s59
    v_exp_f32 v146, v146
    v_mfma_f32_16x16x32_bf16 v[52:55], v[172:175], a[180:183], v[52:55]
    ds_read_b64_tr_b16 a[162:163], v200 offset:12288
    v_cvt_pk_bf16_f32 v241, v130, v131
    v_mfma_f32_16x16x32_bf16 v[52:55], v[164:167], a[148:151], v[52:55]
    s_cselect_b32 s26, s26, 0
    v_exp_f32 v147, v147
    v_mfma_f32_16x16x32_bf16 v[20:23], v[160:163], a[148:151], v[20:23]
    ds_read_b64_tr_b16 a[164:165], v201 offset:8192
    v_cvt_pk_bf16_f32 v244, v136, v137
    v_mfma_f32_16x16x32_bf16 v[20:23], v[168:171], a[180:183], v[20:23]
    v_exp_f32 v152, v152
    v_mfma_f32_16x16x32_bf16 v[24:27], v[168:171], a[184:187], v[24:27]
    ds_read_b64_tr_b16 a[166:167], v201 offset:12288
    v_cvt_pk_bf16_f32 v245, v138, v139
    v_mfma_f32_16x16x32_bf16 v[24:27], v[160:163], a[152:155], v[24:27]
    v_exp_f32 v153, v153
    v_mfma_f32_16x16x32_bf16 v[56:59], v[164:167], a[152:155], v[56:59]
    ds_read_b64_tr_b16 a[168:169], v202 offset:8192
    v_cvt_pk_bf16_f32 v246, v140, v141
    v_mfma_f32_16x16x32_bf16 v[56:59], v[172:175], a[184:187], v[56:59]
    v_exp_f32 v154, v154
    v_mfma_f32_16x16x32_bf16 v[60:63], v[172:175], a[188:191], v[60:63]
    ds_read_b64_tr_b16 a[170:171], v202 offset:12288
    v_cvt_pk_bf16_f32 v247, v142, v143
    v_mfma_f32_16x16x32_bf16 v[60:63], v[164:167], a[156:159], v[60:63]
    v_exp_f32 v155, v155
    v_mfma_f32_16x16x32_bf16 v[28:31], v[160:163], a[156:159], v[28:31]
    s_cmp_eq_u32 s55, s56
    ds_read_b64_tr_b16 a[172:173], v203 offset:8192
    v_cvt_pk_bf16_f32 v242, v132, v133
    v_mfma_f32_16x16x32_bf16 v[28:31], v[168:171], a[188:191], v[28:31]
    s_waitcnt lgkmcnt(7)
    v_exp_f32 v156, v156
    v_smfmac_f32_16x16x64_bf16 v[184:187], a[192:195], v[168:175], v192
    s_cbranch_scc1 L_tail1
    v_cvt_pk_bf16_f32 v243, v134, v135
    v_mfma_f32_16x16x32_bf16 v[128:131], a[64:67], a[0:3], 4.0
    ds_read_b64_tr_b16 a[174:175], v203 offset:12288
    v_cvt_pk_bf16_f32 v168, v144, v145
    v_mfma_f32_16x16x32_bf16 v[128:131], a[68:71], a[4:7], v[128:131]
    v_exp_f32 v157, v157
    v_mfma_f32_16x16x32_bf16 v[128:131], a[72:75], a[8:11], v[128:131]
    ds_read_b64_tr_b16 a[176:177], v204 offset:8192
    v_cvt_pk_bf16_f32 v169, v146, v147
    v_mfma_f32_16x16x32_bf16 v[128:131], a[76:79], a[12:15], v[128:131]
    v_exp_f32 v158, v158
    v_mfma_f32_16x16x32_bf16 v[136:139], a[76:79], a[28:31], 4.0
    ds_read_b64_tr_b16 a[178:179], v204 offset:12288
    v_cvt_pk_bf16_f32 v172, v152, v153
    v_mfma_f32_16x16x32_bf16 v[136:139], a[72:75], a[24:27], v[136:139]
    v_exp_f32 v159, v159
    v_mfma_f32_16x16x32_bf16 v[136:139], a[68:71], a[20:23], v[136:139]
    ds_read_b64_tr_b16 a[180:181], v205 offset:8192
    v_cvt_pk_bf16_f32 v173, v154, v155
    v_mfma_f32_16x16x32_bf16 v[136:139], a[64:67], a[16:19], v[136:139]
    v_exp_f32 v148, v148
    v_mfma_f32_16x16x32_bf16 v[140:143], a[80:83], a[16:19], 4.0
    ds_read_b64_tr_b16 a[182:183], v205 offset:12288
    v_cvt_pk_bf16_f32 v174, v156, v157
    v_mfma_f32_16x16x32_bf16 v[140:143], a[84:87], a[20:23], v[140:143]
    v_exp_f32 v149, v149
    v_mfma_f32_16x16x32_bf16 v[140:143], a[88:91], a[24:27], v[140:143]
    ds_read_b64_tr_b16 a[184:185], v206 offset:8192
    v_cvt_pk_bf16_f32 v175, v158, v159
    v_mfma_f32_16x16x32_bf16 v[140:143], a[92:95], a[28:31], v[140:143]
    v_exp_f32 v150, v150
    v_mfma_f32_16x16x32_bf16 v[132:135], a[92:95], a[12:15], 4.0
    ds_read_b64_tr_b16 a[186:187], v206 offset:12288
    v_cvt_pk_bf16_f32 v170, v148, v149
    v_mfma_f32_16x16x32_bf16 v[132:135], a[88:91], a[8:11], v[132:135]
    v_exp_f32 v151, v151
    v_mfma_f32_16x16x32_bf16 v[132:135], a[84:87], a[4:7], v[132:135]
    ds_read_b64_tr_b16 a[188:189], v207 offset:8192
    v_cvt_pk_bf16_f32 v171, v150, v151
    v_mfma_f32_16x16x32_bf16 v[132:135], a[80:83], a[0:3], v[132:135]
    s_waitcnt lgkmcnt(7)
    ds_read_b64_tr_b16 a[190:191], v207 offset:12288
    v_mfma_f32_16x16x32_bf16 v[64:67], v[248:251], a[128:131], v[64:67]
    v_exp_f32 v128, v128
    v_mfma_f32_16x16x32_bf16 v[64:67], v[240:243], a[160:163], v[64:67]
    v_exp_f32 v129, v129
    v_mfma_f32_16x16x32_bf16 v[96:99], v[244:247], a[160:163], v[96:99]
    v_add_f32 v176, v176, v128
    v_add_f32 v177, v177, v129
    v_mfma_f32_16x16x32_bf16 v[96:99], v[252:255], a[128:131], v[96:99]
    v_exp_f32 v130, v130
    v_mfma_f32_16x16x32_bf16 v[100:103], v[252:255], a[132:135], v[100:103]
    v_exp_f32 v131, v131
    v_mfma_f32_16x16x32_bf16 v[100:103], v[244:247], a[164:167], v[100:103]
    v_add_f32 v176, v176, v130
    v_add_f32 v177, v177, v131
    v_mfma_f32_16x16x32_bf16 v[68:71], v[240:243], a[164:167], v[68:71]
    v_exp_f32 v136, v136
    v_mfma_f32_16x16x32_bf16 v[68:71], v[248:251], a[132:135], v[68:71]
    v_exp_f32 v137, v137
    v_mfma_f32_16x16x32_bf16 v[72:75], v[248:251], a[136:139], v[72:75]
    s_waitcnt lgkmcnt(0)
    v_add_f32 v178, v178, v136
    v_add_f32 v179, v179, v137
    v_mfma_f32_16x16x32_bf16 v[72:75], v[240:243], a[168:171], v[72:75]
    v_exp_f32_e64 v138, v138
    v_mfma_f32_16x16x32_bf16 v[104:107], v[244:247], a[168:171], v[104:107]
    s_mov_b32 m0, s67
    v_exp_f32 v139, v139
    v_mfma_f32_16x16x32_bf16 v[104:107], v[252:255], a[136:139], v[104:107]
    s_lshl_b32 s57, s58, 17
    v_add_f32 v178, v178, v138
    v_add_f32 v179, v179, v139
    v_mfma_f32_16x16x32_bf16 v[108:111], v[252:255], a[140:143], v[108:111]
    ds_read_b128 a[96:99], v196 offset:24576
    ds_read_b128 a[100:103], v197 offset:24576
    v_mfma_f32_16x16x32_bf16 v[108:111], v[244:247], a[172:175], v[108:111]
    buffer_load_dwordx4 v216, s[24:27], s57 offen offset:0 lds
    v_mfma_f32_16x16x32_bf16 v[76:79], v[240:243], a[172:175], v[76:79]
    s_add_u32 s55, s55, 8
    v_exp_f32 v140, v140
    v_mfma_f32_16x16x32_bf16 v[76:79], v[248:251], a[140:143], v[76:79]
    s_min_u32 s60, s55, s59
    v_exp_f32 v141, v141
    v_mfma_f32_16x16x32_bf16 v[144:147], a[64:67], a[32:35], 4.0
    s_load_dword s58, s[10:11], s60
    v_add_f32 v178, v178, v140
    v_add_f32 v179, v179, v141
    v_mfma_f32_16x16x32_bf16 v[144:147], a[68:71], a[36:39], v[144:147]
    ds_read_b128 a[104:107], v198 offset:24576
    ds_read_b128 a[108:111], v199 offset:24576
    v_mfma_f32_16x16x32_bf16 v[144:147], a[72:75], a[40:43], v[144:147]
    buffer_load_dwordx4 v217, s[24:27], s57 offen offset:1024 lds
    v_mfma_f32_16x16x32_bf16 v[144:147], a[76:79], a[44:47], v[144:147]
    v_exp_f32 v142, v142
    v_mfma_f32_16x16x32_bf16 v[152:155], a[76:79], a[60:63], 4.0
    v_exp_f32 v143, v143
    v_mfma_f32_16x16x32_bf16 v[152:155], a[72:75], a[56:59], v[152:155]
    v_add_f32 v178, v178, v142
    v_add_f32 v179, v179, v143
    v_mfma_f32_16x16x32_bf16 v[152:155], a[68:71], a[52:55], v[152:155]
    ds_read_b128 a[112:115], v196 offset:28672
    ds_read_b128 a[116:119], v197 offset:28672
    v_mfma_f32_16x16x32_bf16 v[152:155], a[64:67], a[48:51], v[152:155]
    buffer_load_dwordx4 v218, s[24:27], s57 offen offset:2048 lds
    v_mfma_f32_16x16x32_bf16 v[156:159], a[80:83], a[48:51], 4.0
    v_exp_f32 v132, v132
    v_mfma_f32_16x16x32_bf16 v[156:159], a[84:87], a[52:55], v[156:159]
    v_exp_f32 v133, v133
    v_mfma_f32_16x16x32_bf16 v[156:159], a[88:91], a[56:59], v[156:159]
    v_add_f32 v176, v176, v132
    v_add_f32 v177, v177, v133
    v_mfma_f32_16x16x32_bf16 v[156:159], a[92:95], a[60:63], v[156:159]
    ds_read_b128 a[120:123], v198 offset:28672
    ds_read_b128 a[124:127], v199 offset:28672
    v_mfma_f32_16x16x32_bf16 v[148:151], a[92:95], a[44:47], 4.0
    buffer_load_dwordx4 v219, s[24:27], s57 offen offset:3072 lds
    v_mfma_f32_16x16x32_bf16 v[148:151], a[88:91], a[40:43], v[148:151]
    v_exp_f32 v134, v134
    v_mfma_f32_16x16x32_bf16 v[148:151], a[84:87], a[36:39], v[148:151]
    v_exp_f32 v135, v135
    v_mfma_f32_16x16x32_bf16 v[148:151], a[80:83], a[32:35], v[148:151]
    v_add_f32 v176, v176, v134
    v_add_f32 v177, v177, v135
    v_mfma_f32_16x16x32_bf16 v[80:83], v[248:251], a[144:147], v[80:83]
    v_exp_f32 v144, v144
    v_mfma_f32_16x16x32_bf16 v[80:83], v[240:243], a[176:179], v[80:83]
    v_exp_f32 v145, v145
    v_mfma_f32_16x16x32_bf16 v[112:115], v[244:247], a[176:179], v[112:115]
    ds_read_b64_tr_b16 a[128:129], v200 offset:16384
    v_cvt_pk_bf16_f32 v160, v128, v129
    v_mfma_f32_16x16x32_bf16 v[112:115], v[252:255], a[144:147], v[112:115]
    s_cmp_le_u32 s55, s59
    v_exp_f32 v146, v146
    v_mfma_f32_16x16x32_bf16 v[116:119], v[252:255], a[148:151], v[116:119]
    ds_read_b64_tr_b16 a[130:131], v200 offset:20480
    v_cvt_pk_bf16_f32 v161, v130, v131
    v_mfma_f32_16x16x32_bf16 v[116:119], v[244:247], a[180:183], v[116:119]
    s_cselect_b32 s26, s26, 0
    v_exp_f32 v147, v147
    v_mfma_f32_16x16x32_bf16 v[84:87], v[240:243], a[180:183], v[84:87]
    ds_read_b64_tr_b16 a[132:133], v201 offset:16384
    v_cvt_pk_bf16_f32 v164, v136, v137
    v_mfma_f32_16x16x32_bf16 v[84:87], v[248:251], a[148:151], v[84:87]
    v_exp_f32 v152, v152
    v_mfma_f32_16x16x32_bf16 v[88:91], v[248:251], a[152:155], v[88:91]
    ds_read_b64_tr_b16 a[134:135], v201 offset:20480
    v_cvt_pk_bf16_f32 v165, v138, v139
    v_mfma_f32_16x16x32_bf16 v[88:91], v[240:243], a[184:187], v[88:91]
    v_exp_f32 v153, v153
    v_mfma_f32_16x16x32_bf16 v[120:123], v[244:247], a[184:187], v[120:123]
    ds_read_b64_tr_b16 a[136:137], v202 offset:16384
    v_cvt_pk_bf16_f32 v166, v140, v141
    v_mfma_f32_16x16x32_bf16 v[120:123], v[252:255], a[152:155], v[120:123]
    v_exp_f32 v154, v154
    v_mfma_f32_16x16x32_bf16 v[124:127], v[252:255], a[156:159], v[124:127]
    ds_read_b64_tr_b16 a[138:139], v202 offset:20480
    v_cvt_pk_bf16_f32 v167, v142, v143
    v_mfma_f32_16x16x32_bf16 v[124:127], v[244:247], a[188:191], v[124:127]
    v_exp_f32 v155, v155
    v_mfma_f32_16x16x32_bf16 v[92:95], v[240:243], a[188:191], v[92:95]
    s_cmp_eq_u32 s55, s56
    ds_read_b64_tr_b16 a[140:141], v203 offset:16384
    v_cvt_pk_bf16_f32 v162, v132, v133
    v_mfma_f32_16x16x32_bf16 v[92:95], v[248:251], a[156:159], v[92:95]
    s_waitcnt lgkmcnt(7)
    v_exp_f32 v156, v156
    v_smfmac_f32_16x16x64_bf16 v[188:191], a[192:195], v[248:255], v192
    s_cbranch_scc1 L_tail0
    v_cvt_pk_bf16_f32 v163, v134, v135
    v_mfma_f32_16x16x32_bf16 v[128:131], a[96:99], a[32:35], 4.0
    ds_read_b64_tr_b16 a[142:143], v203 offset:20480
    v_cvt_pk_bf16_f32 v248, v144, v145
    v_mfma_f32_16x16x32_bf16 v[128:131], a[100:103], a[36:39], v[128:131]
    v_exp_f32 v157, v157
    v_mfma_f32_16x16x32_bf16 v[128:131], a[104:107], a[40:43], v[128:131]
    ds_read_b64_tr_b16 a[144:145], v204 offset:16384
    v_cvt_pk_bf16_f32 v249, v146, v147
    v_mfma_f32_16x16x32_bf16 v[128:131], a[108:111], a[44:47], v[128:131]
    v_exp_f32 v158, v158
    v_mfma_f32_16x16x32_bf16 v[136:139], a[108:111], a[60:63], 4.0
    ds_read_b64_tr_b16 a[146:147], v204 offset:20480
    v_cvt_pk_bf16_f32 v252, v152, v153
    v_mfma_f32_16x16x32_bf16 v[136:139], a[104:107], a[56:59], v[136:139]
    v_exp_f32 v159, v159
    v_mfma_f32_16x16x32_bf16 v[136:139], a[100:103], a[52:55], v[136:139]
    ds_read_b64_tr_b16 a[148:149], v205 offset:16384
    v_cvt_pk_bf16_f32 v253, v154, v155
    v_mfma_f32_16x16x32_bf16 v[136:139], a[96:99], a[48:51], v[136:139]
    v_exp_f32 v148, v148
    v_mfma_f32_16x16x32_bf16 v[140:143], a[112:115], a[48:51], 4.0
    ds_read_b64_tr_b16 a[150:151], v205 offset:20480
    v_cvt_pk_bf16_f32 v254, v156, v157
    v_mfma_f32_16x16x32_bf16 v[140:143], a[116:119], a[52:55], v[140:143]
    v_exp_f32 v149, v149
    v_mfma_f32_16x16x32_bf16 v[140:143], a[120:123], a[56:59], v[140:143]
    ds_read_b64_tr_b16 a[152:153], v206 offset:16384
    v_cvt_pk_bf16_f32 v255, v158, v159
    v_mfma_f32_16x16x32_bf16 v[140:143], a[124:127], a[60:63], v[140:143]
    v_exp_f32 v150, v150
    v_mfma_f32_16x16x32_bf16 v[132:135], a[124:127], a[44:47], 4.0
    ds_read_b64_tr_b16 a[154:155], v206 offset:20480
    v_cvt_pk_bf16_f32 v250, v148, v149
    v_mfma_f32_16x16x32_bf16 v[132:135], a[120:123], a[40:43], v[132:135]
    v_exp_f32 v151, v151
    v_mfma_f32_16x16x32_bf16 v[132:135], a[116:119], a[36:39], v[132:135]
    ds_read_b64_tr_b16 a[156:157], v207 offset:16384
    v_cvt_pk_bf16_f32 v251, v150, v151
    v_mfma_f32_16x16x32_bf16 v[132:135], a[112:115], a[32:35], v[132:135]
    s_waitcnt lgkmcnt(7)
    ds_read_b64_tr_b16 a[158:159], v207 offset:20480
    v_mfma_f32_16x16x32_bf16 v[0:3], v[168:171], a[160:163], v[0:3]
    v_exp_f32 v128, v128
    v_mfma_f32_16x16x32_bf16 v[0:3], v[160:163], a[128:131], v[0:3]
    v_exp_f32 v129, v129
    v_mfma_f32_16x16x32_bf16 v[32:35], v[164:167], a[128:131], v[32:35]
    v_add_f32 v180, v180, v128
    v_add_f32 v181, v181, v129
    v_mfma_f32_16x16x32_bf16 v[32:35], v[172:175], a[160:163], v[32:35]
    v_exp_f32 v130, v130
    v_mfma_f32_16x16x32_bf16 v[36:39], v[172:175], a[164:167], v[36:39]
    v_exp_f32 v131, v131
    v_mfma_f32_16x16x32_bf16 v[36:39], v[164:167], a[132:135], v[36:39]
    v_add_f32 v180, v180, v130
    v_add_f32 v181, v181, v131
    v_mfma_f32_16x16x32_bf16 v[4:7], v[160:163], a[132:135], v[4:7]
    v_exp_f32 v136, v136
    v_mfma_f32_16x16x32_bf16 v[4:7], v[168:171], a[164:167], v[4:7]
    v_exp_f32 v137, v137
    v_mfma_f32_16x16x32_bf16 v[8:11], v[168:171], a[168:171], v[8:11]
    s_waitcnt vmcnt(4) lgkmcnt(0)
    v_add_f32 v182, v182, v136
    v_add_f32 v183, v183, v137
    v_mfma_f32_16x16x32_bf16 v[8:11], v[160:163], a[136:139], v[8:11]
    s_barrier
    v_exp_f32 v138, v138
    v_mfma_f32_16x16x32_bf16 v[40:43], v[164:167], a[136:139], v[40:43]
    s_mov_b32 m0, s68
    v_exp_f32 v139, v139
    v_mfma_f32_16x16x32_bf16 v[40:43], v[172:175], a[168:171], v[40:43]
    s_lshl_b32 s57, s58, 17
    v_add_f32 v182, v182, v138
    v_add_f32 v183, v183, v139
    v_mfma_f32_16x16x32_bf16 v[44:47], v[172:175], a[172:175], v[44:47]
    ds_read_b128 a[64:67], v196 offset:32768
    ds_read_b128 a[68:71], v197 offset:32768
    v_mfma_f32_16x16x32_bf16 v[44:47], v[164:167], a[140:143], v[44:47]
    buffer_load_dwordx4 v216, s[24:27], s57 offen offset:0 lds
    v_mfma_f32_16x16x32_bf16 v[12:15], v[160:163], a[140:143], v[12:15]
    s_add_u32 s55, s55, 8
    v_exp_f32 v140, v140
    v_mfma_f32_16x16x32_bf16 v[12:15], v[168:171], a[172:175], v[12:15]
    s_min_u32 s60, s55, s59
    v_exp_f32 v141, v141
    v_mfma_f32_16x16x32_bf16 v[144:147], a[96:99], a[0:3], 4.0
    s_load_dword s58, s[10:11], s60
    v_add_f32 v182, v182, v140
    v_add_f32 v183, v183, v141
    v_mfma_f32_16x16x32_bf16 v[144:147], a[100:103], a[4:7], v[144:147]
    ds_read_b128 a[72:75], v198 offset:32768
    ds_read_b128 a[76:79], v199 offset:32768
    v_mfma_f32_16x16x32_bf16 v[144:147], a[104:107], a[8:11], v[144:147]
    buffer_load_dwordx4 v217, s[24:27], s57 offen offset:1024 lds
    v_mfma_f32_16x16x32_bf16 v[144:147], a[108:111], a[12:15], v[144:147]
    v_exp_f32 v142, v142
    v_mfma_f32_16x16x32_bf16 v[152:155], a[108:111], a[28:31], 4.0
    v_exp_f32 v143, v143
    v_mfma_f32_16x16x32_bf16 v[152:155], a[104:107], a[24:27], v[152:155]
    v_add_f32 v182, v182, v142
    v_add_f32 v183, v183, v143
    v_mfma_f32_16x16x32_bf16 v[152:155], a[100:103], a[20:23], v[152:155]
    ds_read_b128 a[80:83], v196 offset:36864
    ds_read_b128 a[84:87], v197 offset:36864
    v_mfma_f32_16x16x32_bf16 v[152:155], a[96:99], a[16:19], v[152:155]
    buffer_load_dwordx4 v218, s[24:27], s57 offen offset:2048 lds
    v_mfma_f32_16x16x32_bf16 v[156:159], a[112:115], a[16:19], 4.0
    v_exp_f32 v132, v132
    v_mfma_f32_16x16x32_bf16 v[156:159], a[116:119], a[20:23], v[156:159]
    v_exp_f32 v133, v133
    v_mfma_f32_16x16x32_bf16 v[156:159], a[120:123], a[24:27], v[156:159]
    v_add_f32 v180, v180, v132
    v_add_f32 v181, v181, v133
    v_mfma_f32_16x16x32_bf16 v[156:159], a[124:127], a[28:31], v[156:159]
    ds_read_b128 a[88:91], v198 offset:36864
    ds_read_b128 a[92:95], v199 offset:36864
    v_mfma_f32_16x16x32_bf16 v[148:151], a[124:127], a[12:15], 4.0
L_hop1:
    s_cbranch_vccnz L_hop1_1
    buffer_load_dwordx4 v219, s[24:27], s57 offen offset:3072 lds
    v_mfma_f32_16x16x32_bf16 v[148:151], a[120:123], a[8:11], v[148:151]
    v_exp_f32 v134, v134
    v_mfma_f32_16x16x32_bf16 v[148:151], a[116:119], a[4:7], v[148:151]
    v_exp_f32 v135, v135
    v_mfma_f32_16x16x32_bf16 v[148:151], a[112:115], a[0:3], v[148:151]
    v_add_f32 v180, v180, v134
    v_add_f32 v181, v181, v135
    v_mfma_f32_16x16x32_bf16 v[16:19], v[168:171], a[176:179], v[16:19]
    v_exp_f32 v144, v144
    v_mfma_f32_16x16x32_bf16 v[16:19], v[160:163], a[144:147], v[16:19]
    v_exp_f32 v145, v145
    v_mfma_f32_16x16x32_bf16 v[48:51], v[164:167], a[144:147], v[48:51]
    ds_read_b64_tr_b16 a[160:161], v200 offset:24576
    v_cvt_pk_bf16_f32 v240, v128, v129
    v_mfma_f32_16x16x32_bf16 v[48:51], v[172:175], a[176:179], v[48:51]
    s_cmp_le_u32 s55, s59
    v_exp_f32 v146, v146
    v_mfma_f32_16x16x32_bf16 v[52:55], v[172:175], a[180:183], v[52:55]
    ds_read_b64_tr_b16 a[162:163], v200 offset:28672
    v_cvt_pk_bf16_f32 v241, v130, v131
    v_mfma_f32_16x16x32_bf16 v[52:55], v[164:167], a[148:151], v[52:55]
    s_cselect_b32 s26, s26, 0
    v_exp_f32 v147, v147
    v_mfma_f32_16x16x32_bf16 v[20:23], v[160:163], a[148:151], v[20:23]
    ds_read_b64_tr_b16 a[164:165], v201 offset:24576
    v_cvt_pk_bf16_f32 v244, v136, v137
    v_mfma_f32_16x16x32_bf16 v[20:23], v[168:171], a[180:183], v[20:23]
    v_exp_f32 v152, v152
    v_mfma_f32_16x16x32_bf16 v[24:27], v[168:171], a[184:187], v[24:27]
    ds_read_b64_tr_b16 a[166:167], v201 offset:28672
    v_cvt_pk_bf16_f32 v245, v138, v139
    v_mfma_f32_16x16x32_bf16 v[24:27], v[160:163], a[152:155], v[24:27]
    v_exp_f32 v153, v153
    v_mfma_f32_16x16x32_bf16 v[56:59], v[164:167], a[152:155], v[56:59]
    ds_read_b64_tr_b16 a[168:169], v202 offset:24576
    v_cvt_pk_bf16_f32 v246, v140, v141
    v_mfma_f32_16x16x32_bf16 v[56:59], v[172:175], a[184:187], v[56:59]
    v_exp_f32 v154, v154
    v_mfma_f32_16x16x32_bf16 v[60:63], v[172:175], a[188:191], v[60:63]
    ds_read_b64_tr_b16 a[170:171], v202 offset:28672
    v_cvt_pk_bf16_f32 v247, v142, v143
    v_mfma_f32_16x16x32_bf16 v[60:63], v[164:167], a[156:159], v[60:63]
    v_exp_f32 v155, v155
    v_mfma_f32_16x16x32_bf16 v[28:31], v[160:163], a[156:159], v[28:31]
    s_cmp_eq_u32 s55, s56
    ds_read_b64_tr_b16 a[172:173], v203 offset:24576
    v_cvt_pk_bf16_f32 v242, v132, v133
    v_mfma_f32_16x16x32_bf16 v[28:31], v[168:171], a[188:191], v[28:31]
    s_waitcnt lgkmcnt(7)
    v_exp_f32 v156, v156
    v_smfmac_f32_16x16x64_bf16 v[184:187], a[192:195], v[168:175], v192
    s_cbranch_scc1 L_tail1
    v_cvt_pk_bf16_f32 v243, v134, v135
    v_mfma_f32_16x16x32_bf16 v[128:131], a[64:67], a[0:3], 4.0
    ds_read_b64_tr_b16 a[174:175], v203 offset:28672
    v_cvt_pk_bf16_f32 v168, v144, v145
    v_mfma_f32_16x16x32_bf16 v[128:131], a[68:71], a[4:7], v[128:131]
    v_exp_f32 v157, v157
    v_mfma_f32_16x16x32_bf16 v[128:131], a[72:75], a[8:11], v[128:131]
    ds_read_b64_tr_b16 a[176:177], v204 offset:24576
    v_cvt_pk_bf16_f32 v169, v146, v147
    v_mfma_f32_16x16x32_bf16 v[128:131], a[76:79], a[12:15], v[128:131]
    v_exp_f32 v158, v158
    v_mfma_f32_16x16x32_bf16 v[136:139], a[76:79], a[28:31], 4.0
    ds_read_b64_tr_b16 a[178:179], v204 offset:28672
    v_cvt_pk_bf16_f32 v172, v152, v153
    v_mfma_f32_16x16x32_bf16 v[136:139], a[72:75], a[24:27], v[136:139]
    v_exp_f32 v159, v159
    v_mfma_f32_16x16x32_bf16 v[136:139], a[68:71], a[20:23], v[136:139]
    ds_read_b64_tr_b16 a[180:181], v205 offset:24576
    v_cvt_pk_bf16_f32 v173, v154, v155
    v_mfma_f32_16x16x32_bf16 v[136:139], a[64:67], a[16:19], v[136:139]
    v_exp_f32 v148, v148
    v_mfma_f32_16x16x32_bf16 v[140:143], a[80:83], a[16:19], 4.0
    ds_read_b64_tr_b16 a[182:183], v205 offset:28672
    v_cvt_pk_bf16_f32 v174, v156, v157
    v_mfma_f32_16x16x32_bf16 v[140:143], a[84:87], a[20:23], v[140:143]
    v_exp_f32 v149, v149
    v_mfma_f32_16x16x32_bf16 v[140:143], a[88:91], a[24:27], v[140:143]
    ds_read_b64_tr_b16 a[184:185], v206 offset:24576
    v_cvt_pk_bf16_f32 v175, v158, v159
    v_mfma_f32_16x16x32_bf16 v[140:143], a[92:95], a[28:31], v[140:143]
    v_exp_f32 v150, v150
    v_mfma_f32_16x16x32_bf16 v[132:135], a[92:95], a[12:15], 4.0
    ds_read_b64_tr_b16 a[186:187], v206 offset:28672
    v_cvt_pk_bf16_f32 v170, v148, v149
    v_mfma_f32_16x16x32_bf16 v[132:135], a[88:91], a[8:11], v[132:135]
    v_exp_f32 v151, v151
    v_mfma_f32_16x16x32_bf16 v[132:135], a[84:87], a[4:7], v[132:135]
    ds_read_b64_tr_b16 a[188:189], v207 offset:24576
    v_cvt_pk_bf16_f32 v171, v150, v151
    v_mfma_f32_16x16x32_bf16 v[132:135], a[80:83], a[0:3], v[132:135]
    s_waitcnt lgkmcnt(7)
    ds_read_b64_tr_b16 a[190:191], v207 offset:28672
    v_mfma_f32_16x16x32_bf16 v[64:67], v[248:251], a[128:131], v[64:67]
    v_exp_f32 v128, v128
    v_mfma_f32_16x16x32_bf16 v[64:67], v[240:243], a[160:163], v[64:67]
    v_exp_f32 v129, v129
    v_mfma_f32_16x16x32_bf16 v[96:99], v[244:247], a[160:163], v[96:99]
    v_add_f32 v176, v176, v128
    v_add_f32 v177, v177, v129
    v_mfma_f32_16x16x32_bf16 v[96:99], v[252:255], a[128:131], v[96:99]
    v_exp_f32 v130, v130
    v_mfma_f32_16x16x32_bf16 v[100:103], v[252:255], a[132:135], v[100:103]
    v_exp_f32 v131, v131
    v_mfma_f32_16x16x32_bf16 v[100:103], v[244:247], a[164:167], v[100:103]
    v_add_f32 v176, v176, v130
    v_add_f32 v177, v177, v131
    v_mfma_f32_16x16x32_bf16 v[68:71], v[240:243], a[164:167], v[68:71]
    v_exp_f32 v136, v136
    v_mfma_f32_16x16x32_bf16 v[68:71], v[248:251], a[132:135], v[68:71]
    v_exp_f32 v137, v137
    v_mfma_f32_16x16x32_bf16 v[72:75], v[248:251], a[136:139], v[72:75]
    s_waitcnt lgkmcnt(0)
    v_add_f32 v178, v178, v136
    v_add_f32 v179, v179, v137
    v_mfma_f32_16x16x32_bf16 v[72:75], v[240:243], a[168:171], v[72:75]
    v_exp_f32 v138, v138
    v_mfma_f32_16x16x32_bf16 v[104:107], v[244:247], a[168:171], v[104:107]
    s_mov_b32 m0, s69
    v_exp_f32 v139, v139
    v_mfma_f32_16x16x32_bf16 v[104:107], v[252:255], a[136:139], v[104:107]
    s_lshl_b32 s57, s58, 17
    v_add_f32 v178, v178, v138
    v_add_f32 v179, v179, v139
    v_mfma_f32_16x16x32_bf16 v[108:111], v[252:255], a[140:143], v[108:111]
    ds_read_b128 a[96:99], v196 offset:0
    ds_read_b128 a[100:103], v197 offset:0
    v_mfma_f32_16x16x32_bf16 v[108:111], v[244:247], a[172:175], v[108:111]
    buffer_load_dwordx4 v216, s[24:27], s57 offen offset:0 lds
    v_mfma_f32_16x16x32_bf16 v[76:79], v[240:243], a[172:175], v[76:79]
    s_add_u32 s55, s55, 8
    v_exp_f32 v140, v140
    v_mfma_f32_16x16x32_bf16 v[76:79], v[248:251], a[140:143], v[76:79]
    s_min_u32 s60, s55, s59
    v_exp_f32 v141, v141
    v_mfma_f32_16x16x32_bf16 v[144:147], a[64:67], a[32:35], 4.0
    s_load_dword s58, s[10:11], s60
    v_add_f32 v178, v178, v140
    v_add_f32 v179, v179, v141
    v_mfma_f32_16x16x32_bf16 v[144:147], a[68:71], a[36:39], v[144:147]
    ds_read_b128 a[104:107], v198 offset:0
    ds_read_b128 a[108:111], v199 offset:0
    v_mfma_f32_16x16x32_bf16 v[144:147], a[72:75], a[40:43], v[144:147]
    buffer_load_dwordx4 v217, s[24:27], s57 offen offset:1024 lds
    v_mfma_f32_16x16x32_bf16 v[144:147], a[76:79], a[44:47], v[144:147]
    v_exp_f32 v142, v142
    v_mfma_f32_16x16x32_bf16 v[152:155], a[76:79], a[60:63], 4.0
    v_exp_f32 v143, v143
    v_mfma_f32_16x16x32_bf16 v[152:155], a[72:75], a[56:59], v[152:155]
    v_add_f32 v178, v178, v142
    v_add_f32 v179, v179, v143
    v_mfma_f32_16x16x32_bf16 v[152:155], a[68:71], a[52:55], v[152:155]
    ds_read_b128 a[112:115], v196 offset:4096
    ds_read_b128 a[116:119], v197 offset:4096
    v_mfma_f32_16x16x32_bf16 v[152:155], a[64:67], a[48:51], v[152:155]
    buffer_load_dwordx4 v218, s[24:27], s57 offen offset:2048 lds
    v_mfma_f32_16x16x32_bf16 v[156:159], a[80:83], a[48:51], 4.0
    v_exp_f32 v132, v132
    v_mfma_f32_16x16x32_bf16 v[156:159], a[84:87], a[52:55], v[156:159]
    v_exp_f32 v133, v133
    v_mfma_f32_16x16x32_bf16 v[156:159], a[88:91], a[56:59], v[156:159]
    v_add_f32 v176, v176, v132
    v_add_f32 v177, v177, v133
    v_mfma_f32_16x16x32_bf16 v[156:159], a[92:95], a[60:63], v[156:159]
    ds_read_b128 a[120:123], v198 offset:4096
    ds_read_b128 a[124:127], v199 offset:4096
    v_mfma_f32_16x16x32_bf16 v[148:151], a[92:95], a[44:47], 4.0
    buffer_load_dwordx4 v219, s[24:27], s57 offen offset:3072 lds
    v_mfma_f32_16x16x32_bf16 v[148:151], a[88:91], a[40:43], v[148:151]
    v_exp_f32 v134, v134
    v_mfma_f32_16x16x32_bf16 v[148:151], a[84:87], a[36:39], v[148:151]
    v_exp_f32 v135, v135
    v_mfma_f32_16x16x32_bf16 v[148:151], a[80:83], a[32:35], v[148:151]
    v_add_f32 v176, v176, v134
    v_add_f32 v177, v177, v135
    v_mfma_f32_16x16x32_bf16 v[80:83], v[248:251], a[144:147], v[80:83]
    v_exp_f32 v144, v144
    v_mfma_f32_16x16x32_bf16 v[80:83], v[240:243], a[176:179], v[80:83]
    v_exp_f32 v145, v145
    v_mfma_f32_16x16x32_bf16 v[112:115], v[244:247], a[176:179], v[112:115]
    ds_read_b64_tr_b16 a[128:129], v200 offset:32768
    v_cvt_pk_bf16_f32 v160, v128, v129
    v_mfma_f32_16x16x32_bf16 v[112:115], v[252:255], a[144:147], v[112:115]
    s_cmp_le_u32 s55, s59
    v_exp_f32 v146, v146
    v_mfma_f32_16x16x32_bf16 v[116:119], v[252:255], a[148:151], v[116:119]
    ds_read_b64_tr_b16 a[130:131], v200 offset:36864
    v_cvt_pk_bf16_f32 v161, v130, v131
    v_mfma_f32_16x16x32_bf16 v[116:119], v[244:247], a[180:183], v[116:119]
    s_cselect_b32 s26, s26, 0
    v_exp_f32 v147, v147
    v_mfma_f32_16x16x32_bf16 v[84:87], v[240:243], a[180:183], v[84:87]
    ds_read_b64_tr_b16 a[132:133], v201 offset:32768
    v_cvt_pk_bf16_f32 v164, v136, v137
    v_mfma_f32_16x16x32_bf16 v[84:87], v[248:251], a[148:151], v[84:87]
    v_exp_f32 v152, v152
    v_mfma_f32_16x16x32_bf16 v[88:91], v[248:251], a[152:155], v[88:91]
    ds_read_b64_tr_b16 a[134:135], v201 offset:36864
    v_cvt_pk_bf16_f32 v165, v138, v139
    v_mfma_f32_16x16x32_bf16 v[88:91], v[240:243], a[184:187], v[88:91]
    v_exp_f32 v153, v153
    v_mfma_f32_16x16x32_bf16 v[120:123], v[244:247], a[184:187], v[120:123]
    ds_read_b64_tr_b16 a[136:137], v202 offset:32768
    v_cvt_pk_bf16_f32 v166, v140, v141
    v_mfma_f32_16x16x32_bf16 v[120:123], v[252:255], a[152:155], v[120:123]
    v_exp_f32 v154, v154
    v_mfma_f32_16x16x32_bf16 v[124:127], v[252:255], a[156:159], v[124:127]
    ds_read_b64_tr_b16 a[138:139], v202 offset:36864
    v_cvt_pk_bf16_f32 v167, v142, v143
    v_mfma_f32_16x16x32_bf16 v[124:127], v[244:247], a[188:191], v[124:127]
    v_exp_f32 v155, v155
    v_mfma_f32_16x16x32_bf16 v[92:95], v[240:243], a[188:191], v[92:95]
    s_cmp_eq_u32 s55, s56
    ds_read_b64_tr_b16 a[140:141], v203 offset:32768
    v_cvt_pk_bf16_f32 v162, v132, v133
    v_mfma_f32_16x16x32_bf16 v[92:95], v[248:251], a[156:159], v[92:95]
    s_waitcnt lgkmcnt(7)
    v_exp_f32 v156, v156
    v_smfmac_f32_16x16x64_bf16 v[188:191], a[192:195], v[248:255], v192
    s_cbranch_scc1 L_tail0
    v_cvt_pk_bf16_f32 v163, v134, v135
    v_mfma_f32_16x16x32_bf16 v[128:131], a[96:99], a[32:35], 4.0
    ds_read_b64_tr_b16 a[142:143], v203 offset:36864
    v_cvt_pk_bf16_f32 v248, v144, v145
    v_mfma_f32_16x16x32_bf16 v[128:131], a[100:103], a[36:39], v[128:131]
    v_exp_f32 v157, v157
    v_mfma_f32_16x16x32_bf16 v[128:131], a[104:107], a[40:43], v[128:131]
    ds_read_b64_tr_b16 a[144:145], v204 offset:32768
    v_cvt_pk_bf16_f32 v249, v146, v147
    v_mfma_f32_16x16x32_bf16 v[128:131], a[108:111], a[44:47], v[128:131]
    v_exp_f32 v158, v158
    v_mfma_f32_16x16x32_bf16 v[136:139], a[108:111], a[60:63], 4.0
    ds_read_b64_tr_b16 a[146:147], v204 offset:36864
    v_cvt_pk_bf16_f32 v252, v152, v153
    v_mfma_f32_16x16x32_bf16 v[136:139], a[104:107], a[56:59], v[136:139]
    v_exp_f32 v159, v159
    v_mfma_f32_16x16x32_bf16 v[136:139], a[100:103], a[52:55], v[136:139]
    ds_read_b64_tr_b16 a[148:149], v205 offset:32768
    v_cvt_pk_bf16_f32 v253, v154, v155
    v_mfma_f32_16x16x32_bf16 v[136:139], a[96:99], a[48:51], v[136:139]
    v_exp_f32 v148, v148
    v_mfma_f32_16x16x32_bf16 v[140:143], a[112:115], a[48:51], 4.0
    ds_read_b64_tr_b16 a[150:151], v205 offset:36864
    v_cvt_pk_bf16_f32 v254, v156, v157
    v_mfma_f32_16x16x32_bf16 v[140:143], a[116:119], a[52:55], v[140:143]
    v_exp_f32 v149, v149
    v_mfma_f32_16x16x32_bf16 v[140:143], a[120:123], a[56:59], v[140:143]
    ds_read_b64_tr_b16 a[152:153], v206 offset:32768
    v_cvt_pk_bf16_f32 v255, v158, v159
    v_mfma_f32_16x16x32_bf16 v[140:143], a[124:127], a[60:63], v[140:143]
    v_exp_f32 v150, v150
    v_mfma_f32_16x16x32_bf16 v[132:135], a[124:127], a[44:47], 4.0
    ds_read_b64_tr_b16 a[154:155], v206 offset:36864
    v_cvt_pk_bf16_f32 v250, v148, v149
    v_mfma_f32_16x16x32_bf16 v[132:135], a[120:123], a[40:43], v[132:135]
    v_exp_f32 v151, v151
    v_mfma_f32_16x16x32_bf16 v[132:135], a[116:119], a[36:39], v[132:135]
    ds_read_b64_tr_b16 a[156:157], v207 offset:32768
    v_cvt_pk_bf16_f32 v251, v150, v151
    v_mfma_f32_16x16x32_bf16 v[132:135], a[112:115], a[32:35], v[132:135]
    s_waitcnt lgkmcnt(7)
    ds_read_b64_tr_b16 a[158:159], v207 offset:36864
    v_mfma_f32_16x16x32_bf16 v[0:3], v[168:171], a[160:163], v[0:3]
    v_exp_f32 v128, v128
    v_mfma_f32_16x16x32_bf16 v[0:3], v[160:163], a[128:131], v[0:3]
    v_exp_f32 v129, v129
    v_mfma_f32_16x16x32_bf16 v[32:35], v[164:167], a[128:131], v[32:35]
    v_add_f32 v180, v180, v128
    v_add_f32 v181, v181, v129
    v_mfma_f32_16x16x32_bf16 v[32:35], v[172:175], a[160:163], v[32:35]
    v_exp_f32 v130, v130
    v_mfma_f32_16x16x32_bf16 v[36:39], v[172:175], a[164:167], v[36:39]
    v_exp_f32 v131, v131
    v_mfma_f32_16x16x32_bf16 v[36:39], v[164:167], a[132:135], v[36:39]
    v_add_f32 v180, v180, v130
    v_add_f32 v181, v181, v131
    v_mfma_f32_16x16x32_bf16 v[4:7], v[160:163], a[132:135], v[4:7]
    v_exp_f32 v136, v136
    v_mfma_f32_16x16x32_bf16 v[4:7], v[168:171], a[164:167], v[4:7]
    v_exp_f32 v137, v137
    v_mfma_f32_16x16x32_bf16 v[8:11], v[168:171], a[168:171], v[8:11]
    s_waitcnt vmcnt(4) lgkmcnt(0)
    v_add_f32 v182, v182, v136
    v_add_f32 v183, v183, v137
    v_mfma_f32_16x16x32_bf16 v[8:11], v[160:163], a[136:139], v[8:11]
    s_barrier
    v_exp_f32 v138, v138
    v_mfma_f32_16x16x32_bf16 v[40:43], v[164:167], a[136:139], v[40:43]
    s_mov_b32 m0, s16
    v_exp_f32 v139, v139
    v_mfma_f32_16x16x32_bf16 v[40:43], v[172:175], a[168:171], v[40:43]
    s_lshl_b32 s57, s58, 17
    v_add_f32 v182, v182, v138
    v_add_f32 v183, v183, v139
    v_mfma_f32_16x16x32_bf16 v[44:47], v[172:175], a[172:175], v[44:47]
    ds_read_b128 a[64:67], v196 offset:8192
    ds_read_b128 a[68:71], v197 offset:8192
    v_mfma_f32_16x16x32_bf16 v[44:47], v[164:167], a[140:143], v[44:47]
    buffer_load_dwordx4 v216, s[24:27], s57 offen offset:0 lds
    v_mfma_f32_16x16x32_bf16 v[12:15], v[160:163], a[140:143], v[12:15]
    s_add_u32 s55, s55, 8
    v_exp_f32 v140, v140
    v_mfma_f32_16x16x32_bf16 v[12:15], v[168:171], a[172:175], v[12:15]
    s_min_u32 s60, s55, s59
    v_exp_f32 v141, v141
    v_mfma_f32_16x16x32_bf16 v[144:147], a[96:99], a[0:3], 4.0
    s_load_dword s58, s[10:11], s60
    v_add_f32 v182, v182, v140
    v_add_f32 v183, v183, v141
    v_mfma_f32_16x16x32_bf16 v[144:147], a[100:103], a[4:7], v[144:147]
    ds_read_b128 a[72:75], v198 offset:8192
    ds_read_b128 a[76:79], v199 offset:8192
    v_mfma_f32_16x16x32_bf16 v[144:147], a[104:107], a[8:11], v[144:147]
    buffer_load_dwordx4 v217, s[24:27], s57 offen offset:1024 lds
    v_mfma_f32_16x16x32_bf16 v[144:147], a[108:111], a[12:15], v[144:147]
    v_exp_f32 v142, v142
    v_mfma_f32_16x16x32_bf16 v[152:155], a[108:111], a[28:31], 4.0
    v_exp_f32 v143, v143
    v_mfma_f32_16x16x32_bf16 v[152:155], a[104:107], a[24:27], v[152:155]
    v_add_f32 v182, v182, v142
    v_add_f32 v183, v183, v143
    v_mfma_f32_16x16x32_bf16 v[152:155], a[100:103], a[20:23], v[152:155]
    ds_read_b128 a[80:83], v196 offset:12288
    ds_read_b128 a[84:87], v197 offset:12288
    v_mfma_f32_16x16x32_bf16 v[152:155], a[96:99], a[16:19], v[152:155]
    buffer_load_dwordx4 v218, s[24:27], s57 offen offset:2048 lds
    v_mfma_f32_16x16x32_bf16 v[156:159], a[112:115], a[16:19], 4.0
    v_exp_f32 v132, v132
    v_mfma_f32_16x16x32_bf16 v[156:159], a[116:119], a[20:23], v[156:159]
    v_exp_f32 v133, v133
    v_mfma_f32_16x16x32_bf16 v[156:159], a[120:123], a[24:27], v[156:159]
    v_add_f32 v180, v180, v132
    v_add_f32 v181, v181, v133
    v_mfma_f32_16x16x32_bf16 v[156:159], a[124:127], a[28:31], v[156:159]
    ds_read_b128 a[88:91], v198 offset:12288
    ds_read_b128 a[92:95], v199 offset:12288
    v_mfma_f32_16x16x32_bf16 v[148:151], a[124:127], a[12:15], 4.0
    buffer_load_dwordx4 v219, s[24:27], s57 offen offset:3072 lds
    v_mfma_f32_16x16x32_bf16 v[148:151], a[120:123], a[8:11], v[148:151]
    v_exp_f32 v134, v134
    v_mfma_f32_16x16x32_bf16 v[148:151], a[116:119], a[4:7], v[148:151]
    v_exp_f32 v135, v135
    v_mfma_f32_16x16x32_bf16 v[148:151], a[112:115], a[0:3], v[148:151]
    v_add_f32 v180, v180, v134
    v_add_f32 v181, v181, v135
    v_mfma_f32_16x16x32_bf16 v[16:19], v[168:171], a[176:179], v[16:19]
    v_exp_f32 v144, v144
    v_mfma_f32_16x16x32_bf16 v[16:19], v[160:163], a[144:147], v[16:19]
    v_exp_f32 v145, v145
    v_mfma_f32_16x16x32_bf16 v[48:51], v[164:167], a[144:147], v[48:51]
    ds_read_b64_tr_b16 a[160:161], v200 offset:0
    v_cvt_pk_bf16_f32 v240, v128, v129
    v_mfma_f32_16x16x32_bf16 v[48:51], v[172:175], a[176:179], v[48:51]
    s_cmp_le_u32 s55, s59
    v_exp_f32 v146, v146
    v_mfma_f32_16x16x32_bf16 v[52:55], v[172:175], a[180:183], v[52:55]
    ds_read_b64_tr_b16 a[162:163], v200 offset:4096
    v_cvt_pk_bf16_f32 v241, v130, v131
    v_mfma_f32_16x16x32_bf16 v[52:55], v[164:167], a[148:151], v[52:55]
    s_cselect_b32 s26, s26, 0
    v_exp_f32 v147, v147
    v_mfma_f32_16x16x32_bf16 v[20:23], v[160:163], a[148:151], v[20:23]
    ds_read_b64_tr_b16 a[164:165], v201 offset:0
    v_cvt_pk_bf16_f32 v244, v136, v137
    v_mfma_f32_16x16x32_bf16 v[20:23], v[168:171], a[180:183], v[20:23]
    v_exp_f32 v152, v152
    v_mfma_f32_16x16x32_bf16 v[24:27], v[168:171], a[184:187], v[24:27]
    ds_read_b64_tr_b16 a[166:167], v201 offset:4096
    v_cvt_pk_bf16_f32 v245, v138, v139
    v_mfma_f32_16x16x32_bf16 v[24:27], v[160:163], a[152:155], v[24:27]
    v_exp_f32 v153, v153
    v_mfma_f32_16x16x32_bf16 v[56:59], v[164:167], a[152:155], v[56:59]
    ds_read_b64_tr_b16 a[168:169], v202 offset:0
    v_cvt_pk_bf16_f32 v246, v140, v141
    v_mfma_f32_16x16x32_bf16 v[56:59], v[172:175], a[184:187], v[56:59]
    v_exp_f32 v154, v154
    v_mfma_f32_16x16x32_bf16 v[60:63], v[172:175], a[188:191], v[60:63]
    ds_read_b64_tr_b16 a[170:171], v202 offset:4096
    v_cvt_pk_bf16_f32 v247, v142, v143
    v_mfma_f32_16x16x32_bf16 v[60:63], v[164:167], a[156:159], v[60:63]
    v_exp_f32 v155, v155
    v_mfma_f32_16x16x32_bf16 v[28:31], v[160:163], a[156:159], v[28:31]
    s_cmp_eq_u32 s55, s56
    ds_read_b64_tr_b16 a[172:173], v203 offset:0
    v_cvt_pk_bf16_f32 v242, v132, v133
    v_mfma_f32_16x16x32_bf16 v[28:31], v[168:171], a[188:191], v[28:31]
    s_waitcnt lgkmcnt(7)
    v_exp_f32 v156, v156
    v_smfmac_f32_16x16x64_bf16 v[184:187], a[192:195], v[168:175], v192
    s_cbranch_scc1 L_tail1
    v_cvt_pk_bf16_f32 v243, v134, v135
    v_mfma_f32_16x16x32_bf16 v[128:131], a[64:67], a[0:3], 4.0
    ds_read_b64_tr_b16 a[174:175], v203 offset:4096
    v_cvt_pk_bf16_f32 v168, v144, v145
    v_mfma_f32_16x16x32_bf16 v[128:131], a[68:71], a[4:7], v[128:131]
    v_exp_f32 v157, v157
    v_mfma_f32_16x16x32_bf16 v[128:131], a[72:75], a[8:11], v[128:131]
    ds_read_b64_tr_b16 a[176:177], v204 offset:0
    v_cvt_pk_bf16_f32 v169, v146, v147
    v_mfma_f32_16x16x32_bf16 v[128:131], a[76:79], a[12:15], v[128:131]
    v_exp_f32 v158, v158
    v_mfma_f32_16x16x32_bf16 v[136:139], a[76:79], a[28:31], 4.0
    ds_read_b64_tr_b16 a[178:179], v204 offset:4096
    v_cvt_pk_bf16_f32 v172, v152, v153
    v_mfma_f32_16x16x32_bf16 v[136:139], a[72:75], a[24:27], v[136:139]
    v_exp_f32 v159, v159
    v_mfma_f32_16x16x32_bf16 v[136:139], a[68:71], a[20:23], v[136:139]
    ds_read_b64_tr_b16 a[180:181], v205 offset:0
    v_cvt_pk_bf16_f32 v173, v154, v155
    v_mfma_f32_16x16x32_bf16 v[136:139], a[64:67], a[16:19], v[136:139]
    v_exp_f32 v148, v148
    v_mfma_f32_16x16x32_bf16 v[140:143], a[80:83], a[16:19], 4.0
    ds_read_b64_tr_b16 a[182:183], v205 offset:4096
    v_cvt_pk_bf16_f32 v174, v156, v157
    v_mfma_f32_16x16x32_bf16 v[140:143], a[84:87], a[20:23], v[140:143]
    v_exp_f32 v149, v149
    v_mfma_f32_16x16x32_bf16 v[140:143], a[88:91], a[24:27], v[140:143]
    ds_read_b64_tr_b16 a[184:185], v206 offset:0
    v_cvt_pk_bf16_f32 v175, v158, v159
    v_mfma_f32_16x16x32_bf16 v[140:143], a[92:95], a[28:31], v[140:143]
    v_exp_f32 v150, v150
    v_mfma_f32_16x16x32_bf16 v[132:135], a[92:95], a[12:15], 4.0
    ds_read_b64_tr_b16 a[186:187], v206 offset:4096
    v_cvt_pk_bf16_f32 v170, v148, v149
    v_mfma_f32_16x16x32_bf16 v[132:135], a[88:91], a[8:11], v[132:135]
    v_exp_f32 v151, v151
    v_mfma_f32_16x16x32_bf16 v[132:135], a[84:87], a[4:7], v[132:135]
    ds_read_b64_tr_b16 a[188:189], v207 offset:0
    v_cvt_pk_bf16_f32 v171, v150, v151
    v_mfma_f32_16x16x32_bf16 v[132:135], a[80:83], a[0:3], v[132:135]
    s_waitcnt lgkmcnt(7)
    ds_read_b64_tr_b16 a[190:191], v207 offset:4096
    v_mfma_f32_16x16x32_bf16 v[64:67], v[248:251], a[128:131], v[64:67]
    v_exp_f32 v128, v128
    v_mfma_f32_16x16x32_bf16 v[64:67], v[240:243], a[160:163], v[64:67]
    v_exp_f32 v129, v129
    v_mfma_f32_16x16x32_bf16 v[96:99], v[244:247], a[160:163], v[96:99]
    v_add_f32 v176, v176, v128
    v_add_f32 v177, v177, v129
    v_mfma_f32_16x16x32_bf16 v[96:99], v[252:255], a[128:131], v[96:99]
    v_exp_f32 v130, v130
    v_mfma_f32_16x16x32_bf16 v[100:103], v[252:255], a[132:135], v[100:103]
    v_exp_f32 v131, v131
    v_mfma_f32_16x16x32_bf16 v[100:103], v[244:247], a[164:167], v[100:103]
    v_add_f32 v176, v176, v130
    v_add_f32 v177, v177, v131
    v_mfma_f32_16x16x32_bf16 v[68:71], v[240:243], a[164:167], v[68:71]
    v_exp_f32 v136, v136
    v_mfma_f32_16x16x32_bf16 v[68:71], v[248:251], a[132:135], v[68:71]
    v_exp_f32 v137, v137
    v_mfma_f32_16x16x32_bf16 v[72:75], v[248:251], a[136:139], v[72:75]
    s_waitcnt lgkmcnt(0)
    v_add_f32 v178, v178, v136
    v_add_f32 v179, v179, v137
    v_mfma_f32_16x16x32_bf16 v[72:75], v[240:243], a[168:171], v[72:75]
    v_exp_f32_e64 v138, v138
    v_mfma_f32_16x16x32_bf16 v[104:107], v[244:247], a[168:171], v[104:107]
    s_mov_b32 m0, s66
    v_exp_f32 v139, v139
    v_mfma_f32_16x16x32_bf16 v[104:107], v[252:255], a[136:139], v[104:107]
    s_lshl_b32 s57, s58, 17
    v_add_f32 v178, v178, v138
    v_add_f32 v179, v179, v139
    v_mfma_f32_16x16x32_bf16 v[108:111], v[252:255], a[140:143], v[108:111]
    ds_read_b128 a[96:99], v196 offset:16384
    ds_read_b128 a[100:103], v197 offset:16384
    v_mfma_f32_16x16x32_bf16 v[108:111], v[244:247], a[172:175], v[108:111]
    buffer_load_dwordx4 v216, s[24:27], s57 offen offset:0 lds
    v_mfma_f32_16x16x32_bf16 v[76:79], v[240:243], a[172:175], v[76:79]
    s_add_u32 s55, s55, 8
    v_exp_f32 v140, v140
    v_mfma_f32_16x16x32_bf16 v[76:79], v[248:251], a[140:143], v[76:79]
    s_min_u32 s60, s55, s59
    v_exp_f32 v141, v141
    v_mfma_f32_16x16x32_bf16 v[144:147], a[64:67], a[32:35], 4.0
    s_load_dword s58, s[10:11], s60
    v_add_f32 v178, v178, v140
    v_add_f32 v179, v179, v141
    v_mfma_f32_16x16x32_bf16 v[144:147], a[68:71], a[36:39], v[144:147]
    ds_read_b128 a[104:107], v198 offset:16384
    ds_read_b128 a[108:111], v199 offset:16384
    v_mfma_f32_16x16x32_bf16 v[144:147], a[72:75], a[40:43], v[144:147]
    buffer_load_dwordx4 v217, s[24:27], s57 offen offset:1024 lds
    v_mfma_f32_16x16x32_bf16 v[144:147], a[76:79], a[44:47], v[144:147]
    v_exp_f32 v142, v142
    v_mfma_f32_16x16x32_bf16 v[152:155], a[76:79], a[60:63], 4.0
    v_exp_f32 v143, v143
    v_mfma_f32_16x16x32_bf16 v[152:155], a[72:75], a[56:59], v[152:155]
    v_add_f32 v178, v178, v142
    v_add_f32 v179, v179, v143
    v_mfma_f32_16x16x32_bf16 v[152:155], a[68:71], a[52:55], v[152:155]
    ds_read_b128 a[112:115], v196 offset:20480
    ds_read_b128 a[116:119], v197 offset:20480
    v_mfma_f32_16x16x32_bf16 v[152:155], a[64:67], a[48:51], v[152:155]
    buffer_load_dwordx4 v218, s[24:27], s57 offen offset:2048 lds
    v_mfma_f32_16x16x32_bf16 v[156:159], a[80:83], a[48:51], 4.0
    v_exp_f32 v132, v132
    v_mfma_f32_16x16x32_bf16 v[156:159], a[84:87], a[52:55], v[156:159]
    v_exp_f32 v133, v133
    v_mfma_f32_16x16x32_bf16 v[156:159], a[88:91], a[56:59], v[156:159]
    v_add_f32 v176, v176, v132
    v_add_f32 v177, v177, v133
    v_mfma_f32_16x16x32_bf16 v[156:159], a[92:95], a[60:63], v[156:159]
    ds_read_b128 a[120:123], v198 offset:20480
    ds_read_b128 a[124:127], v199 offset:20480
    v_mfma_f32_16x16x32_bf16 v[148:151], a[92:95], a[44:47], 4.0
    buffer_load_dwordx4 v219, s[24:27], s57 offen offset:3072 lds
    v_mfma_f32_16x16x32_bf16 v[148:151], a[88:91], a[40:43], v[148:151]
    v_exp_f32 v134, v134
    v_mfma_f32_16x16x32_bf16 v[148:151], a[84:87], a[36:39], v[148:151]
    v_exp_f32 v135, v135
    v_mfma_f32_16x16x32_bf16 v[148:151], a[80:83], a[32:35], v[148:151]
    v_add_f32 v176, v176, v134
    v_add_f32 v177, v177, v135
    v_mfma_f32_16x16x32_bf16 v[80:83], v[248:251], a[144:147], v[80:83]
    v_exp_f32 v144, v144
    v_mfma_f32_16x16x32_bf16 v[80:83], v[240:243], a[176:179], v[80:83]
    v_exp_f32 v145, v145
    v_mfma_f32_16x16x32_bf16 v[112:115], v[244:247], a[176:179], v[112:115]
    ds_read_b64_tr_b16 a[128:129], v200 offset:8192
    v_cvt_pk_bf16_f32 v160, v128, v129
    v_mfma_f32_16x16x32_bf16 v[112:115], v[252:255], a[144:147], v[112:115]
    s_cmp_le_u32 s55, s59
    v_exp_f32 v146, v146
    v_mfma_f32_16x16x32_bf16 v[116:119], v[252:255], a[148:151], v[116:119]
    ds_read_b64_tr_b16 a[130:131], v200 offset:12288
    v_cvt_pk_bf16_f32 v161, v130, v131
    v_mfma_f32_16x16x32_bf16 v[116:119], v[244:247], a[180:183], v[116:119]
    s_cselect_b32 s26, s26, 0
    v_exp_f32 v147, v147
    v_mfma_f32_16x16x32_bf16 v[84:87], v[240:243], a[180:183], v[84:87]
    ds_read_b64_tr_b16 a[132:133], v201 offset:8192
    v_cvt_pk_bf16_f32 v164, v136, v137
    v_mfma_f32_16x16x32_bf16 v[84:87], v[248:251], a[148:151], v[84:87]
    v_exp_f32 v152, v152
    v_mfma_f32_16x16x32_bf16 v[88:91], v[248:251], a[152:155], v[88:91]
    ds_read_b64_tr_b16 a[134:135], v201 offset:12288
    v_cvt_pk_bf16_f32 v165, v138, v139
    v_mfma_f32_16x16x32_bf16 v[88:91], v[240:243], a[184:187], v[88:91]
    v_exp_f32 v153, v153
    v_mfma_f32_16x16x32_bf16 v[120:123], v[244:247], a[184:187], v[120:123]
    ds_read_b64_tr_b16 a[136:137], v202 offset:8192
    v_cvt_pk_bf16_f32 v166, v140, v141
    v_mfma_f32_16x16x32_bf16 v[120:123], v[252:255], a[152:155], v[120:123]
    v_exp_f32 v154, v154
    v_mfma_f32_16x16x32_bf16 v[124:127], v[252:255], a[156:159], v[124:127]
    ds_read_b64_tr_b16 a[138:139], v202 offset:12288
    v_cvt_pk_bf16_f32 v167, v142, v143
    v_mfma_f32_16x16x32_bf16 v[124:127], v[244:247], a[188:191], v[124:127]
    v_exp_f32 v155, v155
    v_mfma_f32_16x16x32_bf16 v[92:95], v[240:243], a[188:191], v[92:95]
    s_cmp_eq_u32 s55, s56
    ds_read_b64_tr_b16 a[140:141], v203 offset:8192
    v_cvt_pk_bf16_f32 v162, v132, v133
    v_mfma_f32_16x16x32_bf16 v[92:95], v[248:251], a[156:159], v[92:95]
    s_waitcnt lgkmcnt(7)
    v_exp_f32 v156, v156
    v_smfmac_f32_16x16x64_bf16 v[188:191], a[192:195], v[248:255], v192
    s_cbranch_scc1 L_tail0
    v_cvt_pk_bf16_f32 v163, v134, v135
    v_mfma_f32_16x16x32_bf16 v[128:131], a[96:99], a[32:35], 4.0
    ds_read_b64_tr_b16 a[142:143], v203 offset:12288
    v_cvt_pk_bf16_f32 v248, v144, v145
    v_mfma_f32_16x16x32_bf16 v[128:131], a[100:103], a[36:39], v[128:131]
    v_exp_f32 v157, v157
    v_mfma_f32_16x16x32_bf16 v[128:131], a[104:107], a[40:43], v[128:131]
    ds_read_b64_tr_b16 a[144:145], v204 offset:8192
    v_cvt_pk_bf16_f32 v249, v146, v147
    v_mfma_f32_16x16x32_bf16 v[128:131], a[108:111], a[44:47], v[128:131]
    v_exp_f32 v158, v158
    v_mfma_f32_16x16x32_bf16 v[136:139], a[108:111], a[60:63], 4.0
    ds_read_b64_tr_b16 a[146:147], v204 offset:12288
    v_cvt_pk_bf16_f32 v252, v152, v153
    v_mfma_f32_16x16x32_bf16 v[136:139], a[104:107], a[56:59], v[136:139]
    v_exp_f32 v159, v159
    v_mfma_f32_16x16x32_bf16 v[136:139], a[100:103], a[52:55], v[136:139]
    ds_read_b64_tr_b16 a[148:149], v205 offset:8192
    v_cvt_pk_bf16_f32 v253, v154, v155
    v_mfma_f32_16x16x32_bf16 v[136:139], a[96:99], a[48:51], v[136:139]
    v_exp_f32 v148, v148
    v_mfma_f32_16x16x32_bf16 v[140:143], a[112:115], a[48:51], 4.0
    ds_read_b64_tr_b16 a[150:151], v205 offset:12288
    v_cvt_pk_bf16_f32 v254, v156, v157
    v_mfma_f32_16x16x32_bf16 v[140:143], a[116:119], a[52:55], v[140:143]
    v_exp_f32 v149, v149
    v_mfma_f32_16x16x32_bf16 v[140:143], a[120:123], a[56:59], v[140:143]
    ds_read_b64_tr_b16 a[152:153], v206 offset:8192
    v_cvt_pk_bf16_f32 v255, v158, v159
    v_mfma_f32_16x16x32_bf16 v[140:143], a[124:127], a[60:63], v[140:143]
    v_exp_f32 v150, v150
    v_mfma_f32_16x16x32_bf16 v[132:135], a[124:127], a[44:47], 4.0
    ds_read_b64_tr_b16 a[154:155], v206 offset:12288
    v_cvt_pk_bf16_f32 v250, v148, v149
    v_mfma_f32_16x16x32_bf16 v[132:135], a[120:123], a[40:43], v[132:135]
    v_exp_f32 v151, v151
    v_mfma_f32_16x16x32_bf16 v[132:135], a[116:119], a[36:39], v[132:135]
    ds_read_b64_tr_b16 a[156:157], v207 offset:8192
    v_cvt_pk_bf16_f32 v251, v150, v151
    v_mfma_f32_16x16x32_bf16 v[132:135], a[112:115], a[32:35], v[132:135]
    s_waitcnt lgkmcnt(7)
    ds_read_b64_tr_b16 a[158:159], v207 offset:12288
    v_mfma_f32_16x16x32_bf16 v[0:3], v[168:171], a[160:163], v[0:3]
    v_exp_f32 v128, v128
    v_mfma_f32_16x16x32_bf16 v[0:3], v[160:163], a[128:131], v[0:3]
    v_exp_f32 v129, v129
    v_mfma_f32_16x16x32_bf16 v[32:35], v[164:167], a[128:131], v[32:35]
    v_add_f32 v180, v180, v128
    v_add_f32 v181, v181, v129
    v_mfma_f32_16x16x32_bf16 v[32:35], v[172:175], a[160:163], v[32:35]
    v_exp_f32 v130, v130
    v_mfma_f32_16x16x32_bf16 v[36:39], v[172:175], a[164:167], v[36:39]
    v_exp_f32 v131, v131
    v_mfma_f32_16x16x32_bf16 v[36:39], v[164:167], a[132:135], v[36:39]
    v_add_f32 v180, v180, v130
    v_add_f32 v181, v181, v131
    v_mfma_f32_16x16x32_bf16 v[4:7], v[160:163], a[132:135], v[4:7]
L_hop2:
    s_cbranch_vccnz L_hop2_1
    v_exp_f32 v136, v136
    v_mfma_f32_16x16x32_bf16 v[4:7], v[168:171], a[164:167], v[4:7]
    v_exp_f32 v137, v137
    v_mfma_f32_16x16x32_bf16 v[8:11], v[168:171], a[168:171], v[8:11]
    s_waitcnt vmcnt(4) lgkmcnt(0)
    v_add_f32 v182, v182, v136
    v_add_f32 v183, v183, v137
    v_mfma_f32_16x16x32_bf16 v[8:11], v[160:163], a[136:139], v[8:11]
    s_barrier
    v_exp_f32 v138, v138
    v_mfma_f32_16x16x32_bf16 v[40:43], v[164:167], a[136:139], v[40:43]
    s_mov_b32 m0, s67
    v_exp_f32 v139, v139
    v_mfma_f32_16x16x32_bf16 v[40:43], v[172:175], a[168:171], v[40:43]
    s_lshl_b32 s57, s58, 17
    v_add_f32 v182, v182, v138
    v_add_f32 v183, v183, v139
    v_mfma_f32_16x16x32_bf16 v[44:47], v[172:175], a[172:175], v[44:47]
    ds_read_b128 a[64:67], v196 offset:24576
    ds_read_b128 a[68:71], v197 offset:24576
    v_mfma_f32_16x16x32_bf16 v[44:47], v[164:167], a[140:143], v[44:47]
    buffer_load_dwordx4 v216, s[24:27], s57 offen offset:0 lds
    v_mfma_f32_16x16x32_bf16 v[12:15], v[160:163], a[140:143], v[12:15]
    s_add_u32 s55, s55, 8
    v_exp_f32 v140, v140
    v_mfma_f32_16x16x32_bf16 v[12:15], v[168:171], a[172:175], v[12:15]
    s_min_u32 s60, s55, s59
    v_exp_f32 v141, v141
    v_mfma_f32_16x16x32_bf16 v[144:147], a[96:99], a[0:3], 4.0
    s_load_dword s58, s[10:11], s60
    v_add_f32 v182, v182, v140
    v_add_f32 v183, v183, v141
    v_mfma_f32_16x16x32_bf16 v[144:147], a[100:103], a[4:7], v[144:147]
    ds_read_b128 a[72:75], v198 offset:24576
    ds_read_b128 a[76:79], v199 offset:24576
    v_mfma_f32_16x16x32_bf16 v[144:147], a[104:107], a[8:11], v[144:147]
    buffer_load_dwordx4 v217, s[24:27], s57 offen offset:1024 lds
    v_mfma_f32_16x16x32_bf16 v[144:147], a[108:111], a[12:15], v[144:147]
    v_exp_f32 v142, v142
    v_mfma_f32_16x16x32_bf16 v[152:155], a[108:111], a[28:31], 4.0
    v_exp_f32 v143, v143
    v_mfma_f32_16x16x32_bf16 v[152:155], a[104:107], a[24:27], v[152:155]
    v_add_f32 v182, v182, v142
    v_add_f32 v183, v183, v143
    v_mfma_f32_16x16x32_bf16 v[152:155], a[100:103], a[20:23], v[152:155]
    ds_read_b128 a[80:83], v196 offset:28672
    ds_read_b128 a[84:87], v197 offset:28672
    v_mfma_f32_16x16x32_bf16 v[152:155], a[96:99], a[16:19], v[152:155]
    buffer_load_dwordx4 v218, s[24:27], s57 offen offset:2048 lds
    v_mfma_f32_16x16x32_bf16 v[156:159], a[112:115], a[16:19], 4.0
    v_exp_f32 v132, v132
    v_mfma_f32_16x16x32_bf16 v[156:159], a[116:119], a[20:23], v[156:159]
    v_exp_f32 v133, v133
    v_mfma_f32_16x16x32_bf16 v[156:159], a[120:123], a[24:27], v[156:159]
    v_add_f32 v180, v180, v132
    v_add_f32 v181, v181, v133
    v_mfma_f32_16x16x32_bf16 v[156:159], a[124:127], a[28:31], v[156:159]
    ds_read_b128 a[88:91], v198 offset:28672
    ds_read_b128 a[92:95], v199 offset:28672
    v_mfma_f32_16x16x32_bf16 v[148:151], a[124:127], a[12:15], 4.0
    buffer_load_dwordx4 v219, s[24:27], s57 offen offset:3072 lds
    v_mfma_f32_16x16x32_bf16 v[148:151], a[120:123], a[8:11], v[148:151]
    v_exp_f32 v134, v134
    v_mfma_f32_16x16x32_bf16 v[148:151], a[116:119], a[4:7], v[148:151]
    v_exp_f32 v135, v135
    v_mfma_f32_16x16x32_bf16 v[148:151], a[112:115], a[0:3], v[148:151]
    v_add_f32 v180, v180, v134
    v_add_f32 v181, v181, v135
    v_mfma_f32_16x16x32_bf16 v[16:19], v[168:171], a[176:179], v[16:19]
    v_exp_f32 v144, v144
    v_mfma_f32_16x16x32_bf16 v[16:19], v[160:163], a[144:147], v[16:19]
    v_exp_f32 v145, v145
    v_mfma_f32_16x16x32_bf16 v[48:51], v[164:167], a[144:147], v[48:51]
    ds_read_b64_tr_b16 a[160:161], v200 offset:16384
    v_cvt_pk_bf16_f32 v240, v128, v129
    v_mfma_f32_16x16x32_bf16 v[48:51], v[172:175], a[176:179], v[48:51]
    s_cmp_le_u32 s55, s59
    v_exp_f32 v146, v146
    v_mfma_f32_16x16x32_bf16 v[52:55], v[172:175], a[180:183], v[52:55]
    ds_read_b64_tr_b16 a[162:163], v200 offset:20480
    v_cvt_pk_bf16_f32 v241, v130, v131
    v_mfma_f32_16x16x32_bf16 v[52:55], v[164:167], a[148:151], v[52:55]
    s_cselect_b32 s26, s26, 0
    v_exp_f32 v147, v147
    v_mfma_f32_16x16x32_bf16 v[20:23], v[160:163], a[148:151], v[20:23]
    ds_read_b64_tr_b16 a[164:165], v201 offset:16384
    v_cvt_pk_bf16_f32 v244, v136, v137
    v_mfma_f32_16x16x32_bf16 v[20:23], v[168:171], a[180:183], v[20:23]
    v_exp_f32 v152, v152
    v_mfma_f32_16x16x32_bf16 v[24:27], v[168:171], a[184:187], v[24:27]
    ds_read_b64_tr_b16 a[166:167], v201 offset:20480
    v_cvt_pk_bf16_f32 v245, v138, v139
    v_mfma_f32_16x16x32_bf16 v[24:27], v[160:163], a[152:155], v[24:27]
    v_exp_f32 v153, v153
    v_mfma_f32_16x16x32_bf16 v[56:59], v[164:167], a[152:155], v[56:59]
    ds_read_b64_tr_b16 a[168:169], v202 offset:16384
    v_cvt_pk_bf16_f32 v246, v140, v141
    v_mfma_f32_16x16x32_bf16 v[56:59], v[172:175], a[184:187], v[56:59]
    v_exp_f32 v154, v154
    v_mfma_f32_16x16x32_bf16 v[60:63], v[172:175], a[188:191], v[60:63]
    ds_read_b64_tr_b16 a[170:171], v202 offset:20480
    v_cvt_pk_bf16_f32 v247, v142, v143
    v_mfma_f32_16x16x32_bf16 v[60:63], v[164:167], a[156:159], v[60:63]
    v_exp_f32 v155, v155
    v_mfma_f32_16x16x32_bf16 v[28:31], v[160:163], a[156:159], v[28:31]
    s_cmp_eq_u32 s55, s56
    ds_read_b64_tr_b16 a[172:173], v203 offset:16384
    v_cvt_pk_bf16_f32 v242, v132, v133
    v_mfma_f32_16x16x32_bf16 v[28:31], v[168:171], a[188:191], v[28:31]
    s_waitcnt lgkmcnt(7)
    v_exp_f32 v156, v156
    v_smfmac_f32_16x16x64_bf16 v[184:187], a[192:195], v[168:175], v192
    s_cbranch_scc1 L_tail1
    v_cvt_pk_bf16_f32 v243, v134, v135
    v_mfma_f32_16x16x32_bf16 v[128:131], a[64:67], a[0:3], 4.0
    ds_read_b64_tr_b16 a[174:175], v203 offset:20480
    v_cvt_pk_bf16_f32 v168, v144, v145
    v_mfma_f32_16x16x32_bf16 v[128:131], a[68:71], a[4:7], v[128:131]
    v_exp_f32 v157, v157
    v_mfma_f32_16x16x32_bf16 v[128:131], a[72:75], a[8:11], v[128:131]
    ds_read_b64_tr_b16 a[176:177], v204 offset:16384
    v_cvt_pk_bf16_f32 v169, v146, v147
    v_mfma_f32_16x16x32_bf16 v[128:131], a[76:79], a[12:15], v[128:131]
    v_exp_f32 v158, v158
    v_mfma_f32_16x16x32_bf16 v[136:139], a[76:79], a[28:31], 4.0
    ds_read_b64_tr_b16 a[178:179], v204 offset:20480
    v_cvt_pk_bf16_f32 v172, v152, v153
    v_mfma_f32_16x16x32_bf16 v[136:139], a[72:75], a[24:27], v[136:139]
    v_exp_f32 v159, v159
    v_mfma_f32_16x16x32_bf16 v[136:139], a[68:71], a[20:23], v[136:139]
    ds_read_b64_tr_b16 a[180:181], v205 offset:16384
    v_cvt_pk_bf16_f32 v173, v154, v155
    v_mfma_f32_16x16x32_bf16 v[136:139], a[64:67], a[16:19], v[136:139]
    v_exp_f32 v148, v148
    v_mfma_f32_16x16x32_bf16 v[140:143], a[80:83], a[16:19], 4.0
    ds_read_b64_tr_b16 a[182:183], v205 offset:20480
    v_cvt_pk_bf16_f32 v174, v156, v157
    v_mfma_f32_16x16x32_bf16 v[140:143], a[84:87], a[20:23], v[140:143]
    v_exp_f32 v149, v149
    v_mfma_f32_16x16x32_bf16 v[140:143], a[88:91], a[24:27], v[140:143]
    ds_read_b64_tr_b16 a[184:185], v206 offset:16384
    v_cvt_pk_bf16_f32 v175, v158, v159
    v_mfma_f32_16x16x32_bf16 v[140:143], a[92:95], a[28:31], v[140:143]
    v_exp_f32 v150, v150
    v_mfma_f32_16x16x32_bf16 v[132:135], a[92:95], a[12:15], 4.0
    ds_read_b64_tr_b16 a[186:187], v206 offset:20480
    v_cvt_pk_bf16_f32 v170, v148, v149
    v_mfma_f32_16x16x32_bf16 v[132:135], a[88:91], a[8:11], v[132:135]
    v_exp_f32 v151, v151
    v_mfma_f32_16x16x32_bf16 v[132:135], a[84:87], a[4:7], v[132:135]
    ds_read_b64_tr_b16 a[188:189], v207 offset:16384
    v_cvt_pk_bf16_f32 v171, v150, v151
    v_mfma_f32_16x16x32_bf16 v[132:135], a[80:83], a[0:3], v[132:135]
    s_waitcnt lgkmcnt(7)
    ds_read_b64_tr_b16 a[190:191], v207 offset:20480
    v_mfma_f32_16x16x32_bf16 v[64:67], v[248:251], a[128:131], v[64:67]
    v_exp_f32 v128, v128
    v_mfma_f32_16x16x32_bf16 v[64:67], v[240:243], a[160:163], v[64:67]
    v_exp_f32 v129, v129
    v_mfma_f32_16x16x32_bf16 v[96:99], v[244:247], a[160:163], v[96:99]
    v_add_f32 v176, v176, v128
    v_add_f32 v177, v177, v129
    v_mfma_f32_16x16x32_bf16 v[96:99], v[252:255], a[128:131], v[96:99]
    v_exp_f32 v130, v130
    v_mfma_f32_16x16x32_bf16 v[100:103], v[252:255], a[132:135], v[100:103]
    v_exp_f32 v131, v131
    v_mfma_f32_16x16x32_bf16 v[100:103], v[244:247], a[164:167], v[100:103]
    v_add_f32 v176, v176, v130
    v_add_f32 v177, v177, v131
    v_mfma_f32_16x16x32_bf16 v[68:71], v[240:243], a[164:167], v[68:71]
    v_exp_f32 v136, v136
    v_mfma_f32_16x16x32_bf16 v[68:71], v[248:251], a[132:135], v[68:71]
    v_exp_f32 v137, v137
    v_mfma_f32_16x16x32_bf16 v[72:75], v[248:251], a[136:139], v[72:75]
    s_waitcnt lgkmcnt(0)
    v_add_f32 v178, v178, v136
    v_add_f32 v179, v179, v137
    v_mfma_f32_16x16x32_bf16 v[72:75], v[240:243], a[168:171], v[72:75]
    v_exp_f32 v138, v138
    v_mfma_f32_16x16x32_bf16 v[104:107], v[244:247], a[168:171], v[104:107]
    s_mov_b32 m0, s68
    v_exp_f32 v139, v139
    v_mfma_f32_16x16x32_bf16 v[104:107], v[252:255], a[136:139], v[104:107]
    s_lshl_b32 s57, s58, 17
    v_add_f32 v178, v178, v138
    v_add_f32 v179, v179, v139
    v_mfma_f32_16x16x32_bf16 v[108:111], v[252:255], a[140:143], v[108:111]
    ds_read_b128 a[96:99], v196 offset:32768
    ds_read_b128 a[100:103], v197 offset:32768
    v_mfma_f32_16x16x32_bf16 v[108:111], v[244:247], a[172:175], v[108:111]
    buffer_load_dwordx4 v216, s[24:27], s57 offen offset:0 lds
    v_mfma_f32_16x16x32_bf16 v[76:79], v[240:243], a[172:175], v[76:79]
    s_add_u32 s55, s55, 8
    v_exp_f32 v140, v140
    v_mfma_f32_16x16x32_bf16 v[76:79], v[248:251], a[140:143], v[76:79]
    s_min_u32 s60, s55, s59
    v_exp_f32 v141, v141
    v_mfma_f32_16x16x32_bf16 v[144:147], a[64:67], a[32:35], 4.0
    s_load_dword s58, s[10:11], s60
    v_add_f32 v178, v178, v140
    v_add_f32 v179, v179, v141
    v_mfma_f32_16x16x32_bf16 v[144:147], a[68:71], a[36:39], v[144:147]
    ds_read_b128 a[104:107], v198 offset:32768
    ds_read_b128 a[108:111], v199 offset:32768
    v_mfma_f32_16x16x32_bf16 v[144:147], a[72:75], a[40:43], v[144:147]
    buffer_load_dwordx4 v217, s[24:27], s57 offen offset:1024 lds
    v_mfma_f32_16x16x32_bf16 v[144:147], a[76:79], a[44:47], v[144:147]
    v_exp_f32 v142, v142
    v_mfma_f32_16x16x32_bf16 v[152:155], a[76:79], a[60:63], 4.0
    v_exp_f32 v143, v143
    v_mfma_f32_16x16x32_bf16 v[152:155], a[72:75], a[56:59], v[152:155]
    v_add_f32 v178, v178, v142
    v_add_f32 v179, v179, v143
    v_mfma_f32_16x16x32_bf16 v[152:155], a[68:71], a[52:55], v[152:155]
    ds_read_b128 a[112:115], v196 offset:36864
    ds_read_b128 a[116:119], v197 offset:36864
    v_mfma_f32_16x16x32_bf16 v[152:155], a[64:67], a[48:51], v[152:155]
    buffer_load_dwordx4 v218, s[24:27], s57 offen offset:2048 lds
    v_mfma_f32_16x16x32_bf16 v[156:159], a[80:83], a[48:51], 4.0
    v_exp_f32 v132, v132
    v_mfma_f32_16x16x32_bf16 v[156:159], a[84:87], a[52:55], v[156:159]
    v_exp_f32 v133, v133
    v_mfma_f32_16x16x32_bf16 v[156:159], a[88:91], a[56:59], v[156:159]
    v_add_f32 v176, v176, v132
    v_add_f32 v177, v177, v133
    v_mfma_f32_16x16x32_bf16 v[156:159], a[92:95], a[60:63], v[156:159]
    ds_read_b128 a[120:123], v198 offset:36864
    ds_read_b128 a[124:127], v199 offset:36864
    v_mfma_f32_16x16x32_bf16 v[148:151], a[92:95], a[44:47], 4.0
    buffer_load_dwordx4 v219, s[24:27], s57 offen offset:3072 lds
    v_mfma_f32_16x16x32_bf16 v[148:151], a[88:91], a[40:43], v[148:151]
    v_exp_f32 v134, v134
    v_mfma_f32_16x16x32_bf16 v[148:151], a[84:87], a[36:39], v[148:151]
    v_exp_f32 v135, v135
    v_mfma_f32_16x16x32_bf16 v[148:151], a[80:83], a[32:35], v[148:151]
    v_add_f32 v176, v176, v134
    v_add_f32 v177, v177, v135
    v_mfma_f32_16x16x32_bf16 v[80:83], v[248:251], a[144:147], v[80:83]
    v_exp_f32 v144, v144
    v_mfma_f32_16x16x32_bf16 v[80:83], v[240:243], a[176:179], v[80:83]
    v_exp_f32 v145, v145
    v_mfma_f32_16x16x32_bf16 v[112:115], v[244:247], a[176:179], v[112:115]
    ds_read_b64_tr_b16 a[128:129], v200 offset:24576
    v_cvt_pk_bf16_f32 v160, v128, v129
    v_mfma_f32_16x16x32_bf16 v[112:115], v[252:255], a[144:147], v[112:115]
    s_cmp_le_u32 s55, s59
    v_exp_f32 v146, v146
    v_mfma_f32_16x16x32_bf16 v[116:119], v[252:255], a[148:151], v[116:119]
    ds_read_b64_tr_b16 a[130:131], v200 offset:28672
    v_cvt_pk_bf16_f32 v161, v130, v131
    v_mfma_f32_16x16x32_bf16 v[116:119], v[244:247], a[180:183], v[116:119]
    s_cselect_b32 s26, s26, 0
    v_exp_f32 v147, v147
    v_mfma_f32_16x16x32_bf16 v[84:87], v[240:243], a[180:183], v[84:87]
    ds_read_b64_tr_b16 a[132:133], v201 offset:24576
    v_cvt_pk_bf16_f32 v164, v136, v137
    v_mfma_f32_16x16x32_bf16 v[84:87], v[248:251], a[148:151], v[84:87]
    v_exp_f32 v152, v152
    v_mfma_f32_16x16x32_bf16 v[88:91], v[248:251], a[152:155], v[88:91]
    ds_read_b64_tr_b16 a[134:135], v201 offset:28672
    v_cvt_pk_bf16_f32 v165, v138, v139
    v_mfma_f32_16x16x32_bf16 v[88:91], v[240:243], a[184:187], v[88:91]
    v_exp_f32 v153, v153
    v_mfma_f32_16x16x32_bf16 v[120:123], v[244:247], a[184:187], v[120:123]
    ds_read_b64_tr_b16 a[136:137], v202 offset:24576
    v_cvt_pk_bf16_f32 v166, v140, v141
    v_mfma_f32_16x16x32_bf16 v[120:123], v[252:255], a[152:155], v[120:123]
    v_exp_f32 v154, v154
    v_mfma_f32_16x16x32_bf16 v[124:127], v[252:255], a[156:159], v[124:127]
    ds_read_b64_tr_b16 a[138:139], v202 offset:28672
    v_cvt_pk_bf16_f32 v167, v142, v143
    v_mfma_f32_16x16x32_bf16 v[124:127], v[244:247], a[188:191], v[124:127]
    v_exp_f32 v155, v155
    v_mfma_f32_16x16x32_bf16 v[92:95], v[240:243], a[188:191], v[92:95]
    s_cmp_eq_u32 s55, s56
    ds_read_b64_tr_b16 a[140:141], v203 offset:24576
    v_cvt_pk_bf16_f32 v162, v132, v133
    v_mfma_f32_16x16x32_bf16 v[92:95], v[248:251], a[156:159], v[92:95]
    s_waitcnt lgkmcnt(7)
    v_exp_f32 v156, v156
    v_smfmac_f32_16x16x64_bf16 v[188:191], a[192:195], v[248:255], v192
    s_cbranch_scc1 L_tail0
    v_cvt_pk_bf16_f32 v163, v134, v135
    v_mfma_f32_16x16x32_bf16 v[128:131], a[96:99], a[32:35], 4.0
    ds_read_b64_tr_b16 a[142:143], v203 offset:28672
    v_cvt_pk_bf16_f32 v248, v144, v145
    v_mfma_f32_16x16x32_bf16 v[128:131], a[100:103], a[36:39], v[128:131]
    v_exp_f32 v157, v157
    v_mfma_f32_16x16x32_bf16 v[128:131], a[104:107], a[40:43], v[128:131]
    ds_read_b64_tr_b16 a[144:145], v204 offset:24576
    v_cvt_pk_bf16_f32 v249, v146, v147
    v_mfma_f32_16x16x32_bf16 v[128:131], a[108:111], a[44:47], v[128:131]
    v_exp_f32 v158, v158
    v_mfma_f32_16x16x32_bf16 v[136:139], a[108:111], a[60:63], 4.0
    ds_read_b64_tr_b16 a[146:147], v204 offset:28672
    v_cvt_pk_bf16_f32 v252, v152, v153
    v_mfma_f32_16x16x32_bf16 v[136:139], a[104:107], a[56:59], v[136:139]
    v_exp_f32 v159, v159
    v_mfma_f32_16x16x32_bf16 v[136:139], a[100:103], a[52:55], v[136:139]
    ds_read_b64_tr_b16 a[148:149], v205 offset:24576
    v_cvt_pk_bf16_f32 v253, v154, v155
    v_mfma_f32_16x16x32_bf16 v[136:139], a[96:99], a[48:51], v[136:139]
    v_exp_f32 v148, v148
    v_mfma_f32_16x16x32_bf16 v[140:143], a[112:115], a[48:51], 4.0
    ds_read_b64_tr_b16 a[150:151], v205 offset:28672
    v_cvt_pk_bf16_f32 v254, v156, v157
    v_mfma_f32_16x16x32_bf16 v[140:143], a[116:119], a[52:55], v[140:143]
    v_exp_f32 v149, v149
    v_mfma_f32_16x16x32_bf16 v[140:143], a[120:123], a[56:59], v[140:143]
    ds_read_b64_tr_b16 a[152:153], v206 offset:24576
    v_cvt_pk_bf16_f32 v255, v158, v159
    v_mfma_f32_16x16x32_bf16 v[140:143], a[124:127], a[60:63], v[140:143]
    v_exp_f32 v150, v150
    v_mfma_f32_16x16x32_bf16 v[132:135], a[124:127], a[44:47], 4.0
    ds_read_b64_tr_b16 a[154:155], v206 offset:28672
    v_cvt_pk_bf16_f32 v250, v148, v149
    v_mfma_f32_16x16x32_bf16 v[132:135], a[120:123], a[40:43], v[132:135]
    v_exp_f32 v151, v151
    v_mfma_f32_16x16x32_bf16 v[132:135], a[116:119], a[36:39], v[132:135]
    ds_read_b64_tr_b16 a[156:157], v207 offset:24576
    v_cvt_pk_bf16_f32 v251, v150, v151
    v_mfma_f32_16x16x32_bf16 v[132:135], a[112:115], a[32:35], v[132:135]
    s_waitcnt lgkmcnt(7)
    ds_read_b64_tr_b16 a[158:159], v207 offset:28672
    v_mfma_f32_16x16x32_bf16 v[0:3], v[168:171], a[160:163], v[0:3]
    v_exp_f32 v128, v128
    v_mfma_f32_16x16x32_bf16 v[0:3], v[160:163], a[128:131], v[0:3]
    v_exp_f32 v129, v129
    v_mfma_f32_16x16x32_bf16 v[32:35], v[164:167], a[128:131], v[32:35]
    v_add_f32 v180, v180, v128
    v_add_f32 v181, v181, v129
    v_mfma_f32_16x16x32_bf16 v[32:35], v[172:175], a[160:163], v[32:35]
    v_exp_f32 v130, v130
    v_mfma_f32_16x16x32_bf16 v[36:39], v[172:175], a[164:167], v[36:39]
    v_exp_f32 v131, v131
    v_mfma_f32_16x16x32_bf16 v[36:39], v[164:167], a[132:135], v[36:39]
    v_add_f32 v180, v180, v130
    v_add_f32 v181, v181, v131
    v_mfma_f32_16x16x32_bf16 v[4:7], v[160:163], a[132:135], v[4:7]
    v_exp_f32 v136, v136
    v_mfma_f32_16x16x32_bf16 v[4:7], v[168:171], a[164:167], v[4:7]
    v_exp_f32 v137, v137
    v_mfma_f32_16x16x32_bf16 v[8:11], v[168:171], a[168:171], v[8:11]
    s_waitcnt vmcnt(4) lgkmcnt(0)
    v_add_f32 v182, v182, v136
    v_add_f32 v183, v183, v137
    v_mfma_f32_16x16x32_bf16 v[8:11], v[160:163], a[136:139], v[8:11]
    s_barrier
    v_exp_f32 v138, v138
    v_mfma_f32_16x16x32_bf16 v[40:43], v[164:167], a[136:139], v[40:43]
    s_mov_b32 m0, s69
    v_exp_f32 v139, v139
    v_mfma_f32_16x16x32_bf16 v[40:43], v[172:175], a[168:171], v[40:43]
    s_lshl_b32 s57, s58, 17
    v_add_f32 v182, v182, v138
    v_add_f32 v183, v183, v139
    v_mfma_f32_16x16x32_bf16 v[44:47], v[172:175], a[172:175], v[44:47]
    ds_read_b128 a[64:67], v196 offset:0
    ds_read_b128 a[68:71], v197 offset:0
    v_mfma_f32_16x16x32_bf16 v[44:47], v[164:167], a[140:143], v[44:47]
    buffer_load_dwordx4 v216, s[24:27], s57 offen offset:0 lds
    v_mfma_f32_16x16x32_bf16 v[12:15], v[160:163], a[140:143], v[12:15]
    s_add_u32 s55, s55, 8
    v_exp_f32 v140, v140
    v_mfma_f32_16x16x32_bf16 v[12:15], v[168:171], a[172:175], v[12:15]
    s_min_u32 s60, s55, s59
    v_exp_f32 v141, v141
    v_mfma_f32_16x16x32_bf16 v[144:147], a[96:99], a[0:3], 4.0
    s_load_dword s58, s[10:11], s60
    v_add_f32 v182, v182, v140
    v_add_f32 v183, v183, v141
    v_mfma_f32_16x16x32_bf16 v[144:147], a[100:103], a[4:7], v[144:147]
    ds_read_b128 a[72:75], v198 offset:0
    ds_read_b128 a[76:79], v199 offset:0
    v_mfma_f32_16x16x32_bf16 v[144:147], a[104:107], a[8:11], v[144:147]
    buffer_load_dwordx4 v217, s[24:27], s57 offen offset:1024 lds
    v_mfma_f32_16x16x32_bf16 v[144:147], a[108:111], a[12:15], v[144:147]
    v_exp_f32 v142, v142
    v_mfma_f32_16x16x32_bf16 v[152:155], a[108:111], a[28:31], 4.0
    v_exp_f32 v143, v143
    v_mfma_f32_16x16x32_bf16 v[152:155], a[104:107], a[24:27], v[152:155]
    v_add_f32 v182, v182, v142
    v_add_f32 v183, v183, v143
    v_mfma_f32_16x16x32_bf16 v[152:155], a[100:103], a[20:23], v[152:155]
    ds_read_b128 a[80:83], v196 offset:4096
    ds_read_b128 a[84:87], v197 offset:4096
    v_mfma_f32_16x16x32_bf16 v[152:155], a[96:99], a[16:19], v[152:155]
    buffer_load_dwordx4 v218, s[24:27], s57 offen offset:2048 lds
    v_mfma_f32_16x16x32_bf16 v[156:159], a[112:115], a[16:19], 4.0
    v_exp_f32 v132, v132
    v_mfma_f32_16x16x32_bf16 v[156:159], a[116:119], a[20:23], v[156:159]
    v_exp_f32 v133, v133
    v_mfma_f32_16x16x32_bf16 v[156:159], a[120:123], a[24:27], v[156:159]
    v_add_f32 v180, v180, v132
    v_add_f32 v181, v181, v133
    v_mfma_f32_16x16x32_bf16 v[156:159], a[124:127], a[28:31], v[156:159]
    ds_read_b128 a[88:91], v198 offset:4096
    ds_read_b128 a[92:95], v199 offset:4096
    v_mfma_f32_16x16x32_bf16 v[148:151], a[124:127], a[12:15], 4.0
    buffer_load_dwordx4 v219, s[24:27], s57 offen offset:3072 lds
    v_mfma_f32_16x16x32_bf16 v[148:151], a[120:123], a[8:11], v[148:151]
    v_exp_f32 v134, v134
    v_mfma_f32_16x16x32_bf16 v[148:151], a[116:119], a[4:7], v[148:151]
    v_exp_f32 v135, v135
    v_mfma_f32_16x16x32_bf16 v[148:151], a[112:115], a[0:3], v[148:151]
    v_add_f32 v180, v180, v134
    v_add_f32 v181, v181, v135
    v_mfma_f32_16x16x32_bf16 v[16:19], v[168:171], a[176:179], v[16:19]
    v_exp_f32 v144, v144
    v_mfma_f32_16x16x32_bf16 v[16:19], v[160:163], a[144:147], v[16:19]
    v_exp_f32 v145, v145
    v_mfma_f32_16x16x32_bf16 v[48:51], v[164:167], a[144:147], v[48:51]
    ds_read_b64_tr_b16 a[160:161], v200 offset:32768
    v_cvt_pk_bf16_f32 v240, v128, v129
    v_mfma_f32_16x16x32_bf16 v[48:51], v[172:175], a[176:179], v[48:51]
    s_cmp_le_u32 s55, s59
    v_exp_f32 v146, v146
    v_mfma_f32_16x16x32_bf16 v[52:55], v[172:175], a[180:183], v[52:55]
    ds_read_b64_tr_b16 a[162:163], v200 offset:36864
    v_cvt_pk_bf16_f32 v241, v130, v131
    v_mfma_f32_16x16x32_bf16 v[52:55], v[164:167], a[148:151], v[52:55]
    s_cselect_b32 s26, s26, 0
    v_exp_f32 v147, v147
    v_mfma_f32_16x16x32_bf16 v[20:23], v[160:163], a[148:151], v[20:23]
    ds_read_b64_tr_b16 a[164:165], v201 offset:32768
    v_cvt_pk_bf16_f32 v244, v136, v137
    v_mfma_f32_16x16x32_bf16 v[20:23], v[168:171], a[180:183], v[20:23]
    v_exp_f32 v152, v152
    v_mfma_f32_16x16x32_bf16 v[24:27], v[168:171], a[184:187], v[24:27]
    ds_read_b64_tr_b16 a[166:167], v201 offset:36864
    v_cvt_pk_bf16_f32 v245, v138, v139
    v_mfma_f32_16x16x32_bf16 v[24:27], v[160:163], a[152:155], v[24:27]
    v_exp_f32 v153, v153
    v_mfma_f32_16x16x32_bf16 v[56:59], v[164:167], a[152:155], v[56:59]
    ds_read_b64_tr_b16 a[168:169], v202 offset:32768
    v_cvt_pk_bf16_f32 v246, v140, v141
    v_mfma_f32_16x16x32_bf16 v[56:59], v[172:175], a[184:187], v[56:59]
    v_exp_f32 v154, v154
    v_mfma_f32_16x16x32_bf16 v[60:63], v[172:175], a[188:191], v[60:63]
    ds_read_b64_tr_b16 a[170:171], v202 offset:36864
    v_cvt_pk_bf16_f32 v247, v142, v143
    v_mfma_f32_16x16x32_bf16 v[60:63], v[164:167], a[156:159], v[60:63]
    v_exp_f32 v155, v155
    v_mfma_f32_16x16x32_bf16 v[28:31], v[160:163], a[156:159], v[28:31]
    s_cmp_eq_u32 s55, s56
    ds_read_b64_tr_b16 a[172:173], v203 offset:32768
    v_cvt_pk_bf16_f32 v242, v132, v133
    v_mfma_f32_16x16x32_bf16 v[28:31], v[168:171], a[188:191], v[28:31]
    s_waitcnt lgkmcnt(7)
    v_exp_f32 v156, v156
    v_smfmac_f32_16x16x64_bf16 v[184:187], a[192:195], v[168:175], v192
    s_cbranch_scc1 L_tail1
    v_cvt_pk_bf16_f32 v243, v134, v135
    v_mfma_f32_16x16x32_bf16 v[128:131], a[64:67], a[0:3], 4.0
    ds_read_b64_tr_b16 a[174:175], v203 offset:36864
    v_cvt_pk_bf16_f32 v168, v144, v145
    v_mfma_f32_16x16x32_bf16 v[128:131], a[68:71], a[4:7], v[128:131]
    v_exp_f32 v157, v157
    v_mfma_f32_16x16x32_bf16 v[128:131], a[72:75], a[8:11], v[128:131]
    ds_read_b64_tr_b16 a[176:177], v204 offset:32768
    v_cvt_pk_bf16_f32 v169, v146, v147
    v_mfma_f32_16x16x32_bf16 v[128:131], a[76:79], a[12:15], v[128:131]
    v_exp_f32 v158, v158
    v_mfma_f32_16x16x32_bf16 v[136:139], a[76:79], a[28:31], 4.0
    ds_read_b64_tr_b16 a[178:179], v204 offset:36864
    v_cvt_pk_bf16_f32 v172, v152, v153
    v_mfma_f32_16x16x32_bf16 v[136:139], a[72:75], a[24:27], v[136:139]
    v_exp_f32 v159, v159
    v_mfma_f32_16x16x32_bf16 v[136:139], a[68:71], a[20:23], v[136:139]
    ds_read_b64_tr_b16 a[180:181], v205 offset:32768
    v_cvt_pk_bf16_f32 v173, v154, v155
    v_mfma_f32_16x16x32_bf16 v[136:139], a[64:67], a[16:19], v[136:139]
    v_exp_f32 v148, v148
    v_mfma_f32_16x16x32_bf16 v[140:143], a[80:83], a[16:19], 4.0
    ds_read_b64_tr_b16 a[182:183], v205 offset:36864
    v_cvt_pk_bf16_f32 v174, v156, v157
    v_mfma_f32_16x16x32_bf16 v[140:143], a[84:87], a[20:23], v[140:143]
    v_exp_f32 v149, v149
    v_mfma_f32_16x16x32_bf16 v[140:143], a[88:91], a[24:27], v[140:143]
    ds_read_b64_tr_b16 a[184:185], v206 offset:32768
    v_cvt_pk_bf16_f32 v175, v158, v159
    v_mfma_f32_16x16x32_bf16 v[140:143], a[92:95], a[28:31], v[140:143]
    v_exp_f32 v150, v150
    v_mfma_f32_16x16x32_bf16 v[132:135], a[92:95], a[12:15], 4.0
    ds_read_b64_tr_b16 a[186:187], v206 offset:36864
    v_cvt_pk_bf16_f32 v170, v148, v149
    v_mfma_f32_16x16x32_bf16 v[132:135], a[88:91], a[8:11], v[132:135]
    v_exp_f32 v151, v151
    v_mfma_f32_16x16x32_bf16 v[132:135], a[84:87], a[4:7], v[132:135]
    ds_read_b64_tr_b16 a[188:189], v207 offset:32768
    v_cvt_pk_bf16_f32 v171, v150, v151
    v_mfma_f32_16x16x32_bf16 v[132:135], a[80:83], a[0:3], v[132:135]
    s_waitcnt lgkmcnt(7)
    ds_read_b64_tr_b16 a[190:191], v207 offset:36864
    v_mfma_f32_16x16x32_bf16 v[64:67], v[248:251], a[128:131], v[64:67]
    v_exp_f32 v128, v128
    v_mfma_f32_16x16x32_bf16 v[64:67], v[240:243], a[160:163], v[64:67]
    v_exp_f32 v129, v129
    v_mfma_f32_16x16x32_bf16 v[96:99], v[244:247], a[160:163], v[96:99]
    v_add_f32 v176, v176, v128
    v_add_f32 v177, v177, v129
    v_mfma_f32_16x16x32_bf16 v[96:99], v[252:255], a[128:131], v[96:99]
    v_exp_f32 v130, v130
    v_mfma_f32_16x16x32_bf16 v[100:103], v[252:255], a[132:135], v[100:103]
    v_exp_f32 v131, v131
    v_mfma_f32_16x16x32_bf16 v[100:103], v[244:247], a[164:167], v[100:103]
    v_add_f32 v176, v176, v130
    v_add_f32 v177, v177, v131
    v_mfma_f32_16x16x32_bf16 v[68:71], v[240:243], a[164:167], v[68:71]
    v_exp_f32 v136, v136
    v_mfma_f32_16x16x32_bf16 v[68:71], v[248:251], a[132:135], v[68:71]
    v_exp_f32 v137, v137
    v_mfma_f32_16x16x32_bf16 v[72:75], v[248:251], a[136:139], v[72:75]
    s_waitcnt lgkmcnt(0)
    v_add_f32 v178, v178, v136
    v_add_f32 v179, v179, v137
    v_mfma_f32_16x16x32_bf16 v[72:75], v[240:243], a[168:171], v[72:75]
    v_exp_f32_e64 v138, v138
    v_mfma_f32_16x16x32_bf16 v[104:107], v[244:247], a[168:171], v[104:107]
    s_mov_b32 m0, s16
    v_exp_f32 v139, v139
    v_mfma_f32_16x16x32_bf16 v[104:107], v[252:255], a[136:139], v[104:107]
    s_lshl_b32 s57, s58, 17
    v_add_f32 v178, v178, v138
    v_add_f32 v179, v179, v139
    v_mfma_f32_16x16x32_bf16 v[108:111], v[252:255], a[140:143], v[108:111]
    ds_read_b128 a[96:99], v196 offset:8192
    ds_read_b128 a[100:103], v197 offset:8192
    v_mfma_f32_16x16x32_bf16 v[108:111], v[244:247], a[172:175], v[108:111]
    buffer_load_dwordx4 v216, s[24:27], s57 offen offset:0 lds
    v_mfma_f32_16x16x32_bf16 v[76:79], v[240:243], a[172:175], v[76:79]
    s_add_u32 s55, s55, 8
    v_exp_f32 v140, v140
    v_mfma_f32_16x16x32_bf16 v[76:79], v[248:251], a[140:143], v[76:79]
    s_min_u32 s60, s55, s59
    v_exp_f32 v141, v141
    v_mfma_f32_16x16x32_bf16 v[144:147], a[64:67], a[32:35], 4.0
    s_load_dword s58, s[10:11], s60
    v_add_f32 v178, v178, v140
    v_add_f32 v179, v179, v141
    v_mfma_f32_16x16x32_bf16 v[144:147], a[68:71], a[36:39], v[144:147]
    ds_read_b128 a[104:107], v198 offset:8192
    ds_read_b128 a[108:111], v199 offset:8192
    v_mfma_f32_16x16x32_bf16 v[144:147], a[72:75], a[40:43], v[144:147]
    buffer_load_dwordx4 v217, s[24:27], s57 offen offset:1024 lds
    v_mfma_f32_16x16x32_bf16 v[144:147], a[76:79], a[44:47], v[144:147]
    v_exp_f32 v142, v142
    v_mfma_f32_16x16x32_bf16 v[152:155], a[76:79], a[60:63], 4.0
    v_exp_f32 v143, v143
    v_mfma_f32_16x16x32_bf16 v[152:155], a[72:75], a[56:59], v[152:155]
    v_add_f32 v178, v178, v142
    v_add_f32 v179, v179, v143
    v_mfma_f32_16x16x32_bf16 v[152:155], a[68:71], a[52:55], v[152:155]
    ds_read_b128 a[112:115], v196 offset:12288
    ds_read_b128 a[116:119], v197 offset:12288
    v_mfma_f32_16x16x32_bf16 v[152:155], a[64:67], a[48:51], v[152:155]
    buffer_load_dwordx4 v218, s[24:27], s57 offen offset:2048 lds
    v_mfma_f32_16x16x32_bf16 v[156:159], a[80:83], a[48:51], 4.0
    v_exp_f32 v132, v132
    v_mfma_f32_16x16x32_bf16 v[156:159], a[84:87], a[52:55], v[156:159]
    v_exp_f32 v133, v133
    v_mfma_f32_16x16x32_bf16 v[156:159], a[88:91], a[56:59], v[156:159]
    v_add_f32 v176, v176, v132
    v_add_f32 v177, v177, v133
    v_mfma_f32_16x16x32_bf16 v[156:159], a[92:95], a[60:63], v[156:159]
    ds_read_b128 a[120:123], v198 offset:12288
    ds_read_b128 a[124:127], v199 offset:12288
    v_mfma_f32_16x16x32_bf16 v[148:151], a[92:95], a[44:47], 4.0
    buffer_load_dwordx4 v219, s[24:27], s57 offen offset:3072 lds
    v_mfma_f32_16x16x32_bf16 v[148:151], a[88:91], a[40:43], v[148:151]
    v_exp_f32 v134, v134
    v_mfma_f32_16x16x32_bf16 v[148:151], a[84:87], a[36:39], v[148:151]
    v_exp_f32 v135, v135
    v_mfma_f32_16x16x32_bf16 v[148:151], a[80:83], a[32:35], v[148:151]
    v_add_f32 v176, v176, v134
    v_add_f32 v177, v177, v135
    v_mfma_f32_16x16x32_bf16 v[80:83], v[248:251], a[144:147], v[80:83]
    v_exp_f32 v144, v144
    v_mfma_f32_16x16x32_bf16 v[80:83], v[240:243], a[176:179], v[80:83]
    v_exp_f32 v145, v145
    v_mfma_f32_16x16x32_bf16 v[112:115], v[244:247], a[176:179], v[112:115]
    ds_read_b64_tr_b16 a[128:129], v200 offset:0
    v_cvt_pk_bf16_f32 v160, v128, v129
    v_mfma_f32_16x16x32_bf16 v[112:115], v[252:255], a[144:147], v[112:115]
    s_cmp_le_u32 s55, s59
    v_exp_f32 v146, v146
    v_mfma_f32_16x16x32_bf16 v[116:119], v[252:255], a[148:151], v[116:119]
    ds_read_b64_tr_b16 a[130:131], v200 offset:4096
    v_cvt_pk_bf16_f32 v161, v130, v131
    v_mfma_f32_16x16x32_bf16 v[116:119], v[244:247], a[180:183], v[116:119]
    s_cselect_b32 s26, s26, 0
    v_exp_f32 v147, v147
    v_mfma_f32_16x16x32_bf16 v[84:87], v[240:243], a[180:183], v[84:87]
    ds_read_b64_tr_b16 a[132:133], v201 offset:0
    v_cvt_pk_bf16_f32 v164, v136, v137
    v_mfma_f32_16x16x32_bf16 v[84:87], v[248:251], a[148:151], v[84:87]
    v_exp_f32 v152, v152
    v_mfma_f32_16x16x32_bf16 v[88:91], v[248:251], a[152:155], v[88:91]
    ds_read_b64_tr_b16 a[134:135], v201 offset:4096
    v_cvt_pk_bf16_f32 v165, v138, v139
    v_mfma_f32_16x16x32_bf16 v[88:91], v[240:243], a[184:187], v[88:91]
    v_exp_f32 v153, v153
    v_mfma_f32_16x16x32_bf16 v[120:123], v[244:247], a[184:187], v[120:123]
    ds_read_b64_tr_b16 a[136:137], v202 offset:0
    v_cvt_pk_bf16_f32 v166, v140, v141
    v_mfma_f32_16x16x32_bf16 v[120:123], v[252:255], a[152:155], v[120:123]
    v_exp_f32 v154, v154
    v_mfma_f32_16x16x32_bf16 v[124:127], v[252:255], a[156:159], v[124:127]
    ds_read_b64_tr_b16 a[138:139], v202 offset:4096
    v_cvt_pk_bf16_f32 v167, v142, v143
    v_mfma_f32_16x16x32_bf16 v[124:127], v[244:247], a[188:191], v[124:127]
    v_exp_f32 v155, v155
    v_mfma_f32_16x16x32_bf16 v[92:95], v[240:243], a[188:191], v[92:95]
    s_cmp_eq_u32 s55, s56
    ds_read_b64_tr_b16 a[140:141], v203 offset:0
    v_cvt_pk_bf16_f32 v162, v132, v133
    v_mfma_f32_16x16x32_bf16 v[92:95], v[248:251], a[156:159], v[92:95]
    s_waitcnt lgkmcnt(7)
    v_exp_f32 v156, v156
    v_smfmac_f32_16x16x64_bf16 v[188:191], a[192:195], v[248:255], v192
    s_cbranch_scc0 L_loop
    s_branch L_tail0
.p2alignl 5, 0xbf800000
L_pad2:
L_hop0_1:
    s_cbranch_vccnz L_main
L_loop2:
    v_cvt_pk_bf16_f32 v163, v134, v135
    v_mfma_f32_16x16x32_bf16 v[128:131], a[96:99], a[32:35], 4.0
    ds_read_b64_tr_b16 a[142:143], v203 offset:4096
    v_cvt_pk_bf16_f32 v248, v144, v145
    v_mfma_f32_16x16x32_bf16 v[128:131], a[100:103], a[36:39], v[128:131]
    v_exp_f32 v157, v157
    v_mfma_f32_16x16x32_bf16 v[128:131], a[104:107], a[40:43], v[128:131]
    ds_read_b64_tr_b16 a[144:145], v204 offset:0
    v_cvt_pk_bf16_f32 v249, v146, v147
    v_mfma_f32_16x16x32_bf16 v[128:131], a[108:111], a[44:47], v[128:131]
    v_exp_f32 v158, v158
    v_mfma_f32_16x16x32_bf16 v[136:139], a[108:111], a[60:63], 4.0
    ds_read_b64_tr_b16 a[146:147], v204 offset:4096
    v_cvt_pk_bf16_f32 v252, v152, v153
    v_mfma_f32_16x16x32_bf16 v[136:139], a[104:107], a[56:59], v[136:139]
    v_exp_f32 v159, v159
    v_mfma_f32_16x16x32_bf16 v[136:139], a[100:103], a[52:55], v[136:139]
    ds_read_b64_tr_b16 a[148:149], v205 offset:0
    v_cvt_pk_bf16_f32 v253, v154, v155
    v_mfma_f32_16x16x32_bf16 v[136:139], a[96:99], a[48:51], v[136:139]
    v_exp_f32 v148, v148
    v_mfma_f32_16x16x32_bf16 v[140:143], a[112:115], a[48:51], 4.0
    ds_read_b64_tr_b16 a[150:151], v205 offset:4096
    v_cvt_pk_bf16_f32 v254, v156, v157
    v_mfma_f32_16x16x32_bf16 v[140:143], a[116:119], a[52:55], v[140:143]
    v_exp_f32 v149, v149
    v_mfma_f32_16x16x32_bf16 v[140:143], a[120:123], a[56:59], v[140:143]
    ds_read_b64_tr_b16 a[152:153], v206 offset:0
    v_cvt_pk_bf16_f32 v255, v158, v159
    v_mfma_f32_16x16x32_bf16 v[140:143], a[124:127], a[60:63], v[140:143]
    v_exp_f32 v150, v150
    v_mfma_f32_16x16x32_bf16 v[132:135], a[124:127], a[44:47], 4.0
    ds_read_b64_tr_b16 a[154:155], v206 offset:4096
    v_cvt_pk_bf16_f32 v250, v148, v149
    v_mfma_f32_16x16x32_bf16 v[132:135], a[120:123], a[40:43], v[132:135]
    v_exp_f32 v151, v151
    v_mfma_f32_16x16x32_bf16 v[132:135], a[116:119], a[36:39], v[132:135]
    ds_read_b64_tr_b16 a[156:157], v207 offset:0
    v_cvt_pk_bf16_f32 v251, v150, v151
    v_mfma_f32_16x16x32_bf16 v[132:135], a[112:115], a[32:35], v[132:135]
    s_waitcnt lgkmcnt(7)
    ds_read_b64_tr_b16 a[158:159], v207 offset:4096
    v_mfma_f32_16x16x32_bf16 v[0:3], v[168:171], a[160:163], v[0:3]
    v_exp_f32 v128, v128
    v_mfma_f32_16x16x32_bf16 v[0:3], v[160:163], a[128:131], v[0:3]
    v_exp_f32 v129, v129
    v_mfma_f32_16x16x32_bf16 v[32:35], v[164:167], a[128:131], v[32:35]
    v_add_f32 v180, v180, v128
    v_add_f32 v181, v181, v129
    v_mfma_f32_16x16x32_bf16 v[32:35], v[172:175], a[160:163], v[32:35]
    v_exp_f32 v130, v130
    v_mfma_f32_16x16x32_bf16 v[36:39], v[172:175], a[164:167], v[36:39]
    v_exp_f32 v131, v131
    v_mfma_f32_16x16x32_bf16 v[36:39], v[164:167], a[132:135], v[36:39]
    v_add_f32 v180, v180, v130
    v_add_f32 v181, v181, v131
    v_mfma_f32_16x16x32_bf16 v[4:7], v[160:163], a[132:135], v[4:7]
    s_waitcnt vmcnt(4) lgkmcnt(0)
    v_exp_f32 v136, v136
    v_mfma_f32_16x16x32_bf16 v[4:7], v[168:171], a[164:167], v[4:7]
    s_barrier
    v_exp_f32 v137, v137
    v_mfma_f32_16x16x32_bf16 v[8:11], v[168:171], a[168:171], v[8:11]
    v_add_f32 v182, v182, v136
    v_add_f32 v183, v183, v137
    v_mfma_f32_16x16x32_bf16 v[8:11], v[160:163], a[136:139], v[8:11]
    v_exp_f32 v138, v138
    v_mfma_f32_16x16x32_bf16 v[40:43], v[164:167], a[136:139], v[40:43]
    s_mov_b32 m0, s66
    v_exp_f32 v139, v139
    v_mfma_f32_16x16x32_bf16 v[40:43], v[172:175], a[168:171], v[40:43]
    s_lshl_b32 s57, s58, 17
    v_add_f32 v182, v182, v138
    v_add_f32 v183, v183, v139
    v_mfma_f32_16x16x32_bf16 v[44:47], v[172:175], a[172:175], v[44:47]
    ds_read_b128 a[64:67], v196 offset:16384
    ds_read_b128 a[68:71], v197 offset:16384
    v_mfma_f32_16x16x32_bf16 v[44:47], v[164:167], a[140:143], v[44:47]
    buffer_load_dwordx4 v216, s[24:27], s57 offen offset:0 lds
    v_mfma_f32_16x16x32_bf16 v[12:15], v[160:163], a[140:143], v[12:15]
    s_add_u32 s55, s55, 8
    v_exp_f32 v140, v140
    v_mfma_f32_16x16x32_bf16 v[12:15], v[168:171], a[172:175], v[12:15]
    s_min_u32 s60, s55, s59
    v_exp_f32 v141, v141
    v_mfma_f32_16x16x32_bf16 v[144:147], a[96:99], a[0:3], 4.0
    s_load_dword s58, s[10:11], s60
    v_add_f32 v182, v182, v140
    v_add_f32 v183, v183, v141
    v_mfma_f32_16x16x32_bf16 v[144:147], a[100:103], a[4:7], v[144:147]
    ds_read_b128 a[72:75], v198 offset:16384
    ds_read_b128 a[76:79], v199 offset:16384
    v_mfma_f32_16x16x32_bf16 v[144:147], a[104:107], a[8:11], v[144:147]
    buffer_load_dwordx4 v217, s[24:27], s57 offen offset:1024 lds
    v_mfma_f32_16x16x32_bf16 v[144:147], a[108:111], a[12:15], v[144:147]
    v_exp_f32 v142, v142
    v_mfma_f32_16x16x32_bf16 v[152:155], a[108:111], a[28:31], 4.0
    v_exp_f32 v143, v143
    v_mfma_f32_16x16x32_bf16 v[152:155], a[104:107], a[24:27], v[152:155]
    v_add_f32 v182, v182, v142
    v_add_f32 v183, v183, v143
    v_mfma_f32_16x16x32_bf16 v[152:155], a[100:103], a[20:23], v[152:155]
    ds_read_b128 a[80:83], v196 offset:20480
    ds_read_b128 a[84:87], v197 offset:20480
    v_mfma_f32_16x16x32_bf16 v[152:155], a[96:99], a[16:19], v[152:155]
    buffer_load_dwordx4 v218, s[24:27], s57 offen offset:2048 lds
    v_mfma_f32_16x16x32_bf16 v[156:159], a[112:115], a[16:19], 4.0
    v_exp_f32 v132, v132
    v_mfma_f32_16x16x32_bf16 v[156:159], a[116:119], a[20:23], v[156:159]
    v_exp_f32 v133, v133
    v_mfma_f32_16x16x32_bf16 v[156:159], a[120:123], a[24:27], v[156:159]
    v_add_f32 v180, v180, v132
    v_add_f32 v181, v181, v133
    v_mfma_f32_16x16x32_bf16 v[156:159], a[124:127], a[28:31], v[156:159]
    ds_read_b128 a[88:91], v198 offset:20480
    ds_read_b128 a[92:95], v199 offset:20480
    v_mfma_f32_16x16x32_bf16 v[148:151], a[124:127], a[12:15], 4.0
    buffer_load_dwordx4 v219, s[24:27], s57 offen offset:3072 lds
    v_mfma_f32_16x16x32_bf16 v[148:151], a[120:123], a[8:11], v[148:151]
    v_exp_f32 v134, v134
    v_mfma_f32_16x16x32_bf16 v[148:151], a[116:119], a[4:7], v[148:151]
    v_exp_f32 v135, v135
    v_mfma_f32_16x16x32_bf16 v[148:151], a[112:115], a[0:3], v[148:151]
    v_add_f32 v180, v180, v134
    v_add_f32 v181, v181, v135
    v_mfma_f32_16x16x32_bf16 v[16:19], v[168:171], a[176:179], v[16:19]
    v_exp_f32 v144, v144
    v_mfma_f32_16x16x32_bf16 v[16:19], v[160:163], a[144:147], v[16:19]
    v_exp_f32 v145, v145
    v_mfma_f32_16x16x32_bf16 v[48:51], v[164:167], a[144:147], v[48:51]
    ds_read_b64_tr_b16 a[160:161], v200 offset:8192
    v_cvt_pk_bf16_f32 v240, v128, v129
    v_mfma_f32_16x16x32_bf16 v[48:51], v[172:175], a[176:179], v[48:51]
    s_cmp_le_u32 s55, s59
    v_exp_f32 v146, v146
    v_mfma_f32_16x16x32_bf16 v[52:55], v[172:175], a[180:183], v[52:55]
    ds_read_b64_tr_b16 a[162:163], v200 offset:12288
    v_cvt_pk_bf16_f32 v241, v130, v131
    v_mfma_f32_16x16x32_bf16 v[52:55], v[164:167], a[148:151], v[52:55]
    s_cselect_b32 s26, s26, 0
    v_exp_f32 v147, v147
    v_mfma_f32_16x16x32_bf16 v[20:23], v[160:163], a[148:151], v[20:23]
    ds_read_b64_tr_b16 a[164:165], v201 offset:8192
    v_cvt_pk_bf16_f32 v244, v136, v137
    v_mfma_f32_16x16x32_bf16 v[20:23], v[168:171], a[180:183], v[20:23]
    v_exp_f32 v152, v152
    v_mfma_f32_16x16x32_bf16 v[24:27], v[168:171], a[184:187], v[24:27]
    ds_read_b64_tr_b16 a[166:167], v201 offset:12288
    v_cvt_pk_bf16_f32 v245, v138, v139
    v_mfma_f32_16x16x32_bf16 v[24:27], v[160:163], a[152:155], v[24:27]
    v_exp_f32 v153, v153
    v_mfma_f32_16x16x32_bf16 v[56:59], v[164:167], a[152:155], v[56:59]
    ds_read_b64_tr_b16 a[168:169], v202 offset:8192
    v_cvt_pk_bf16_f32 v246, v140, v141
    v_mfma_f32_16x16x32_bf16 v[56:59], v[172:175], a[184:187], v[56:59]
    v_exp_f32 v154, v154
    v_mfma_f32_16x16x32_bf16 v[60:63], v[172:175], a[188:191], v[60:63]
    ds_read_b64_tr_b16 a[170:171], v202 offset:12288
    v_cvt_pk_bf16_f32 v247, v142, v143
    v_mfma_f32_16x16x32_bf16 v[60:63], v[164:167], a[156:159], v[60:63]
    v_exp_f32 v155, v155
    v_mfma_f32_16x16x32_bf16 v[28:31], v[160:163], a[156:159], v[28:31]
    s_cmp_eq_u32 s55, s56
    ds_read_b64_tr_b16 a[172:173], v203 offset:8192
    v_cvt_pk_bf16_f32 v242, v132, v133
    v_mfma_f32_16x16x32_bf16 v[28:31], v[168:171], a[188:191], v[28:31]
    s_waitcnt lgkmcnt(7)
    v_exp_f32 v156, v156
    v_smfmac_f32_16x16x64_bf16 v[184:187], a[192:195], v[168:175], v192
    s_cbranch_scc1 L_tail1
    v_cvt_pk_bf16_f32 v243, v134, v135
    v_mfma_f32_16x16x32_bf16 v[128:131], a[64:67], a[0:3], 4.0
    ds_read_b64_tr_b16 a[174:175], v203 offset:12288
    v_cvt_pk_bf16_f32 v168, v144, v145
    v_mfma_f32_16x16x32_bf16 v[128:131], a[68:71], a[4:7], v[128:131]
    v_exp_f32 v157, v157
    v_mfma_f32_16x16x32_bf16 v[128:131], a[72:75], a[8:11], v[128:131]
    ds_read_b64_tr_b16 a[176:177], v204 offset:8192
    v_cvt_pk_bf16_f32 v169, v146, v147
    v_mfma_f32_16x16x32_bf16 v[128:131], a[76:79], a[12:15], v[128:131]
    v_exp_f32 v158, v158
    v_mfma_f32_16x16x32_bf16 v[136:139], a[76:79], a[28:31], 4.0
    ds_read_b64_tr_b16 a[178:179], v204 offset:12288
    v_cvt_pk_bf16_f32 v172, v152, v153
    v_mfma_f32_16x16x32_bf16 v[136:139], a[72:75], a[24:27], v[136:139]
    v_exp_f32 v159, v159
    v_mfma_f32_16x16x32_bf16 v[136:139], a[68:71], a[20:23], v[136:139]
    ds_read_b64_tr_b16 a[180:181], v205 offset:8192
    v_cvt_pk_bf16_f32 v173, v154, v155
    v_mfma_f32_16x16x32_bf16 v[136:139], a[64:67], a[16:19], v[136:139]
    v_exp_f32 v148, v148
    v_mfma_f32_16x16x32_bf16 v[140:143], a[80:83], a[16:19], 4.0
    ds_read_b64_tr_b16 a[182:183], v205 offset:12288
    v_cvt_pk_bf16_f32 v174, v156, v157
    v_mfma_f32_16x16x32_bf16 v[140:143], a[84:87], a[20:23], v[140:143]
    v_exp_f32 v149, v149
    v_mfma_f32_16x16x32_bf16 v[140:143], a[88:91], a[24:27], v[140:143]
    ds_read_b64_tr_b16 a[184:185], v206 offset:8192
    v_cvt_pk_bf16_f32 v175, v158, v159
    v_mfma_f32_16x16x32_bf16 v[140:143], a[92:95], a[28:31], v[140:143]
    v_exp_f32 v150, v150
    v_mfma_f32_16x16x32_bf16 v[132:135], a[92:95], a[12:15], 4.0
    ds_read_b64_tr_b16 a[186:187], v206 offset:12288
    v_cvt_pk_bf16_f32 v170, v148, v149
    v_mfma_f32_16x16x32_bf16 v[132:135], a[88:91], a[8:11], v[132:135]
    v_exp_f32 v151, v151
    v_mfma_f32_16x16x32_bf16 v[132:135], a[84:87], a[4:7], v[132:135]
    ds_read_b64_tr_b16 a[188:189], v207 offset:8192
    v_cvt_pk_bf16_f32 v171, v150, v151
    v_mfma_f32_16x16x32_bf16 v[132:135], a[80:83], a[0:3], v[132:135]
    s_waitcnt lgkmcnt(7)
    ds_read_b64_tr_b16 a[190:191], v207 offset:12288
    v_mfma_f32_16x16x32_bf16 v[64:67], v[248:251], a[128:131], v[64:67]
    v_exp_f32 v128, v128
    v_mfma_f32_16x16x32_bf16 v[64:67], v[240:243], a[160:163], v[64:67]
    v_exp_f32 v129, v129
    v_mfma_f32_16x16x32_bf16 v[96:99], v[244:247], a[160:163], v[96:99]
    v_add_f32 v176, v176, v128
    v_add_f32 v177, v177, v129
    v_mfma_f32_16x16x32_bf16 v[96:99], v[252:255], a[128:131], v[96:99]
    v_exp_f32 v130, v130
    v_mfma_f32_16x16x32_bf16 v[100:103], v[252:255], a[132:135], v[100:103]
    v_exp_f32 v131, v131
    v_mfma_f32_16x16x32_bf16 v[100:103], v[244:247], a[164:167], v[100:103]
    v_add_f32 v176, v176, v130
    v_add_f32 v177, v177, v131
    v_mfma_f32_16x16x32_bf16 v[68:71], v[240:243], a[164:167], v[68:71]
    s_waitcnt lgkmcnt(0)
    v_exp_f32 v136, v136
    v_mfma_f32_16x16x32_bf16 v[68:71], v[248:251], a[132:135], v[68:71]
    v_exp_f32 v137, v137
    v_mfma_f32_16x16x32_bf16 v[72:75], v[248:251], a[136:139], v[72:75]
    v_add_f32 v178, v178, v136
    v_add_f32 v179, v179, v137
    v_mfma_f32_16x16x32_bf16 v[72:75], v[240:243], a[168:171], v[72:75]
    v_exp_f32_e64 v138, v138
    v_mfma_f32_16x16x32_bf16 v[104:107], v[244:247], a[168:171], v[104:107]
    s_mov_b32 m0, s67
    v_exp_f32 v139, v139
    v_mfma_f32_16x16x32_bf16 v[104:107], v[252:255], a[136:139], v[104:107]
    s_lshl_b32 s57, s58, 17
    v_add_f32 v178, v178, v138
    v_add_f32 v179, v179, v139
    v_mfma_f32_16x16x32_bf16 v[108:111], v[252:255], a[140:143], v[108:111]
    ds_read_b128 a[96:99], v196 offset:24576
    ds_read_b128 a[100:103], v197 offset:24576
    v_mfma_f32_16x16x32_bf16 v[108:111], v[244:247], a[172:175], v[108:111]
    buffer_load_dwordx4 v216, s[24:27], s57 offen offset:0 lds
    v_mfma_f32_16x16x32_bf16 v[76:79], v[240:243], a[172:175], v[76:79]
    s_add_u32 s55, s55, 8
    v_exp_f32 v140, v140
    v_mfma_f32_16x16x32_bf16 v[76:79], v[248:251], a[140:143], v[76:79]
    s_min_u32 s60, s55, s59
    v_exp_f32 v141, v141
    v_mfma_f32_16x16x32_bf16 v[144:147], a[64:67], a[32:35], 4.0
    s_load_dword s58, s[10:11], s60
    v_add_f32 v178, v178, v140
    v_add_f32 v179, v179, v141
    v_mfma_f32_16x16x32_bf16 v[144:147], a[68:71], a[36:39], v[144:147]
    ds_read_b128 a[104:107], v198 offset:24576
    ds_read_b128 a[108:111], v199 offset:24576
    v_mfma_f32_16x16x32_bf16 v[144:147], a[72:75], a[40:43], v[144:147]
    buffer_load_dwordx4 v217, s[24:27], s57 offen offset:1024 lds
    v_mfma_f32_16x16x32_bf16 v[144:147], a[76:79], a[44:47], v[144:147]
    v_exp_f32 v142, v142
    v_mfma_f32_16x16x32_bf16 v[152:155], a[76:79], a[60:63], 4.0
    v_exp_f32 v143, v143
    v_mfma_f32_16x16x32_bf16 v[152:155], a[72:75], a[56:59], v[152:155]
    v_add_f32 v178, v178, v142
    v_add_f32 v179, v179, v143
    v_mfma_f32_16x16x32_bf16 v[152:155], a[68:71], a[52:55], v[152:155]
    ds_read_b128 a[112:115], v196 offset:28672
    ds_read_b128 a[116:119], v197 offset:28672
    v_mfma_f32_16x16x32_bf16 v[152:155], a[64:67], a[48:51], v[152:155]
    buffer_load_dwordx4 v218, s[24:27], s57 offen offset:2048 lds
    v_mfma_f32_16x16x32_bf16 v[156:159], a[80:83], a[48:51], 4.0
    v_exp_f32 v132, v132
    v_mfma_f32_16x16x32_bf16 v[156:159], a[84:87], a[52:55], v[156:159]
    v_exp_f32 v133, v133
    v_mfma_f32_16x16x32_bf16 v[156:159], a[88:91], a[56:59], v[156:159]
    v_add_f32 v176, v176, v132
    v_add_f32 v177, v177, v133
    v_mfma_f32_16x16x32_bf16 v[156:159], a[92:95], a[60:63], v[156:159]
    ds_read_b128 a[120:123], v198 offset:28672
    ds_read_b128 a[124:127], v199 offset:28672
    v_mfma_f32_16x16x32_bf16 v[148:151], a[92:95], a[44:47], 4.0
    buffer_load_dwordx4 v219, s[24:27], s57 offen offset:3072 lds
    v_mfma_f32_16x16x32_bf16 v[148:151], a[88:91], a[40:43], v[148:151]
    v_exp_f32 v134, v134
    v_mfma_f32_16x16x32_bf16 v[148:151], a[84:87], a[36:39], v[148:151]
    v_exp_f32 v135, v135
    v_mfma_f32_16x16x32_bf16 v[148:151], a[80:83], a[32:35], v[148:151]
    v_add_f32 v176, v176, v134
    v_add_f32 v177, v177, v135
    v_mfma_f32_16x16x32_bf16 v[80:83], v[248:251], a[144:147], v[80:83]
    v_exp_f32 v144, v144
    v_mfma_f32_16x16x32_bf16 v[80:83], v[240:243], a[176:179], v[80:83]
    v_exp_f32 v145, v145
    v_mfma_f32_16x16x32_bf16 v[112:115], v[244:247], a[176:179], v[112:115]
    ds_read_b64_tr_b16 a[128:129], v200 offset:16384
    v_cvt_pk_bf16_f32 v160, v128, v129
    v_mfma_f32_16x16x32_bf16 v[112:115], v[252:255], a[144:147], v[112:115]
    s_cmp_le_u32 s55, s59
    v_exp_f32 v146, v146
    v_mfma_f32_16x16x32_bf16 v[116:119], v[252:255], a[148:151], v[116:119]
    ds_read_b64_tr_b16 a[130:131], v200 offset:20480
    v_cvt_pk_bf16_f32 v161, v130, v131
    v_mfma_f32_16x16x32_bf16 v[116:119], v[244:247], a[180:183], v[116:119]
    s_cselect_b32 s26, s26, 0
    v_exp_f32 v147, v147
    v_mfma_f32_16x16x32_bf16 v[84:87], v[240:243], a[180:183], v[84:87]
    ds_read_b64_tr_b16 a[132:133], v201 offset:16384
    v_cvt_pk_bf16_f32 v164, v136, v137
    v_mfma_f32_16x16x32_bf16 v[84:87], v[248:251], a[148:151], v[84:87]
    v_exp_f32 v152, v152
    v_mfma_f32_16x16x32_bf16 v[88:91], v[248:251], a[152:155], v[88:91]
    ds_read_b64_tr_b16 a[134:135], v201 offset:20480
    v_cvt_pk_bf16_f32 v165, v138, v139
    v_mfma_f32_16x16x32_bf16 v[88:91], v[240:243], a[184:187], v[88:91]
    v_exp_f32 v153, v153
    v_mfma_f32_16x16x32_bf16 v[120:123], v[244:247], a[184:187], v[120:123]
    ds_read_b64_tr_b16 a[136:137], v202 offset:16384
    v_cvt_pk_bf16_f32 v166, v140, v141
    v_mfma_f32_16x16x32_bf16 v[120:123], v[252:255], a[152:155], v[120:123]
    v_exp_f32 v154, v154
    v_mfma_f32_16x16x32_bf16 v[124:127], v[252:255], a[156:159], v[124:127]
    ds_read_b64_tr_b16 a[138:139], v202 offset:20480
    v_cvt_pk_bf16_f32 v167, v142, v143
    v_mfma_f32_16x16x32_bf16 v[124:127], v[244:247], a[188:191], v[124:127]
    v_exp_f32 v155, v155
    v_mfma_f32_16x16x32_bf16 v[92:95], v[240:243], a[188:191], v[92:95]
    s_cmp_eq_u32 s55, s56
    ds_read_b64_tr_b16 a[140:141], v203 offset:16384
    v_cvt_pk_bf16_f32 v162, v132, v133
    v_mfma_f32_16x16x32_bf16 v[92:95], v[248:251], a[156:159], v[92:95]
    s_waitcnt lgkmcnt(7)
    v_exp_f32 v156, v156
    v_smfmac_f32_16x16x64_bf16 v[188:191], a[192:195], v[248:255], v192
    s_cbranch_scc1 L_tail0
    v_cvt_pk_bf16_f32 v163, v134, v135
    v_mfma_f32_16x16x32_bf16 v[128:131], a[96:99], a[32:35], 4.0
    ds_read_b64_tr_b16 a[142:143], v203 offset:20480
    v_cvt_pk_bf16_f32 v248, v144, v145
    v_mfma_f32_16x16x32_bf16 v[128:131], a[100:103], a[36:39], v[128:131]
    v_exp_f32 v157, v157
    v_mfma_f32_16x16x32_bf16 v[128:131], a[104:107], a[40:43], v[128:131]
    ds_read_b64_tr_b16 a[144:145], v204 offset:16384
    v_cvt_pk_bf16_f32 v249, v146, v147
    v_mfma_f32_16x16x32_bf16 v[128:131], a[108:111], a[44:47], v[128:131]
    v_exp_f32 v158, v158
    v_mfma_f32_16x16x32_bf16 v[136:139], a[108:111], a[60:63], 4.0
    ds_read_b64_tr_b16 a[146:147], v204 offset:20480
    v_cvt_pk_bf16_f32 v252, v152, v153
    v_mfma_f32_16x16x32_bf16 v[136:139], a[104:107], a[56:59], v[136:139]
    v_exp_f32 v159, v159
    v_mfma_f32_16x16x32_bf16 v[136:139], a[100:103], a[52:55], v[136:139]
    ds_read_b64_tr_b16 a[148:149], v205 offset:16384
    v_cvt_pk_bf16_f32 v253, v154, v155
    v_mfma_f32_16x16x32_bf16 v[136:139], a[96:99], a[48:51], v[136:139]
    v_exp_f32 v148, v148
    v_mfma_f32_16x16x32_bf16 v[140:143], a[112:115], a[48:51], 4.0
    ds_read_b64_tr_b16 a[150:151], v205 offset:20480
    v_cvt_pk_bf16_f32 v254, v156, v157
    v_mfma_f32_16x16x32_bf16 v[140:143], a[116:119], a[52:55], v[140:143]
    v_exp_f32 v149, v149
    v_mfma_f32_16x16x32_bf16 v[140:143], a[120:123], a[56:59], v[140:143]
    ds_read_b64_tr_b16 a[152:153], v206 offset:16384
    v_cvt_pk_bf16_f32 v255, v158, v159
    v_mfma_f32_16x16x32_bf16 v[140:143], a[124:127], a[60:63], v[140:143]
    v_exp_f32 v150, v150
    v_mfma_f32_16x16x32_bf16 v[132:135], a[124:127], a[44:47], 4.0
    ds_read_b64_tr_b16 a[154:155], v206 offset:20480
    v_cvt_pk_bf16_f32 v250, v148, v149
    v_mfma_f32_16x16x32_bf16 v[132:135], a[120:123], a[40:43], v[132:135]
    v_exp_f32 v151, v151
    v_mfma_f32_16x16x32_bf16 v[132:135], a[116:119], a[36:39], v[132:135]
    ds_read_b64_tr_b16 a[156:157], v207 offset:16384
    v_cvt_pk_bf16_f32 v251, v150, v151
    v_mfma_f32_16x16x32_bf16 v[132:135], a[112:115], a[32:35], v[132:135]
    s_waitcnt lgkmcnt(7)
    ds_read_b64_tr_b16 a[158:159], v207 offset:20480
    v_mfma_f32_16x16x32_bf16 v[0:3], v[168:171], a[160:163], v[0:3]
    v_exp_f32 v128, v128
    v_mfma_f32_16x16x32_bf16 v[0:3], v[160:163], a[128:131], v[0:3]
    v_exp_f32 v129, v129
    v_mfma_f32_16x16x32_bf16 v[32:35], v[164:167], a[128:131], v[32:35]
    v_add_f32 v180, v180, v128
    v_add_f32 v181, v181, v129
    v_mfma_f32_16x16x32_bf16 v[32:35], v[172:175], a[160:163], v[32:35]
    v_exp_f32 v130, v130
    v_mfma_f32_16x16x32_bf16 v[36:39], v[172:175], a[164:167], v[36:39]
    v_exp_f32 v131, v131
    v_mfma_f32_16x16x32_bf16 v[36:39], v[164:167], a[132:135], v[36:39]
    v_add_f32 v180, v180, v130
    v_add_f32 v181, v181, v131
    v_mfma_f32_16x16x32_bf16 v[4:7], v[160:163], a[132:135], v[4:7]
    s_waitcnt vmcnt(4) lgkmcnt(0)
    v_exp_f32 v136, v136
    v_mfma_f32_16x16x32_bf16 v[4:7], v[168:171], a[164:167], v[4:7]
    s_barrier
    v_exp_f32 v137, v137
    v_mfma_f32_16x16x32_bf16 v[8:11], v[168:171], a[168:171], v[8:11]
    v_add_f32 v182, v182, v136
    v_add_f32 v183, v183, v137
    v_mfma_f32_16x16x32_bf16 v[8:11], v[160:163], a[136:139], v[8:11]
    v_exp_f32 v138, v138
    v_mfma_f32_16x16x32_bf16 v[40:43], v[164:167], a[136:139], v[40:43]
    s_mov_b32 m0, s68
    v_exp_f32 v139, v139
    v_mfma_f32_16x16x32_bf16 v[40:43], v[172:175], a[168:171], v[40:43]
    s_lshl_b32 s57, s58, 17
    v_add_f32 v182, v182, v138
    v_add_f32 v183, v183, v139
    v_mfma_f32_16x16x32_bf16 v[44:47], v[172:175], a[172:175], v[44:47]
    ds_read_b128 a[64:67], v196 offset:32768
    ds_read_b128 a[68:71], v197 offset:32768
    v_mfma_f32_16x16x32_bf16 v[44:47], v[164:167], a[140:143], v[44:47]
    buffer_load_dwordx4 v216, s[24:27], s57 offen offset:0 lds
    v_mfma_f32_16x16x32_bf16 v[12:15], v[160:163], a[140:143], v[12:15]
    s_add_u32 s55, s55, 8
    v_exp_f32 v140, v140
    v_mfma_f32_16x16x32_bf16 v[12:15], v[168:171], a[172:175], v[12:15]
    s_min_u32 s60, s55, s59
    v_exp_f32 v141, v141
    v_mfma_f32_16x16x32_bf16 v[144:147], a[96:99], a[0:3], 4.0
    s_load_dword s58, s[10:11], s60
    v_add_f32 v182, v182, v140
    v_add_f32 v183, v183, v141
    v_mfma_f32_16x16x32_bf16 v[144:147], a[100:103], a[4:7], v[144:147]
    ds_read_b128 a[72:75], v198 offset:32768
    ds_read_b128 a[76:79], v199 offset:32768
    v_mfma_f32_16x16x32_bf16 v[144:147], a[104:107], a[8:11], v[144:147]
    buffer_load_dwordx4 v217, s[24:27], s57 offen offset:1024 lds
    v_mfma_f32_16x16x32_bf16 v[144:147], a[108:111], a[12:15], v[144:147]
    v_exp_f32 v142, v142
    v_mfma_f32_16x16x32_bf16 v[152:155], a[108:111], a[28:31], 4.0
    v_exp_f32 v143, v143
    v_mfma_f32_16x16x32_bf16 v[152:155], a[104:107], a[24:27], v[152:155]
    v_add_f32 v182, v182, v142
    v_add_f32 v183, v183, v143
    v_mfma_f32_16x16x32_bf16 v[152:155], a[100:103], a[20:23], v[152:155]
    ds_read_b128 a[80:83], v196 offset:36864
    ds_read_b128 a[84:87], v197 offset:36864
    v_mfma_f32_16x16x32_bf16 v[152:155], a[96:99], a[16:19], v[152:155]
    buffer_load_dwordx4 v218, s[24:27], s57 offen offset:2048 lds
    v_mfma_f32_16x16x32_bf16 v[156:159], a[112:115], a[16:19], 4.0
    v_exp_f32 v132, v132
    v_mfma_f32_16x16x32_bf16 v[156:159], a[116:119], a[20:23], v[156:159]
    v_exp_f32 v133, v133
    v_mfma_f32_16x16x32_bf16 v[156:159], a[120:123], a[24:27], v[156:159]
    v_add_f32 v180, v180, v132
    v_add_f32 v181, v181, v133
    v_mfma_f32_16x16x32_bf16 v[156:159], a[124:127], a[28:31], v[156:159]
    ds_read_b128 a[88:91], v198 offset:36864
    ds_read_b128 a[92:95], v199 offset:36864
    v_mfma_f32_16x16x32_bf16 v[148:151], a[124:127], a[12:15], 4.0
    buffer_load_dwordx4 v219, s[24:27], s57 offen offset:3072 lds
    v_mfma_f32_16x16x32_bf16 v[148:151], a[120:123], a[8:11], v[148:151]
    v_exp_f32 v134, v134
    v_mfma_f32_16x16x32_bf16 v[148:151], a[116:119], a[4:7], v[148:151]
    v_exp_f32 v135, v135
    v_mfma_f32_16x16x32_bf16 v[148:151], a[112:115], a[0:3], v[148:151]
    v_add_f32 v180, v180, v134
    v_add_f32 v181, v181, v135
    v_mfma_f32_16x16x32_bf16 v[16:19], v[168:171], a[176:179], v[16:19]
    v_exp_f32 v144, v144
    v_mfma_f32_16x16x32_bf16 v[16:19], v[160:163], a[144:147], v[16:19]
    v_exp_f32 v145, v145
    v_mfma_f32_16x16x32_bf16 v[48:51], v[164:167], a[144:147], v[48:51]
    ds_read_b64_tr_b16 a[160:161], v200 offset:24576
    v_cvt_pk_bf16_f32 v240, v128, v129
    v_mfma_f32_16x16x32_bf16 v[48:51], v[172:175], a[176:179], v[48:51]
    s_cmp_le_u32 s55, s59
    v_exp_f32 v146, v146
    v_mfma_f32_16x16x32_bf16 v[52:55], v[172:175], a[180:183], v[52:55]
    ds_read_b64_tr_b16 a[162:163], v200 offset:28672
    v_cvt_pk_bf16_f32 v241, v130, v131
    v_mfma_f32_16x16x32_bf16 v[52:55], v[164:167], a[148:151], v[52:55]
    s_cselect_b32 s26, s26, 0
    v_exp_f32 v147, v147
    v_mfma_f32_16x16x32_bf16 v[20:23], v[160:163], a[148:151], v[20:23]
    ds_read_b64_tr_b16 a[164:165], v201 offset:24576
    v_cvt_pk_bf16_f32 v244, v136, v137
    v_mfma_f32_16x16x32_bf16 v[20:23], v[168:171], a[180:183], v[20:23]
    v_exp_f32 v152, v152
    v_mfma_f32_16x16x32_bf16 v[24:27], v[168:171], a[184:187], v[24:27]
    ds_read_b64_tr_b16 a[166:167], v201 offset:28672
    v_cvt_pk_bf16_f32 v245, v138, v139
    v_mfma_f32_16x16x32_bf16 v[24:27], v[160:163], a[152:155], v[24:27]
    v_exp_f32 v153, v153
    v_mfma_f32_16x16x32_bf16 v[56:59], v[164:167], a[152:155], v[56:59]
    ds_read_b64_tr_b16 a[168:169], v202 offset:24576
    v_cvt_pk_bf16_f32 v246, v140, v141
    v_mfma_f32_16x16x32_bf16 v[56:59], v[172:175], a[184:187], v[56:59]
    v_exp_f32 v154, v154
    v_mfma_f32_16x16x32_bf16 v[60:63], v[172:175], a[188:191], v[60:63]
    ds_read_b64_tr_b16 a[170:171], v202 offset:28672
    v_cvt_pk_bf16_f32 v247, v142, v143
    v_mfma_f32_16x16x32_bf16 v[60:63], v[164:167], a[156:159], v[60:63]
    v_exp_f32 v155, v155
    v_mfma_f32_16x16x32_bf16 v[28:31], v[160:163], a[156:159], v[28:31]
    s_cmp_eq_u32 s55, s56
    ds_read_b64_tr_b16 a[172:173], v203 offset:24576
    v_cvt_pk_bf16_f32 v242, v132, v133
    v_mfma_f32_16x16x32_bf16 v[28:31], v[168:171], a[188:191], v[28:31]
    s_waitcnt lgkmcnt(7)
    v_exp_f32 v156, v156
    v_smfmac_f32_16x16x64_bf16 v[184:187], a[192:195], v[168:175], v192
    s_cbranch_scc1 L_tail1
    v_cvt_pk_bf16_f32 v243, v134, v135
    v_mfma_f32_16x16x32_bf16 v[128:131], a[64:67], a[0:3], 4.0
    ds_read_b64_tr_b16 a[174:175], v203 offset:28672
    v_cvt_pk_bf16_f32 v168, v144, v145
    v_mfma_f32_16x16x32_bf16 v[128:131], a[68:71], a[4:7], v[128:131]
    v_exp_f32 v157, v157
    v_mfma_f32_16x16x32_bf16 v[128:131], a[72:75], a[8:11], v[128:131]
    ds_read_b64_tr_b16 a[176:177], v204 offset:24576
    v_cvt_pk_bf16_f32 v169, v146, v147
    v_mfma_f32_16x16x32_bf16 v[128:131], a[76:79], a[12:15], v[128:131]
    v_exp_f32 v158, v158
    v_mfma_f32_16x16x32_bf16 v[136:139], a[76:79], a[28:31], 4.0
    ds_read_b64_tr_b16 a[178:179], v204 offset:28672
    v_cvt_pk_bf16_f32 v172, v152, v153
    v_mfma_f32_16x16x32_bf16 v[136:139], a[72:75], a[24:27], v[136:139]
    v_exp_f32 v159, v159
    v_mfma_f32_16x16x32_bf16 v[136:139], a[68:71], a[20:23], v[136:139]
    ds_read_b64_tr_b16 a[180:181], v205 offset:24576
    v_cvt_pk_bf16_f32 v173, v154, v155
    v_mfma_f32_16x16x32_bf16 v[136:139], a[64:67], a[16:19], v[136:139]
    v_exp_f32 v148, v148
    v_mfma_f32_16x16x32_bf16 v[140:143], a[80:83], a[16:19], 4.0
    ds_read_b64_tr_b16 a[182:183], v205 offset:28672
    v_cvt_pk_bf16_f32 v174, v156, v157
    v_mfma_f32_16x16x32_bf16 v[140:143], a[84:87], a[20:23], v[140:143]
    v_exp_f32 v149, v149
    v_mfma_f32_16x16x32_bf16 v[140:143], a[88:91], a[24:27], v[140:143]
    ds_read_b64_tr_b16 a[184:185], v206 offset:24576
    v_cvt_pk_bf16_f32 v175, v158, v159
    v_mfma_f32_16x16x32_bf16 v[140:143], a[92:95], a[28:31], v[140:143]
    v_exp_f32 v150, v150
    v_mfma_f32_16x16x32_bf16 v[132:135], a[92:95], a[12:15], 4.0
    ds_read_b64_tr_b16 a[186:187], v206 offset:28672
    v_cvt_pk_bf16_f32 v170, v148, v149
    v_mfma_f32_16x16x32_bf16 v[132:135], a[88:91], a[8:11], v[132:135]
    v_exp_f32 v151, v151
    v_mfma_f32_16x16x32_bf16 v[132:135], a[84:87], a[4:7], v[132:135]
    ds_read_b64_tr_b16 a[188:189], v207 offset:24576
    v_cvt_pk_bf16_f32 v171, v150, v151
    v_mfma_f32_16x16x32_bf16 v[132:135], a[80:83], a[0:3], v[132:135]
    s_waitcnt lgkmcnt(7)
    ds_read_b64_tr_b16 a[190:191], v207 offset:28672
    v_mfma_f32_16x16x32_bf16 v[64:67], v[248:251], a[128:131], v[64:67]
    v_exp_f32 v128, v128
    v_mfma_f32_16x16x32_bf16 v[64:67], v[240:243], a[160:163], v[64:67]
    v_exp_f32 v129, v129
    v_mfma_f32_16x16x32_bf16 v[96:99], v[244:247], a[160:163], v[96:99]
    v_add_f32 v176, v176, v128
    v_add_f32 v177, v177, v129
    v_mfma_f32_16x16x32_bf16 v[96:99], v[252:255], a[128:131], v[96:99]
    v_exp_f32 v130, v130
    v_mfma_f32_16x16x32_bf16 v[100:103], v[252:255], a[132:135], v[100:103]
    v_exp_f32 v131, v131
    v_mfma_f32_16x16x32_bf16 v[100:103], v[244:247], a[164:167], v[100:103]
    v_add_f32 v176, v176, v130
    v_add_f32 v177, v177, v131
    v_mfma_f32_16x16x32_bf16 v[68:71], v[240:243], a[164:167], v[68:71]
    s_waitcnt lgkmcnt(0)
    v_exp_f32 v136, v136
    v_mfma_f32_16x16x32_bf16 v[68:71], v[248:251], a[132:135], v[68:71]
    v_exp_f32 v137, v137
    v_mfma_f32_16x16x32_bf16 v[72:75], v[248:251], a[136:139], v[72:75]
    v_add_f32 v178, v178, v136
    v_add_f32 v179, v179, v137
    v_mfma_f32_16x16x32_bf16 v[72:75], v[240:243], a[168:171], v[72:75]
    v_exp_f32_e64 v138, v138
    v_mfma_f32_16x16x32_bf16 v[104:107], v[244:247], a[168:171], v[104:107]
    s_mov_b32 m0, s69
    v_exp_f32 v139, v139
    v_mfma_f32_16x16x32_bf16 v[104:107], v[252:255], a[136:139], v[104:107]
    s_lshl_b32 s57, s58, 17
    v_add_f32 v178, v178, v138
    v_add_f32 v179, v179, v139
    v_mfma_f32_16x16x32_bf16 v[108:111], v[252:255], a[140:143], v[108:111]
    ds_read_b128 a[96:99], v196 offset:0
    ds_read_b128 a[100:103], v197 offset:0
    v_mfma_f32_16x16x32_bf16 v[108:111], v[244:247], a[172:175], v[108:111]
    buffer_load_dwordx4 v216, s[24:27], s57 offen offset:0 lds
    v_mfma_f32_16x16x32_bf16 v[76:79], v[240:243], a[172:175], v[76:79]
    s_add_u32 s55, s55, 8
    v_exp_f32 v140, v140
    v_mfma_f32_16x16x32_bf16 v[76:79], v[248:251], a[140:143], v[76:79]
    s_min_u32 s60, s55, s59
    v_exp_f32 v141, v141
    v_mfma_f32_16x16x32_bf16 v[144:147], a[64:67], a[32:35], 4.0
    s_load_dword s58, s[10:11], s60
    v_add_f32 v178, v178, v140
    v_add_f32 v179, v179, v141
    v_mfma_f32_16x16x32_bf16 v[144:147], a[68:71], a[36:39], v[144:147]
    ds_read_b128 a[104:107], v198 offset:0
    ds_read_b128 a[108:111], v199 offset:0
    v_mfma_f32_16x16x32_bf16 v[144:147], a[72:75], a[40:43], v[144:147]
    buffer_load_dwordx4 v217, s[24:27], s57 offen offset:1024 lds
    v_mfma_f32_16x16x32_bf16 v[144:147], a[76:79], a[44:47], v[144:147]
    v_exp_f32 v142, v142
    v_mfma_f32_16x16x32_bf16 v[152:155], a[76:79], a[60:63], 4.0
    v_exp_f32 v143, v143
    v_mfma_f32_16x16x32_bf16 v[152:155], a[72:75], a[56:59], v[152:155]
    v_add_f32 v178, v178, v142
    v_add_f32 v179, v179, v143
    v_mfma_f32_16x16x32_bf16 v[152:155], a[68:71], a[52:55], v[152:155]
    ds_read_b128 a[112:115], v196 offset:4096
    ds_read_b128 a[116:119], v197 offset:4096
    v_mfma_f32_16x16x32_bf16 v[152:155], a[64:67], a[48:51], v[152:155]
    buffer_load_dwordx4 v218, s[24:27], s57 offen offset:2048 lds
    v_mfma_f32_16x16x32_bf16 v[156:159], a[80:83], a[48:51], 4.0
L_hop1_1:
    s_cbranch_vccnz L_main
    v_exp_f32 v132, v132
    v_mfma_f32_16x16x32_bf16 v[156:159], a[84:87], a[52:55], v[156:159]
    v_exp_f32 v133, v133
    v_mfma_f32_16x16x32_bf16 v[156:159], a[88:91], a[56:59], v[156:159]
    v_add_f32 v176, v176, v132
    v_add_f32 v177, v177, v133
    v_mfma_f32_16x16x32_bf16 v[156:159], a[92:95], a[60:63], v[156:159]
    ds_read_b128 a[120:123], v198 offset:4096
    ds_read_b128 a[124:127], v199 offset:4096
    v_mfma_f32_16x16x32_bf16 v[148:151], a[92:95], a[44:47], 4.0
    buffer_load_dwordx4 v219, s[24:27], s57 offen offset:3072 lds
    v_mfma_f32_16x16x32_bf16 v[148:151], a[88:91], a[40:43], v[148:151]
    v_exp_f32 v134, v134
    v_mfma_f32_16x16x32_bf16 v[148:151], a[84:87], a[36:39], v[148:151]
    v_exp_f32 v135, v135
    v_mfma_f32_16x16x32_bf16 v[148:151], a[80:83], a[32:35], v[148:151]
    v_add_f32 v176, v176, v134
    v_add_f32 v177, v177, v135
    v_mfma_f32_16x16x32_bf16 v[80:83], v[248:251], a[144:147], v[80:83]
    v_exp_f32 v144, v144
    v_mfma_f32_16x16x32_bf16 v[80:83], v[240:243], a[176:179], v[80:83]
    v_exp_f32 v145, v145
    v_mfma_f32_16x16x32_bf16 v[112:115], v[244:247], a[176:179], v[112:115]
    ds_read_b64_tr_b16 a[128:129], v200 offset:32768
    v_cvt_pk_bf16_f32 v160, v128, v129
    v_mfma_f32_16x16x32_bf16 v[112:115], v[252:255], a[144:147], v[112:115]
    s_cmp_le_u32 s55, s59
    v_exp_f32 v146, v146
    v_mfma_f32_16x16x32_bf16 v[116:119], v[252:255], a[148:151], v[116:119]
    ds_read_b64_tr_b16 a[130:131], v200 offset:36864
    v_cvt_pk_bf16_f32 v161, v130, v131
    v_mfma_f32_16x16x32_bf16 v[116:119], v[244:247], a[180:183], v[116:119]
    s_cselect_b32 s26, s26, 0
    v_exp_f32 v147, v147
    v_mfma_f32_16x16x32_bf16 v[84:87], v[240:243], a[180:183], v[84:87]
    ds_read_b64_tr_b16 a[132:133], v201 offset:32768
    v_cvt_pk_bf16_f32 v164, v136, v137
    v_mfma_f32_16x16x32_bf16 v[84:87], v[248:251], a[148:151], v[84:87]
    v_exp_f32 v152, v152
    v_mfma_f32_16x16x32_bf16 v[88:91], v[248:251], a[152:155], v[88:91]
    ds_read_b64_tr_b16 a[134:135], v201 offset:36864
    v_cvt_pk_bf16_f32 v165, v138, v139
    v_mfma_f32_16x16x32_bf16 v[88:91], v[240:243], a[184:187], v[88:91]
    v_exp_f32 v153, v153
    v_mfma_f32_16x16x32_bf16 v[120:123], v[244:247], a[184:187], v[120:123]
    ds_read_b64_tr_b16 a[136:137], v202 offset:32768
    v_cvt_pk_bf16_f32 v166, v140, v141
    v_mfma_f32_16x16x32_bf16 v[120:123], v[252:255], a[152:155], v[120:123]
    v_exp_f32 v154, v154
    v_mfma_f32_16x16x32_bf16 v[124:127], v[252:255], a[156:159], v[124:127]
    ds_read_b64_tr_b16 a[138:139], v202 offset:36864
    v_cvt_pk_bf16_f32 v167, v142, v143
    v_mfma_f32_16x16x32_bf16 v[124:127], v[244:247], a[188:191], v[124:127]
    v_exp_f32 v155, v155
    v_mfma_f32_16x16x32_bf16 v[92:95], v[240:243], a[188:191], v[92:95]
    s_cmp_eq_u32 s55, s56
    ds_read_b64_tr_b16 a[140:141], v203 offset:32768
    v_cvt_pk_bf16_f32 v162, v132, v133
    v_mfma_f32_16x16x32_bf16 v[92:95], v[248:251], a[156:159], v[92:95]
    s_waitcnt lgkmcnt(7)
    v_exp_f32 v156, v156
    v_smfmac_f32_16x16x64_bf16 v[188:191], a[192:195], v[248:255], v192
    s_cbranch_scc1 L_tail0
    v_cvt_pk_bf16_f32 v163, v134, v135
    v_mfma_f32_16x16x32_bf16 v[128:131], a[96:99], a[32:35], 4.0
    ds_read_b64_tr_b16 a[142:143], v203 offset:36864
    v_cvt_pk_bf16_f32 v248, v144, v145
    v_mfma_f32_16x16x32_bf16 v[128:131], a[100:103], a[36:39], v[128:131]
    v_exp_f32 v157, v157
    v_mfma_f32_16x16x32_bf16 v[128:131], a[104:107], a[40:43], v[128:131]
    ds_read_b64_tr_b16 a[144:145], v204 offset:32768
    v_cvt_pk_bf16_f32 v249, v146, v147
    v_mfma_f32_16x16x32_bf16 v[128:131], a[108:111], a[44:47], v[128:131]
    v_exp_f32 v158, v158
    v_mfma_f32_16x16x32_bf16 v[136:139], a[108:111], a[60:63], 4.0
    ds_read_b64_tr_b16 a[146:147], v204 offset:36864
    v_cvt_pk_bf16_f32 v252, v152, v153
    v_mfma_f32_16x16x32_bf16 v[136:139], a[104:107], a[56:59], v[136:139]
    v_exp_f32 v159, v159
    v_mfma_f32_16x16x32_bf16 v[136:139], a[100:103], a[52:55], v[136:139]
    ds_read_b64_tr_b16 a[148:149], v205 offset:32768
    v_cvt_pk_bf16_f32 v253, v154, v155
    v_mfma_f32_16x16x32_bf16 v[136:139], a[96:99], a[48:51], v[136:139]
    v_exp_f32 v148, v148
    v_mfma_f32_16x16x32_bf16 v[140:143], a[112:115], a[48:51], 4.0
    ds_read_b64_tr_b16 a[150:151], v205 offset:36864
    v_cvt_pk_bf16_f32 v254, v156, v157
    v_mfma_f32_16x16x32_bf16 v[140:143], a[116:119], a[52:55], v[140:143]
    v_exp_f32 v149, v149
    v_mfma_f32_16x16x32_bf16 v[140:143], a[120:123], a[56:59], v[140:143]
    ds_read_b64_tr_b16 a[152:153], v206 offset:32768
    v_cvt_pk_bf16_f32 v255, v158, v159
    v_mfma_f32_16x16x32_bf16 v[140:143], a[124:127], a[60:63], v[140:143]
    v_exp_f32 v150, v150
    v_mfma_f32_16x16x32_bf16 v[132:135], a[124:127], a[44:47], 4.0
    ds_read_b64_tr_b16 a[154:155], v206 offset:36864
    v_cvt_pk_bf16_f32 v250, v148, v149
    v_mfma_f32_16x16x32_bf16 v[132:135], a[120:123], a[40:43], v[132:135]
    v_exp_f32 v151, v151
    v_mfma_f32_16x16x32_bf16 v[132:135], a[116:119], a[36:39], v[132:135]
    ds_read_b64_tr_b16 a[156:157], v207 offset:32768
    v_cvt_pk_bf16_f32 v251, v150, v151
    v_mfma_f32_16x16x32_bf16 v[132:135], a[112:115], a[32:35], v[132:135]
    s_waitcnt lgkmcnt(7)
    ds_read_b64_tr_b16 a[158:159], v207 offset:36864
    v_mfma_f32_16x16x32_bf16 v[0:3], v[168:171], a[160:163], v[0:3]
    v_exp_f32 v128, v128
    v_mfma_f32_16x16x32_bf16 v[0:3], v[160:163], a[128:131], v[0:3]
    v_exp_f32 v129, v129
    v_mfma_f32_16x16x32_bf16 v[32:35], v[164:167], a[128:131], v[32:35]
    v_add_f32 v180, v180, v128
    v_add_f32 v181, v181, v129
    v_mfma_f32_16x16x32_bf16 v[32:35], v[172:175], a[160:163], v[32:35]
    v_exp_f32 v130, v130
    v_mfma_f32_16x16x32_bf16 v[36:39], v[172:175], a[164:167], v[36:39]
    v_exp_f32 v131, v131
    v_mfma_f32_16x16x32_bf16 v[36:39], v[164:167], a[132:135], v[36:39]
    v_add_f32 v180, v180, v130
    v_add_f32 v181, v181, v131
    v_mfma_f32_16x16x32_bf16 v[4:7], v[160:163], a[132:135], v[4:7]
    s_waitcnt vmcnt(4) lgkmcnt(0)
    v_exp_f32 v136, v136
    v_mfma_f32_16x16x32_bf16 v[4:7], v[168:171], a[164:167], v[4:7]
    s_barrier
    v_exp_f32 v137, v137
    v_mfma_f32_16x16x32_bf16 v[8:11], v[168:171], a[168:171], v[8:11]
    v_add_f32 v182, v182, v136
    v_add_f32 v183, v183, v137
    v_mfma_f32_16x16x32_bf16 v[8:11], v[160:163], a[136:139], v[8:11]
    v_exp_f32 v138, v138
    v_mfma_f32_16x16x32_bf16 v[40:43], v[164:167], a[136:139], v[40:43]
    s_mov_b32 m0, s16
    v_exp_f32 v139, v139
    v_mfma_f32_16x16x32_bf16 v[40:43], v[172:175], a[168:171], v[40:43]
    s_lshl_b32 s57, s58, 17
    v_add_f32 v182, v182, v138
    v_add_f32 v183, v183, v139
    v_mfma_f32_16x16x32_bf16 v[44:47], v[172:175], a[172:175], v[44:47]
    ds_read_b128 a[64:67], v196 offset:8192
    ds_read_b128 a[68:71], v197 offset:8192
    v_mfma_f32_16x16x32_bf16 v[44:47], v[164:167], a[140:143], v[44:47]
    buffer_load_dwordx4 v216, s[24:27], s57 offen offset:0 lds
    v_mfma_f32_16x16x32_bf16 v[12:15], v[160:163], a[140:143], v[12:15]
    s_add_u32 s55, s55, 8
    v_exp_f32 v140, v140
    v_mfma_f32_16x16x32_bf16 v[12:15], v[168:171], a[172:175], v[12:15]
    s_min_u32 s60, s55, s59
    v_exp_f32 v141, v141
    v_mfma_f32_16x16x32_bf16 v[144:147], a[96:99], a[0:3], 4.0
    s_load_dword s58, s[10:11], s60
    v_add_f32 v182, v182, v140
    v_add_f32 v183, v183, v141
    v_mfma_f32_16x16x32_bf16 v[144:147], a[100:103], a[4:7], v[144:147]
    ds_read_b128 a[72:75], v198 offset:8192
    ds_read_b128 a[76:79], v199 offset:8192
    v_mfma_f32_16x16x32_bf16 v[144:147], a[104:107], a[8:11], v[144:147]
    buffer_load_dwordx4 v217, s[24:27], s57 offen offset:1024 lds
    v_mfma_f32_16x16x32_bf16 v[144:147], a[108:111], a[12:15], v[144:147]
    v_exp_f32 v142, v142
    v_mfma_f32_16x16x32_bf16 v[152:155], a[108:111], a[28:31], 4.0
    v_exp_f32 v143, v143
    v_mfma_f32_16x16x32_bf16 v[152:155], a[104:107], a[24:27], v[152:155]
    v_add_f32 v182, v182, v142
    v_add_f32 v183, v183, v143
    v_mfma_f32_16x16x32_bf16 v[152:155], a[100:103], a[20:23], v[152:155]
    ds_read_b128 a[80:83], v196 offset:12288
    ds_read_b128 a[84:87], v197 offset:12288
    v_mfma_f32_16x16x32_bf16 v[152:155], a[96:99], a[16:19], v[152:155]
    buffer_load_dwordx4 v218, s[24:27], s57 offen offset:2048 lds
    v_mfma_f32_16x16x32_bf16 v[156:159], a[112:115], a[16:19], 4.0
    v_exp_f32 v132, v132
    v_mfma_f32_16x16x32_bf16 v[156:159], a[116:119], a[20:23], v[156:159]
    v_exp_f32 v133, v133
    v_mfma_f32_16x16x32_bf16 v[156:159], a[120:123], a[24:27], v[156:159]
    v_add_f32 v180, v180, v132
    v_add_f32 v181, v181, v133
    v_mfma_f32_16x16x32_bf16 v[156:159], a[124:127], a[28:31], v[156:159]
    ds_read_b128 a[88:91], v198 offset:12288
    ds_read_b128 a[92:95], v199 offset:12288
    v_mfma_f32_16x16x32_bf16 v[148:151], a[124:127], a[12:15], 4.0
    buffer_load_dwordx4 v219, s[24:27], s57 offen offset:3072 lds
    v_mfma_f32_16x16x32_bf16 v[148:151], a[120:123], a[8:11], v[148:151]
    v_exp_f32 v134, v134
    v_mfma_f32_16x16x32_bf16 v[148:151], a[116:119], a[4:7], v[148:151]
    v_exp_f32 v135, v135
    v_mfma_f32_16x16x32_bf16 v[148:151], a[112:115], a[0:3], v[148:151]
    v_add_f32 v180, v180, v134
    v_add_f32 v181, v181, v135
    v_mfma_f32_16x16x32_bf16 v[16:19], v[168:171], a[176:179], v[16:19]
    v_exp_f32 v144, v144
    v_mfma_f32_16x16x32_bf16 v[16:19], v[160:163], a[144:147], v[16:19]
    v_exp_f32 v145, v145
    v_mfma_f32_16x16x32_bf16 v[48:51], v[164:167], a[144:147], v[48:51]
    ds_read_b64_tr_b16 a[160:161], v200 offset:0
    v_cvt_pk_bf16_f32 v240, v128, v129
    v_mfma_f32_16x16x32_bf16 v[48:51], v[172:175], a[176:179], v[48:51]
    s_cmp_le_u32 s55, s59
    v_exp_f32 v146, v146
    v_mfma_f32_16x16x32_bf16 v[52:55], v[172:175], a[180:183], v[52:55]
    ds_read_b64_tr_b16 a[162:163], v200 offset:4096
    v_cvt_pk_bf16_f32 v241, v130, v131
    v_mfma_f32_16x16x32_bf16 v[52:55], v[164:167], a[148:151], v[52:55]
    s_cselect_b32 s26, s26, 0
    v_exp_f32 v147, v147
    v_mfma_f32_16x16x32_bf16 v[20:23], v[160:163], a[148:151], v[20:23]
    ds_read_b64_tr_b16 a[164:165], v201 offset:0
    v_cvt_pk_bf16_f32 v244, v136, v137
    v_mfma_f32_16x16x32_bf16 v[20:23], v[168:171], a[180:183], v[20:23]
    v_exp_f32 v152, v152
    v_mfma_f32_16x16x32_bf16 v[24:27], v[168:171], a[184:187], v[24:27]
    ds_read_b64_tr_b16 a[166:167], v201 offset:4096
    v_cvt_pk_bf16_f32 v245, v138, v139
    v_mfma_f32_16x16x32_bf16 v[24:27], v[160:163], a[152:155], v[24:27]
    v_exp_f32 v153, v153
    v_mfma_f32_16x16x32_bf16 v[56:59], v[164:167], a[152:155], v[56:59]
    ds_read_b64_tr_b16 a[168:169], v202 offset:0
    v_cvt_pk_bf16_f32 v246, v140, v141
    v_mfma_f32_16x16x32_bf16 v[56:59], v[172:175], a[184:187], v[56:59]
    v_exp_f32 v154, v154
    v_mfma_f32_16x16x32_bf16 v[60:63], v[172:175], a[188:191], v[60:63]
    ds_read_b64_tr_b16 a[170:171], v202 offset:4096
    v_cvt_pk_bf16_f32 v247, v142, v143
    v_mfma_f32_16x16x32_bf16 v[60:63], v[164:167], a[156:159], v[60:63]
    v_exp_f32 v155, v155
    v_mfma_f32_16x16x32_bf16 v[28:31], v[160:163], a[156:159], v[28:31]
    s_cmp_eq_u32 s55, s56
    ds_read_b64_tr_b16 a[172:173], v203 offset:0
    v_cvt_pk_bf16_f32 v242, v132, v133
    v_mfma_f32_16x16x32_bf16 v[28:31], v[168:171], a[188:191], v[28:31]
    s_waitcnt lgkmcnt(7)
    v_exp_f32 v156, v156
    v_smfmac_f32_16x16x64_bf16 v[184:187], a[192:195], v[168:175], v192
    s_cbranch_scc1 L_tail1
    v_cvt_pk_bf16_f32 v243, v134, v135
    v_mfma_f32_16x16x32_bf16 v[128:131], a[64:67], a[0:3], 4.0
    ds_read_b64_tr_b16 a[174:175], v203 offset:4096
    v_cvt_pk_bf16_f32 v168, v144, v145
    v_mfma_f32_16x16x32_bf16 v[128:131], a[68:71], a[4:7], v[128:131]
    v_exp_f32 v157, v157
    v_mfma_f32_16x16x32_bf16 v[128:131], a[72:75], a[8:11], v[128:131]
    ds_read_b64_tr_b16 a[176:177], v204 offset:0
    v_cvt_pk_bf16_f32 v169, v146, v147
    v_mfma_f32_16x16x32_bf16 v[128:131], a[76:79], a[12:15], v[128:131]
    v_exp_f32 v158, v158
    v_mfma_f32_16x16x32_bf16 v[136:139], a[76:79], a[28:31], 4.0
    ds_read_b64_tr_b16 a[178:179], v204 offset:4096
    v_cvt_pk_bf16_f32 v172, v152, v153
    v_mfma_f32_16x16x32_bf16 v[136:139], a[72:75], a[24:27], v[136:139]
    v_exp_f32 v159, v159
    v_mfma_f32_16x16x32_bf16 v[136:139], a[68:71], a[20:23], v[136:139]
    ds_read_b64_tr_b16 a[180:181], v205 offset:0
    v_cvt_pk_bf16_f32 v173, v154, v155
    v_mfma_f32_16x16x32_bf16 v[136:139], a[64:67], a[16:19], v[136:139]
    v_exp_f32 v148, v148
    v_mfma_f32_16x16x32_bf16 v[140:143], a[80:83], a[16:19], 4.0
    ds_read_b64_tr_b16 a[182:183], v205 offset:4096
    v_cvt_pk_bf16_f32 v174, v156, v157
    v_mfma_f32_16x16x32_bf16 v[140:143], a[84:87], a[20:23], v[140:143]
    v_exp_f32 v149, v149
    v_mfma_f32_16x16x32_bf16 v[140:143], a[88:91], a[24:27], v[140:143]
    ds_read_b64_tr_b16 a[184:185], v206 offset:0
    v_cvt_pk_bf16_f32 v175, v158, v159
    v_mfma_f32_16x16x32_bf16 v[140:143], a[92:95], a[28:31], v[140:143]
    v_exp_f32 v150, v150
    v_mfma_f32_16x16x32_bf16 v[132:135], a[92:95], a[12:15], 4.0
    ds_read_b64_tr_b16 a[186:187], v206 offset:4096
    v_cvt_pk_bf16_f32 v170, v148, v149
    v_mfma_f32_16x16x32_bf16 v[132:135], a[88:91], a[8:11], v[132:135]
    v_exp_f32 v151, v151
    v_mfma_f32_16x16x32_bf16 v[132:135], a[84:87], a[4:7], v[132:135]
    ds_read_b64_tr_b16 a[188:189], v207 offset:0
    v_cvt_pk_bf16_f32 v171, v150, v151
    v_mfma_f32_16x16x32_bf16 v[132:135], a[80:83], a[0:3], v[132:135]
    s_waitcnt lgkmcnt(7)
    ds_read_b64_tr_b16 a[190:191], v207 offset:4096
    v_mfma_f32_16x16x32_bf16 v[64:67], v[248:251], a[128:131], v[64:67]
    v_exp_f32 v128, v128
    v_mfma_f32_16x16x32_bf16 v[64:67], v[240:243], a[160:163], v[64:67]
    v_exp_f32 v129, v129
    v_mfma_f32_16x16x32_bf16 v[96:99], v[244:247], a[160:163], v[96:99]
    v_add_f32 v176, v176, v128
    v_add_f32 v177, v177, v129
    v_mfma_f32_16x16x32_bf16 v[96:99], v[252:255], a[128:131], v[96:99]
    v_exp_f32 v130, v130
    v_mfma_f32_16x16x32_bf16 v[100:103], v[252:255], a[132:135], v[100:103]
    v_exp_f32 v131, v131
    v_mfma_f32_16x16x32_bf16 v[100:103], v[244:247], a[164:167], v[100:103]
    v_add_f32 v176, v176, v130
    v_add_f32 v177, v177, v131
    v_mfma_f32_16x16x32_bf16 v[68:71], v[240:243], a[164:167], v[68:71]
    s_waitcnt lgkmcnt(0)
    v_exp_f32 v136, v136
    v_mfma_f32_16x16x32_bf16 v[68:71], v[248:251], a[132:135], v[68:71]
    v_exp_f32 v137, v137
    v_mfma_f32_16x16x32_bf16 v[72:75], v[248:251], a[136:139], v[72:75]
    v_add_f32 v178, v178, v136
    v_add_f32 v179, v179, v137
    v_mfma_f32_16x16x32_bf16 v[72:75], v[240:243], a[168:171], v[72:75]
    v_exp_f32 v138, v138
    v_mfma_f32_16x16x32_bf16 v[104:107], v[244:247], a[168:171], v[104:107]
    s_mov_b32 m0, s66
    v_exp_f32 v139, v139
    v_mfma_f32_16x16x32_bf16 v[104:107], v[252:255], a[136:139], v[104:107]
    s_lshl_b32 s57, s58, 17
    v_add_f32 v178, v178, v138
    v_add_f32 v179, v179, v139
    v_mfma_f32_16x16x32_bf16 v[108:111], v[252:255], a[140:143], v[108:111]
    ds_read_b128 a[96:99], v196 offset:16384
    ds_read_b128 a[100:103], v197 offset:16384
    v_mfma_f32_16x16x32_bf16 v[108:111], v[244:247], a[172:175], v[108:111]
    buffer_load_dwordx4 v216, s[24:27], s57 offen offset:0 lds
    v_mfma_f32_16x16x32_bf16 v[76:79], v[240:243], a[172:175], v[76:79]
    s_add_u32 s55, s55, 8
    v_exp_f32 v140, v140
    v_mfma_f32_16x16x32_bf16 v[76:79], v[248:251], a[140:143], v[76:79]
    s_min_u32 s60, s55, s59
    v_exp_f32 v141, v141
    v_mfma_f32_16x16x32_bf16 v[144:147], a[64:67], a[32:35], 4.0
    s_load_dword s58, s[10:11], s60
    v_add_f32 v178, v178, v140
    v_add_f32 v179, v179, v141
    v_mfma_f32_16x16x32_bf16 v[144:147], a[68:71], a[36:39], v[144:147]
    ds_read_b128 a[104:107], v198 offset:16384
    ds_read_b128 a[108:111], v199 offset:16384
    v_mfma_f32_16x16x32_bf16 v[144:147], a[72:75], a[40:43], v[144:147]
    buffer_load_dwordx4 v217, s[24:27], s57 offen offset:1024 lds
    v_mfma_f32_16x16x32_bf16 v[144:147], a[76:79], a[44:47], v[144:147]
    v_exp_f32 v142, v142
    v_mfma_f32_16x16x32_bf16 v[152:155], a[76:79], a[60:63], 4.0
    v_exp_f32 v143, v143
    v_mfma_f32_16x16x32_bf16 v[152:155], a[72:75], a[56:59], v[152:155]
    v_add_f32 v178, v178, v142
    v_add_f32 v179, v179, v143
    v_mfma_f32_16x16x32_bf16 v[152:155], a[68:71], a[52:55], v[152:155]
    ds_read_b128 a[112:115], v196 offset:20480
    ds_read_b128 a[116:119], v197 offset:20480
    v_mfma_f32_16x16x32_bf16 v[152:155], a[64:67], a[48:51], v[152:155]
    buffer_load_dwordx4 v218, s[24:27], s57 offen offset:2048 lds
    v_mfma_f32_16x16x32_bf16 v[156:159], a[80:83], a[48:51], 4.0
    v_exp_f32 v132, v132
    v_mfma_f32_16x16x32_bf16 v[156:159], a[84:87], a[52:55], v[156:159]
    v_exp_f32 v133, v133
    v_mfma_f32_16x16x32_bf16 v[156:159], a[88:91], a[56:59], v[156:159]
    v_add_f32 v176, v176, v132
    v_add_f32 v177, v177, v133
    v_mfma_f32_16x16x32_bf16 v[156:159], a[92:95], a[60:63], v[156:159]
    ds_read_b128 a[120:123], v198 offset:20480
    ds_read_b128 a[124:127], v199 offset:20480
    v_mfma_f32_16x16x32_bf16 v[148:151], a[92:95], a[44:47], 4.0
    buffer_load_dwordx4 v219, s[24:27], s57 offen offset:3072 lds
    v_mfma_f32_16x16x32_bf16 v[148:151], a[88:91], a[40:43], v[148:151]
    v_exp_f32 v134, v134
    v_mfma_f32_16x16x32_bf16 v[148:151], a[84:87], a[36:39], v[148:151]
    v_exp_f32 v135, v135
    v_mfma_f32_16x16x32_bf16 v[148:151], a[80:83], a[32:35], v[148:151]
    v_add_f32 v176, v176, v134
    v_add_f32 v177, v177, v135
    v_mfma_f32_16x16x32_bf16 v[80:83], v[248:251], a[144:147], v[80:83]
    v_exp_f32 v144, v144
    v_mfma_f32_16x16x32_bf16 v[80:83], v[240:243], a[176:179], v[80:83]
    v_exp_f32 v145, v145
    v_mfma_f32_16x16x32_bf16 v[112:115], v[244:247], a[176:179], v[112:115]
    ds_read_b64_tr_b16 a[128:129], v200 offset:8192
    v_cvt_pk_bf16_f32 v160, v128, v129
    v_mfma_f32_16x16x32_bf16 v[112:115], v[252:255], a[144:147], v[112:115]
    s_cmp_le_u32 s55, s59
    v_exp_f32 v146, v146
    v_mfma_f32_16x16x32_bf16 v[116:119], v[252:255], a[148:151], v[116:119]
    ds_read_b64_tr_b16 a[130:131], v200 offset:12288
    v_cvt_pk_bf16_f32 v161, v130, v131
    v_mfma_f32_16x16x32_bf16 v[116:119], v[244:247], a[180:183], v[116:119]
    s_cselect_b32 s26, s26, 0
    v_exp_f32 v147, v147
    v_mfma_f32_16x16x32_bf16 v[84:87], v[240:243], a[180:183], v[84:87]
    ds_read_b64_tr_b16 a[132:133], v201 offset:8192
    v_cvt_pk_bf16_f32 v164, v136, v137
    v_mfma_f32_16x16x32_bf16 v[84:87], v[248:251], a[148:151], v[84:87]
    v_exp_f32 v152, v152
    v_mfma_f32_16x16x32_bf16 v[88:91], v[248:251], a[152:155], v[88:91]
    ds_read_b64_tr_b16 a[134:135], v201 offset:12288
    v_cvt_pk_bf16_f32 v165, v138, v139
    v_mfma_f32_16x16x32_bf16 v[88:91], v[240:243], a[184:187], v[88:91]
    v_exp_f32 v153, v153
    v_mfma_f32_16x16x32_bf16 v[120:123], v[244:247], a[184:187], v[120:123]
    ds_read_b64_tr_b16 a[136:137], v202 offset:8192
    v_cvt_pk_bf16_f32 v166, v140, v141
    v_mfma_f32_16x16x32_bf16 v[120:123], v[252:255], a[152:155], v[120:123]
    v_exp_f32 v154, v154
    v_mfma_f32_16x16x32_bf16 v[124:127], v[252:255], a[156:159], v[124:127]
    ds_read_b64_tr_b16 a[138:139], v202 offset:12288
    v_cvt_pk_bf16_f32 v167, v142, v143
    v_mfma_f32_16x16x32_bf16 v[124:127], v[244:247], a[188:191], v[124:127]
    v_exp_f32 v155, v155
    v_mfma_f32_16x16x32_bf16 v[92:95], v[240:243], a[188:191], v[92:95]
    s_cmp_eq_u32 s55, s56
    ds_read_b64_tr_b16 a[140:141], v203 offset:8192
    v_cvt_pk_bf16_f32 v162, v132, v133
    v_mfma_f32_16x16x32_bf16 v[92:95], v[248:251], a[156:159], v[92:95]
    s_waitcnt lgkmcnt(7)
    v_exp_f32 v156, v156
    v_smfmac_f32_16x16x64_bf16 v[188:191], a[192:195], v[248:255], v192
    s_cbranch_scc1 L_tail0
    v_cvt_pk_bf16_f32 v163, v134, v135
    v_mfma_f32_16x16x32_bf16 v[128:131], a[96:99], a[32:35], 4.0
    ds_read_b64_tr_b16 a[142:143], v203 offset:12288
    v_cvt_pk_bf16_f32 v248, v144, v145
    v_mfma_f32_16x16x32_bf16 v[128:131], a[100:103], a[36:39], v[128:131]
    v_exp_f32 v157, v157
    v_mfma_f32_16x16x32_bf16 v[128:131], a[104:107], a[40:43], v[128:131]
    ds_read_b64_tr_b16 a[144:145], v204 offset:8192
    v_cvt_pk_bf16_f32 v249, v146, v147
    v_mfma_f32_16x16x32_bf16 v[128:131], a[108:111], a[44:47], v[128:131]
    v_exp_f32 v158, v158
    v_mfma_f32_16x16x32_bf16 v[136:139], a[108:111], a[60:63], 4.0
    ds_read_b64_tr_b16 a[146:147], v204 offset:12288
    v_cvt_pk_bf16_f32 v252, v152, v153
    v_mfma_f32_16x16x32_bf16 v[136:139], a[104:107], a[56:59], v[136:139]
    v_exp_f32 v159, v159
    v_mfma_f32_16x16x32_bf16 v[136:139], a[100:103], a[52:55], v[136:139]
    ds_read_b64_tr_b16 a[148:149], v205 offset:8192
    v_cvt_pk_bf16_f32 v253, v154, v155
    v_mfma_f32_16x16x32_bf16 v[136:139], a[96:99], a[48:51], v[136:139]
    v_exp_f32 v148, v148
    v_mfma_f32_16x16x32_bf16 v[140:143], a[112:115], a[48:51], 4.0
    ds_read_b64_tr_b16 a[150:151], v205 offset:12288
    v_cvt_pk_bf16_f32 v254, v156, v157
    v_mfma_f32_16x16x32_bf16 v[140:143], a[116:119], a[52:55], v[140:143]
    v_exp_f32 v149, v149
    v_mfma_f32_16x16x32_bf16 v[140:143], a[120:123], a[56:59], v[140:143]
    ds_read_b64_tr_b16 a[152:153], v206 offset:8192
    v_cvt_pk_bf16_f32 v255, v158, v159
    v_mfma_f32_16x16x32_bf16 v[140:143], a[124:127], a[60:63], v[140:143]
    v_exp_f32 v150, v150
    v_mfma_f32_16x16x32_bf16 v[132:135], a[124:127], a[44:47], 4.0
    ds_read_b64_tr_b16 a[154:155], v206 offset:12288
    v_cvt_pk_bf16_f32 v250, v148, v149
    v_mfma_f32_16x16x32_bf16 v[132:135], a[120:123], a[40:43], v[132:135]
    v_exp_f32 v151, v151
    v_mfma_f32_16x16x32_bf16 v[132:135], a[116:119], a[36:39], v[132:135]
    ds_read_b64_tr_b16 a[156:157], v207 offset:8192
    v_cvt_pk_bf16_f32 v251, v150, v151
    v_mfma_f32_16x16x32_bf16 v[132:135], a[112:115], a[32:35], v[132:135]
    s_waitcnt lgkmcnt(7)
    ds_read_b64_tr_b16 a[158:159], v207 offset:12288
    v_mfma_f32_16x16x32_bf16 v[0:3], v[168:171], a[160:163], v[0:3]
    v_exp_f32 v128, v128
    v_mfma_f32_16x16x32_bf16 v[0:3], v[160:163], a[128:131], v[0:3]
    v_exp_f32 v129, v129
    v_mfma_f32_16x16x32_bf16 v[32:35], v[164:167], a[128:131], v[32:35]
    v_add_f32 v180, v180, v128
    v_add_f32 v181, v181, v129
    v_mfma_f32_16x16x32_bf16 v[32:35], v[172:175], a[160:163], v[32:35]
    v_exp_f32 v130, v130
    v_mfma_f32_16x16x32_bf16 v[36:39], v[172:175], a[164:167], v[36:39]
    v_exp_f32 v131, v131
    v_mfma_f32_16x16x32_bf16 v[36:39], v[164:167], a[132:135], v[36:39]
    v_add_f32 v180, v180, v130
    v_add_f32 v181, v181, v131
    v_mfma_f32_16x16x32_bf16 v[4:7], v[160:163], a[132:135], v[4:7]
    s_waitcnt vmcnt(4) lgkmcnt(0)
    v_exp_f32 v136, v136
    v_mfma_f32_16x16x32_bf16 v[4:7], v[168:171], a[164:167], v[4:7]
    s_barrier
    v_exp_f32 v137, v137
    v_mfma_f32_16x16x32_bf16 v[8:11], v[168:171], a[168:171], v[8:11]
    v_add_f32 v182, v182, v136
    v_add_f32 v183, v183, v137
    v_mfma_f32_16x16x32_bf16 v[8:11], v[160:163], a[136:139], v[8:11]
    v_exp_f32 v138, v138
    v_mfma_f32_16x16x32_bf16 v[40:43], v[164:167], a[136:139], v[40:43]
    s_mov_b32 m0, s67
    v_exp_f32 v139, v139
    v_mfma_f32_16x16x32_bf16 v[40:43], v[172:175], a[168:171], v[40:43]
    s_lshl_b32 s57, s58, 17
    v_add_f32 v182, v182, v138
    v_add_f32 v183, v183, v139
    v_mfma_f32_16x16x32_bf16 v[44:47], v[172:175], a[172:175], v[44:47]
    ds_read_b128 a[64:67], v196 offset:24576
    ds_read_b128 a[68:71], v197 offset:24576
    v_mfma_f32_16x16x32_bf16 v[44:47], v[164:167], a[140:143], v[44:47]
    buffer_load_dwordx4 v216, s[24:27], s57 offen offset:0 lds
    v_mfma_f32_16x16x32_bf16 v[12:15], v[160:163], a[140:143], v[12:15]
    s_add_u32 s55, s55, 8
    v_exp_f32 v140, v140
    v_mfma_f32_16x16x32_bf16 v[12:15], v[168:171], a[172:175], v[12:15]
    s_min_u32 s60, s55, s59
    v_exp_f32 v141, v141
    v_mfma_f32_16x16x32_bf16 v[144:147], a[96:99], a[0:3], 4.0
    s_load_dword s58, s[10:11], s60
    v_add_f32 v182, v182, v140
    v_add_f32 v183, v183, v141
    v_mfma_f32_16x16x32_bf16 v[144:147], a[100:103], a[4:7], v[144:147]
    ds_read_b128 a[72:75], v198 offset:24576
    ds_read_b128 a[76:79], v199 offset:24576
    v_mfma_f32_16x16x32_bf16 v[144:147], a[104:107], a[8:11], v[144:147]
    buffer_load_dwordx4 v217, s[24:27], s57 offen offset:1024 lds
    v_mfma_f32_16x16x32_bf16 v[144:147], a[108:111], a[12:15], v[144:147]
    v_exp_f32 v142, v142
    v_mfma_f32_16x16x32_bf16 v[152:155], a[108:111], a[28:31], 4.0
    v_exp_f32 v143, v143
    v_mfma_f32_16x16x32_bf16 v[152:155], a[104:107], a[24:27], v[152:155]
    v_add_f32 v182, v182, v142
    v_add_f32 v183, v183, v143
    v_mfma_f32_16x16x32_bf16 v[152:155], a[100:103], a[20:23], v[152:155]
    ds_read_b128 a[80:83], v196 offset:28672
    ds_read_b128 a[84:87], v197 offset:28672
    v_mfma_f32_16x16x32_bf16 v[152:155], a[96:99], a[16:19], v[152:155]
    buffer_load_dwordx4 v218, s[24:27], s57 offen offset:2048 lds
    v_mfma_f32_16x16x32_bf16 v[156:159], a[112:115], a[16:19], 4.0
    v_exp_f32 v132, v132
    v_mfma_f32_16x16x32_bf16 v[156:159], a[116:119], a[20:23], v[156:159]
    v_exp_f32 v133, v133
    v_mfma_f32_16x16x32_bf16 v[156:159], a[120:123], a[24:27], v[156:159]
    v_add_f32 v180, v180, v132
    v_add_f32 v181, v181, v133
    v_mfma_f32_16x16x32_bf16 v[156:159], a[124:127], a[28:31], v[156:159]
    ds_read_b128 a[88:91], v198 offset:28672
    ds_read_b128 a[92:95], v199 offset:28672
    v_mfma_f32_16x16x32_bf16 v[148:151], a[124:127], a[12:15], 4.0
    buffer_load_dwordx4 v219, s[24:27], s57 offen offset:3072 lds
    v_mfma_f32_16x16x32_bf16 v[148:151], a[120:123], a[8:11], v[148:151]
    v_exp_f32 v134, v134
    v_mfma_f32_16x16x32_bf16 v[148:151], a[116:119], a[4:7], v[148:151]
    v_exp_f32 v135, v135
    v_mfma_f32_16x16x32_bf16 v[148:151], a[112:115], a[0:3], v[148:151]
    v_add_f32 v180, v180, v134
    v_add_f32 v181, v181, v135
    v_mfma_f32_16x16x32_bf16 v[16:19], v[168:171], a[176:179], v[16:19]
    v_exp_f32 v144, v144
    v_mfma_f32_16x16x32_bf16 v[16:19], v[160:163], a[144:147], v[16:19]
    v_exp_f32 v145, v145
    v_mfma_f32_16x16x32_bf16 v[48:51], v[164:167], a[144:147], v[48:51]
    ds_read_b64_tr_b16 a[160:161], v200 offset:16384
    v_cvt_pk_bf16_f32 v240, v128, v129
    v_mfma_f32_16x16x32_bf16 v[48:51], v[172:175], a[176:179], v[48:51]
    s_cmp_le_u32 s55, s59
    v_exp_f32 v146, v146
    v_mfma_f32_16x16x32_bf16 v[52:55], v[172:175], a[180:183], v[52:55]
    ds_read_b64_tr_b16 a[162:163], v200 offset:20480
    v_cvt_pk_bf16_f32 v241, v130, v131
    v_mfma_f32_16x16x32_bf16 v[52:55], v[164:167], a[148:151], v[52:55]
    s_cselect_b32 s26, s26, 0
    v_exp_f32 v147, v147
    v_mfma_f32_16x16x32_bf16 v[20:23], v[160:163], a[148:151], v[20:23]
    ds_read_b64_tr_b16 a[164:165], v201 offset:16384
    v_cvt_pk_bf16_f32 v244, v136, v137
    v_mfma_f32_16x16x32_bf16 v[20:23], v[168:171], a[180:183], v[20:23]
    v_exp_f32 v152, v152
    v_mfma_f32_16x16x32_bf16 v[24:27], v[168:171], a[184:187], v[24:27]
    ds_read_b64_tr_b16 a[166:167], v201 offset:20480
    v_cvt_pk_bf16_f32 v245, v138, v139
    v_mfma_f32_16x16x32_bf16 v[24:27], v[160:163], a[152:155], v[24:27]
    v_exp_f32 v153, v153
    v_mfma_f32_16x16x32_bf16 v[56:59], v[164:167], a[152:155], v[56:59]
    ds_read_b64_tr_b16 a[168:169], v202 offset:16384
    v_cvt_pk_bf16_f32 v246, v140, v141
    v_mfma_f32_16x16x32_bf16 v[56:59], v[172:175], a[184:187], v[56:59]
    v_exp_f32 v154, v154
    v_mfma_f32_16x16x32_bf16 v[60:63], v[172:175], a[188:191], v[60:63]
    ds_read_b64_tr_b16 a[170:171], v202 offset:20480
    v_cvt_pk_bf16_f32 v247, v142, v143
    v_mfma_f32_16x16x32_bf16 v[60:63], v[164:167], a[156:159], v[60:63]
    v_exp_f32 v155, v155
    v_mfma_f32_16x16x32_bf16 v[28:31], v[160:163], a[156:159], v[28:31]
    s_cmp_eq_u32 s55, s56
    ds_read_b64_tr_b16 a[172:173], v203 offset:16384
    v_cvt_pk_bf16_f32 v242, v132, v133
    v_mfma_f32_16x16x32_bf16 v[28:31], v[168:171], a[188:191], v[28:31]
    s_waitcnt lgkmcnt(7)
    v_exp_f32 v156, v156
    v_smfmac_f32_16x16x64_bf16 v[184:187], a[192:195], v[168:175], v192
    s_cbranch_scc1 L_tail1
    v_cvt_pk_bf16_f32 v243, v134, v135
    v_mfma_f32_16x16x32_bf16 v[128:131], a[64:67], a[0:3], 4.0
    ds_read_b64_tr_b16 a[174:175], v203 offset:20480
    v_cvt_pk_bf16_f32 v168, v144, v145
    v_mfma_f32_16x16x32_bf16 v[128:131], a[68:71], a[4:7], v[128:131]
    v_exp_f32 v157, v157
    v_mfma_f32_16x16x32_bf16 v[128:131], a[72:75], a[8:11], v[128:131]
    ds_read_b64_tr_b16 a[176:177], v204 offset:16384
    v_cvt_pk_bf16_f32 v169, v146, v147
    v_mfma_f32_16x16x32_bf16 v[128:131], a[76:79], a[12:15], v[128:131]
    v_exp_f32 v158, v158
    v_mfma_f32_16x16x32_bf16 v[136:139], a[76:79], a[28:31], 4.0
    ds_read_b64_tr_b16 a[178:179], v204 offset:20480
    v_cvt_pk_bf16_f32 v172, v152, v153
    v_mfma_f32_16x16x32_bf16 v[136:139], a[72:75], a[24:27], v[136:139]
    v_exp_f32 v159, v159
    v_mfma_f32_16x16x32_bf16 v[136:139], a[68:71], a[20:23], v[136:139]
    ds_read_b64_tr_b16 a[180:181], v205 offset:16384
    v_cvt_pk_bf16_f32 v173, v154, v155
    v_mfma_f32_16x16x32_bf16 v[136:139], a[64:67], a[16:19], v[136:139]
    v_exp_f32 v148, v148
    v_mfma_f32_16x16x32_bf16 v[140:143], a[80:83], a[16:19], 4.0
    ds_read_b64_tr_b16 a[182:183], v205 offset:20480
    v_cvt_pk_bf16_f32 v174, v156, v157
    v_mfma_f32_16x16x32_bf16 v[140:143], a[84:87], a[20:23], v[140:143]
    v_exp_f32 v149, v149
    v_mfma_f32_16x16x32_bf16 v[140:143], a[88:91], a[24:27], v[140:143]
    ds_read_b64_tr_b16 a[184:185], v206 offset:16384
    v_cvt_pk_bf16_f32 v175, v158, v159
    v_mfma_f32_16x16x32_bf16 v[140:143], a[92:95], a[28:31], v[140:143]
    v_exp_f32 v150, v150
    v_mfma_f32_16x16x32_bf16 v[132:135], a[92:95], a[12:15], 4.0
    ds_read_b64_tr_b16 a[186:187], v206 offset:20480
    v_cvt_pk_bf16_f32 v170, v148, v149
    v_mfma_f32_16x16x32_bf16 v[132:135], a[88:91], a[8:11], v[132:135]
    v_exp_f32 v151, v151
    v_mfma_f32_16x16x32_bf16 v[132:135], a[84:87], a[4:7], v[132:135]
    ds_read_b64_tr_b16 a[188:189], v207 offset:16384
    v_cvt_pk_bf16_f32 v171, v150, v151
    v_mfma_f32_16x16x32_bf16 v[132:135], a[80:83], a[0:3], v[132:135]
    s_waitcnt lgkmcnt(7)
    ds_read_b64_tr_b16 a[190:191], v207 offset:20480
    v_mfma_f32_16x16x32_bf16 v[64:67], v[248:251], a[128:131], v[64:67]
    v_exp_f32 v128, v128
    v_mfma_f32_16x16x32_bf16 v[64:67], v[240:243], a[160:163], v[64:67]
L_hop2_1:
    s_cbranch_vccnz L_main
    v_exp_f32 v129, v129
    v_mfma_f32_16x16x32_bf16 v[96:99], v[244:247], a[160:163], v[96:99]
    v_add_f32 v176, v176, v128
    v_add_f32 v177, v177, v129
    v_mfma_f32_16x16x32_bf16 v[96:99], v[252:255], a[128:131], v[96:99]
    v_exp_f32 v130, v130
    v_mfma_f32_16x16x32_bf16 v[100:103], v[252:255], a[132:135], v[100:103]
    v_exp_f32 v131, v131
    v_mfma_f32_16x16x32_bf16 v[100:103], v[244:247], a[164:167], v[100:103]
    v_add_f32 v176, v176, v130
    v_add_f32 v177, v177, v131
    v_mfma_f32_16x16x32_bf16 v[68:71], v[240:243], a[164:167], v[68:71]
    s_waitcnt lgkmcnt(0)
    v_exp_f32 v136, v136
    v_mfma_f32_16x16x32_bf16 v[68:71], v[248:251], a[132:135], v[68:71]
    v_exp_f32 v137, v137
    v_mfma_f32_16x16x32_bf16 v[72:75], v[248:251], a[136:139], v[72:75]
    v_add_f32 v178, v178, v136
    v_add_f32 v179, v179, v137
    v_mfma_f32_16x16x32_bf16 v[72:75], v[240:243], a[168:171], v[72:75]
    v_exp_f32 v138, v138
    v_mfma_f32_16x16x32_bf16 v[104:107], v[244:247], a[168:171], v[104:107]
    s_mov_b32 m0, s68
    v_exp_f32 v139, v139
    v_mfma_f32_16x16x32_bf16 v[104:107], v[252:255], a[136:139], v[104:107]
    s_lshl_b32 s57, s58, 17
    v_add_f32 v178, v178, v138
    v_add_f32 v179, v179, v139
    v_mfma_f32_16x16x32_bf16 v[108:111], v[252:255], a[140:143], v[108:111]
    ds_read_b128 a[96:99], v196 offset:32768
    ds_read_b128 a[100:103], v197 offset:32768
    v_mfma_f32_16x16x32_bf16 v[108:111], v[244:247], a[172:175], v[108:111]
    buffer_load_dwordx4 v216, s[24:27], s57 offen offset:0 lds
    v_mfma_f32_16x16x32_bf16 v[76:79], v[240:243], a[172:175], v[76:79]
    s_add_u32 s55, s55, 8
    v_exp_f32 v140, v140
    v_mfma_f32_16x16x32_bf16 v[76:79], v[248:251], a[140:143], v[76:79]
    s_min_u32 s60, s55, s59
    v_exp_f32 v141, v141
    v_mfma_f32_16x16x32_bf16 v[144:147], a[64:67], a[32:35], 4.0
    s_load_dword s58, s[10:11], s60
    v_add_f32 v178, v178, v140
    v_add_f32 v179, v179, v141
    v_mfma_f32_16x16x32_bf16 v[144:147], a[68:71], a[36:39], v[144:147]
    ds_read_b128 a[104:107], v198 offset:32768
    ds_read_b128 a[108:111], v199 offset:32768
    v_mfma_f32_16x16x32_bf16 v[144:147], a[72:75], a[40:43], v[144:147]
    buffer_load_dwordx4 v217, s[24:27], s57 offen offset:1024 lds
    v_mfma_f32_16x16x32_bf16 v[144:147], a[76:79], a[44:47], v[144:147]
    v_exp_f32 v142, v142
    v_mfma_f32_16x16x32_bf16 v[152:155], a[76:79], a[60:63], 4.0
    v_exp_f32 v143, v143
    v_mfma_f32_16x16x32_bf16 v[152:155], a[72:75], a[56:59], v[152:155]
    v_add_f32 v178, v178, v142
    v_add_f32 v179, v179, v143
    v_mfma_f32_16x16x32_bf16 v[152:155], a[68:71], a[52:55], v[152:155]
    ds_read_b128 a[112:115], v196 offset:36864
    ds_read_b128 a[116:119], v197 offset:36864
    v_mfma_f32_16x16x32_bf16 v[152:155], a[64:67], a[48:51], v[152:155]
    buffer_load_dwordx4 v218, s[24:27], s57 offen offset:2048 lds
    v_mfma_f32_16x16x32_bf16 v[156:159], a[80:83], a[48:51], 4.0
    v_exp_f32 v132, v132
    v_mfma_f32_16x16x32_bf16 v[156:159], a[84:87], a[52:55], v[156:159]
    v_exp_f32 v133, v133
    v_mfma_f32_16x16x32_bf16 v[156:159], a[88:91], a[56:59], v[156:159]
    v_add_f32 v176, v176, v132
    v_add_f32 v177, v177, v133
    v_mfma_f32_16x16x32_bf16 v[156:159], a[92:95], a[60:63], v[156:159]
    ds_read_b128 a[120:123], v198 offset:36864
    ds_read_b128 a[124:127], v199 offset:36864
    v_mfma_f32_16x16x32_bf16 v[148:151], a[92:95], a[44:47], 4.0
    buffer_load_dwordx4 v219, s[24:27], s57 offen offset:3072 lds
    v_mfma_f32_16x16x32_bf16 v[148:151], a[88:91], a[40:43], v[148:151]
    v_exp_f32 v134, v134
    v_mfma_f32_16x16x32_bf16 v[148:151], a[84:87], a[36:39], v[148:151]
    v_exp_f32 v135, v135
    v_mfma_f32_16x16x32_bf16 v[148:151], a[80:83], a[32:35], v[148:151]
    v_add_f32 v176, v176, v134
    v_add_f32 v177, v177, v135
    v_mfma_f32_16x16x32_bf16 v[80:83], v[248:251], a[144:147], v[80:83]
    v_exp_f32 v144, v144
    v_mfma_f32_16x16x32_bf16 v[80:83], v[240:243], a[176:179], v[80:83]
    v_exp_f32 v145, v145
    v_mfma_f32_16x16x32_bf16 v[112:115], v[244:247], a[176:179], v[112:115]
    ds_read_b64_tr_b16 a[128:129], v200 offset:24576
    v_cvt_pk_bf16_f32 v160, v128, v129
    v_mfma_f32_16x16x32_bf16 v[112:115], v[252:255], a[144:147], v[112:115]
    s_cmp_le_u32 s55, s59
    v_exp_f32 v146, v146
    v_mfma_f32_16x16x32_bf16 v[116:119], v[252:255], a[148:151], v[116:119]
    ds_read_b64_tr_b16 a[130:131], v200 offset:28672
    v_cvt_pk_bf16_f32 v161, v130, v131
    v_mfma_f32_16x16x32_bf16 v[116:119], v[244:247], a[180:183], v[116:119]
    s_cselect_b32 s26, s26, 0
    v_exp_f32 v147, v147
    v_mfma_f32_16x16x32_bf16 v[84:87], v[240:243], a[180:183], v[84:87]
    ds_read_b64_tr_b16 a[132:133], v201 offset:24576
    v_cvt_pk_bf16_f32 v164, v136, v137
    v_mfma_f32_16x16x32_bf16 v[84:87], v[248:251], a[148:151], v[84:87]
    v_exp_f32 v152, v152
    v_mfma_f32_16x16x32_bf16 v[88:91], v[248:251], a[152:155], v[88:91]
    ds_read_b64_tr_b16 a[134:135], v201 offset:28672
    v_cvt_pk_bf16_f32 v165, v138, v139
    v_mfma_f32_16x16x32_bf16 v[88:91], v[240:243], a[184:187], v[88:91]
    v_exp_f32 v153, v153
    v_mfma_f32_16x16x32_bf16 v[120:123], v[244:247], a[184:187], v[120:123]
    ds_read_b64_tr_b16 a[136:137], v202 offset:24576
    v_cvt_pk_bf16_f32 v166, v140, v141
    v_mfma_f32_16x16x32_bf16 v[120:123], v[252:255], a[152:155], v[120:123]
    v_exp_f32 v154, v154
    v_mfma_f32_16x16x32_bf16 v[124:127], v[252:255], a[156:159], v[124:127]
    ds_read_b64_tr_b16 a[138:139], v202 offset:28672
    v_cvt_pk_bf16_f32 v167, v142, v143
    v_mfma_f32_16x16x32_bf16 v[124:127], v[244:247], a[188:191], v[124:127]
    v_exp_f32 v155, v155
    v_mfma_f32_16x16x32_bf16 v[92:95], v[240:243], a[188:191], v[92:95]
    s_cmp_eq_u32 s55, s56
    ds_read_b64_tr_b16 a[140:141], v203 offset:24576
    v_cvt_pk_bf16_f32 v162, v132, v133
    v_mfma_f32_16x16x32_bf16 v[92:95], v[248:251], a[156:159], v[92:95]
    s_waitcnt lgkmcnt(7)
    v_exp_f32 v156, v156
    v_smfmac_f32_16x16x64_bf16 v[188:191], a[192:195], v[248:255], v192
    s_cbranch_scc1 L_tail0
    v_cvt_pk_bf16_f32 v163, v134, v135
    v_mfma_f32_16x16x32_bf16 v[128:131], a[96:99], a[32:35], 4.0
    ds_read_b64_tr_b16 a[142:143], v203 offset:28672
    v_cvt_pk_bf16_f32 v248, v144, v145
    v_mfma_f32_16x16x32_bf16 v[128:131], a[100:103], a[36:39], v[128:131]
    v_exp_f32 v157, v157
    v_mfma_f32_16x16x32_bf16 v[128:131], a[104:107], a[40:43], v[128:131]
    ds_read_b64_tr_b16 a[144:145], v204 offset:24576
    v_cvt_pk_bf16_f32 v249, v146, v147
    v_mfma_f32_16x16x32_bf16 v[128:131], a[108:111], a[44:47], v[128:131]
    v_exp_f32 v158, v158
    v_mfma_f32_16x16x32_bf16 v[136:139], a[108:111], a[60:63], 4.0
    ds_read_b64_tr_b16 a[146:147], v204 offset:28672
    v_cvt_pk_bf16_f32 v252, v152, v153
    v_mfma_f32_16x16x32_bf16 v[136:139], a[104:107], a[56:59], v[136:139]
    v_exp_f32 v159, v159
    v_mfma_f32_16x16x32_bf16 v[136:139], a[100:103], a[52:55], v[136:139]
    ds_read_b64_tr_b16 a[148:149], v205 offset:24576
    v_cvt_pk_bf16_f32 v253, v154, v155
    v_mfma_f32_16x16x32_bf16 v[136:139], a[96:99], a[48:51], v[136:139]
    v_exp_f32 v148, v148
    v_mfma_f32_16x16x32_bf16 v[140:143], a[112:115], a[48:51], 4.0
    ds_read_b64_tr_b16 a[150:151], v205 offset:28672
    v_cvt_pk_bf16_f32 v254, v156, v157
    v_mfma_f32_16x16x32_bf16 v[140:143], a[116:119], a[52:55], v[140:143]
    v_exp_f32 v149, v149
    v_mfma_f32_16x16x32_bf16 v[140:143], a[120:123], a[56:59], v[140:143]
    ds_read_b64_tr_b16 a[152:153], v206 offset:24576
    v_cvt_pk_bf16_f32 v255, v158, v159
    v_mfma_f32_16x16x32_bf16 v[140:143], a[124:127], a[60:63], v[140:143]
    v_exp_f32 v150, v150
    v_mfma_f32_16x16x32_bf16 v[132:135], a[124:127], a[44:47], 4.0
    ds_read_b64_tr_b16 a[154:155], v206 offset:28672
    v_cvt_pk_bf16_f32 v250, v148, v149
    v_mfma_f32_16x16x32_bf16 v[132:135], a[120:123], a[40:43], v[132:135]
    v_exp_f32 v151, v151
    v_mfma_f32_16x16x32_bf16 v[132:135], a[116:119], a[36:39], v[132:135]
    ds_read_b64_tr_b16 a[156:157], v207 offset:24576
    v_cvt_pk_bf16_f32 v251, v150, v151
    v_mfma_f32_16x16x32_bf16 v[132:135], a[112:115], a[32:35], v[132:135]
    s_waitcnt lgkmcnt(7)
    ds_read_b64_tr_b16 a[158:159], v207 offset:28672
    v_mfma_f32_16x16x32_bf16 v[0:3], v[168:171], a[160:163], v[0:3]
    v_exp_f32 v128, v128
    v_mfma_f32_16x16x32_bf16 v[0:3], v[160:163], a[128:131], v[0:3]
    v_exp_f32 v129, v129
    v_mfma_f32_16x16x32_bf16 v[32:35], v[164:167], a[128:131], v[32:35]
    v_add_f32 v180, v180, v128
    v_add_f32 v181, v181, v129
    v_mfma_f32_16x16x32_bf16 v[32:35], v[172:175], a[160:163], v[32:35]
    v_exp_f32 v130, v130
    v_mfma_f32_16x16x32_bf16 v[36:39], v[172:175], a[164:167], v[36:39]
    v_exp_f32 v131, v131
    v_mfma_f32_16x16x32_bf16 v[36:39], v[164:167], a[132:135], v[36:39]
    v_add_f32 v180, v180, v130
    v_add_f32 v181, v181, v131
    v_mfma_f32_16x16x32_bf16 v[4:7], v[160:163], a[132:135], v[4:7]
    s_waitcnt vmcnt(4) lgkmcnt(0)
    v_exp_f32 v136, v136
    v_mfma_f32_16x16x32_bf16 v[4:7], v[168:171], a[164:167], v[4:7]
    s_barrier
    v_exp_f32 v137, v137
    v_mfma_f32_16x16x32_bf16 v[8:11], v[168:171], a[168:171], v[8:11]
    v_add_f32 v182, v182, v136
    v_add_f32 v183, v183, v137
    v_mfma_f32_16x16x32_bf16 v[8:11], v[160:163], a[136:139], v[8:11]
    v_exp_f32 v138, v138
    v_mfma_f32_16x16x32_bf16 v[40:43], v[164:167], a[136:139], v[40:43]
    s_mov_b32 m0, s69
    v_exp_f32 v139, v139
    v_mfma_f32_16x16x32_bf16 v[40:43], v[172:175], a[168:171], v[40:43]
    s_lshl_b32 s57, s58, 17
    v_add_f32 v182, v182, v138
    v_add_f32 v183, v183, v139
    v_mfma_f32_16x16x32_bf16 v[44:47], v[172:175], a[172:175], v[44:47]
    ds_read_b128 a[64:67], v196 offset:0
    ds_read_b128 a[68:71], v197 offset:0
    v_mfma_f32_16x16x32_bf16 v[44:47], v[164:167], a[140:143], v[44:47]
    buffer_load_dwordx4 v216, s[24:27], s57 offen offset:0 lds
    v_mfma_f32_16x16x32_bf16 v[12:15], v[160:163], a[140:143], v[12:15]
    s_add_u32 s55, s55, 8
    v_exp_f32 v140, v140
    v_mfma_f32_16x16x32_bf16 v[12:15], v[168:171], a[172:175], v[12:15]
    s_min_u32 s60, s55, s59
    v_exp_f32 v141, v141
    v_mfma_f32_16x16x32_bf16 v[144:147], a[96:99], a[0:3], 4.0
    s_load_dword s58, s[10:11], s60
    v_add_f32 v182, v182, v140
    v_add_f32 v183, v183, v141
    v_mfma_f32_16x16x32_bf16 v[144:147], a[100:103], a[4:7], v[144:147]
    ds_read_b128 a[72:75], v198 offset:0
    ds_read_b128 a[76:79], v199 offset:0
    v_mfma_f32_16x16x32_bf16 v[144:147], a[104:107], a[8:11], v[144:147]
    buffer_load_dwordx4 v217, s[24:27], s57 offen offset:1024 lds
    v_mfma_f32_16x16x32_bf16 v[144:147], a[108:111], a[12:15], v[144:147]
    v_exp_f32 v142, v142
    v_mfma_f32_16x16x32_bf16 v[152:155], a[108:111], a[28:31], 4.0
    v_exp_f32 v143, v143
    v_mfma_f32_16x16x32_bf16 v[152:155], a[104:107], a[24:27], v[152:155]
    v_add_f32 v182, v182, v142
    v_add_f32 v183, v183, v143
    v_mfma_f32_16x16x32_bf16 v[152:155], a[100:103], a[20:23], v[152:155]
    ds_read_b128 a[80:83], v196 offset:4096
    ds_read_b128 a[84:87], v197 offset:4096
    v_mfma_f32_16x16x32_bf16 v[152:155], a[96:99], a[16:19], v[152:155]
    buffer_load_dwordx4 v218, s[24:27], s57 offen offset:2048 lds
    v_mfma_f32_16x16x32_bf16 v[156:159], a[112:115], a[16:19], 4.0
    v_exp_f32 v132, v132
    v_mfma_f32_16x16x32_bf16 v[156:159], a[116:119], a[20:23], v[156:159]
    v_exp_f32 v133, v133
    v_mfma_f32_16x16x32_bf16 v[156:159], a[120:123], a[24:27], v[156:159]
    v_add_f32 v180, v180, v132
    v_add_f32 v181, v181, v133
    v_mfma_f32_16x16x32_bf16 v[156:159], a[124:127], a[28:31], v[156:159]
    ds_read_b128 a[88:91], v198 offset:4096
    ds_read_b128 a[92:95], v199 offset:4096
    v_mfma_f32_16x16x32_bf16 v[148:151], a[124:127], a[12:15], 4.0
    buffer_load_dwordx4 v219, s[24:27], s57 offen offset:3072 lds
    v_mfma_f32_16x16x32_bf16 v[148:151], a[120:123], a[8:11], v[148:151]
    v_exp_f32 v134, v134
    v_mfma_f32_16x16x32_bf16 v[148:151], a[116:119], a[4:7], v[148:151]
    v_exp_f32 v135, v135
    v_mfma_f32_16x16x32_bf16 v[148:151], a[112:115], a[0:3], v[148:151]
    v_add_f32 v180, v180, v134
    v_add_f32 v181, v181, v135
    v_mfma_f32_16x16x32_bf16 v[16:19], v[168:171], a[176:179], v[16:19]
    v_exp_f32 v144, v144
    v_mfma_f32_16x16x32_bf16 v[16:19], v[160:163], a[144:147], v[16:19]
    v_exp_f32 v145, v145
    v_mfma_f32_16x16x32_bf16 v[48:51], v[164:167], a[144:147], v[48:51]
    ds_read_b64_tr_b16 a[160:161], v200 offset:32768
    v_cvt_pk_bf16_f32 v240, v128, v129
    v_mfma_f32_16x16x32_bf16 v[48:51], v[172:175], a[176:179], v[48:51]
    s_cmp_le_u32 s55, s59
    v_exp_f32 v146, v146
    v_mfma_f32_16x16x32_bf16 v[52:55], v[172:175], a[180:183], v[52:55]
    ds_read_b64_tr_b16 a[162:163], v200 offset:36864
    v_cvt_pk_bf16_f32 v241, v130, v131
    v_mfma_f32_16x16x32_bf16 v[52:55], v[164:167], a[148:151], v[52:55]
    s_cselect_b32 s26, s26, 0
    v_exp_f32 v147, v147
    v_mfma_f32_16x16x32_bf16 v[20:23], v[160:163], a[148:151], v[20:23]
    ds_read_b64_tr_b16 a[164:165], v201 offset:32768
    v_cvt_pk_bf16_f32 v244, v136, v137
    v_mfma_f32_16x16x32_bf16 v[20:23], v[168:171], a[180:183], v[20:23]
    v_exp_f32 v152, v152
    v_mfma_f32_16x16x32_bf16 v[24:27], v[168:171], a[184:187], v[24:27]
    ds_read_b64_tr_b16 a[166:167], v201 offset:36864
    v_cvt_pk_bf16_f32 v245, v138, v139
    v_mfma_f32_16x16x32_bf16 v[24:27], v[160:163], a[152:155], v[24:27]
    v_exp_f32 v153, v153
    v_mfma_f32_16x16x32_bf16 v[56:59], v[164:167], a[152:155], v[56:59]
    ds_read_b64_tr_b16 a[168:169], v202 offset:32768
    v_cvt_pk_bf16_f32 v246, v140, v141
    v_mfma_f32_16x16x32_bf16 v[56:59], v[172:175], a[184:187], v[56:59]
    v_exp_f32 v154, v154
    v_mfma_f32_16x16x32_bf16 v[60:63], v[172:175], a[188:191], v[60:63]
    ds_read_b64_tr_b16 a[170:171], v202 offset:36864
    v_cvt_pk_bf16_f32 v247, v142, v143
    v_mfma_f32_16x16x32_bf16 v[60:63], v[164:167], a[156:159], v[60:63]
    v_exp_f32 v155, v155
    v_mfma_f32_16x16x32_bf16 v[28:31], v[160:163], a[156:159], v[28:31]
    s_cmp_eq_u32 s55, s56
    ds_read_b64_tr_b16 a[172:173], v203 offset:32768
    v_cvt_pk_bf16_f32 v242, v132, v133
    v_mfma_f32_16x16x32_bf16 v[28:31], v[168:171], a[188:191], v[28:31]
    s_waitcnt lgkmcnt(7)
    v_exp_f32 v156, v156
    v_smfmac_f32_16x16x64_bf16 v[184:187], a[192:195], v[168:175], v192
    s_cbranch_scc1 L_tail1
    v_cvt_pk_bf16_f32 v243, v134, v135
    v_mfma_f32_16x16x32_bf16 v[128:131], a[64:67], a[0:3], 4.0
    ds_read_b64_tr_b16 a[174:175], v203 offset:36864
    v_cvt_pk_bf16_f32 v168, v144, v145
    v_mfma_f32_16x16x32_bf16 v[128:131], a[68:71], a[4:7], v[128:131]
    v_exp_f32 v157, v157
    v_mfma_f32_16x16x32_bf16 v[128:131], a[72:75], a[8:11], v[128:131]
    ds_read_b64_tr_b16 a[176:177], v204 offset:32768
    v_cvt_pk_bf16_f32 v169, v146, v147
    v_mfma_f32_16x16x32_bf16 v[128:131], a[76:79], a[12:15], v[128:131]
    v_exp_f32 v158, v158
    v_mfma_f32_16x16x32_bf16 v[136:139], a[76:79], a[28:31], 4.0
    ds_read_b64_tr_b16 a[178:179], v204 offset:36864
    v_cvt_pk_bf16_f32 v172, v152, v153
    v_mfma_f32_16x16x32_bf16 v[136:139], a[72:75], a[24:27], v[136:139]
    v_exp_f32 v159, v159
    v_mfma_f32_16x16x32_bf16 v[136:139], a[68:71], a[20:23], v[136:139]
    ds_read_b64_tr_b16 a[180:181], v205 offset:32768
    v_cvt_pk_bf16_f32 v173, v154, v155
    v_mfma_f32_16x16x32_bf16 v[136:139], a[64:67], a[16:19], v[136:139]
    v_exp_f32 v148, v148
    v_mfma_f32_16x16x32_bf16 v[140:143], a[80:83], a[16:19], 4.0
    ds_read_b64_tr_b16 a[182:183], v205 offset:36864
    v_cvt_pk_bf16_f32 v174, v156, v157
    v_mfma_f32_16x16x32_bf16 v[140:143], a[84:87], a[20:23], v[140:143]
    v_exp_f32 v149, v149
    v_mfma_f32_16x16x32_bf16 v[140:143], a[88:91], a[24:27], v[140:143]
    ds_read_b64_tr_b16 a[184:185], v206 offset:32768
    v_cvt_pk_bf16_f32 v175, v158, v159
    v_mfma_f32_16x16x32_bf16 v[140:143], a[92:95], a[28:31], v[140:143]
    v_exp_f32 v150, v150
    v_mfma_f32_16x16x32_bf16 v[132:135], a[92:95], a[12:15], 4.0
    ds_read_b64_tr_b16 a[186:187], v206 offset:36864
    v_cvt_pk_bf16_f32 v170, v148, v149
    v_mfma_f32_16x16x32_bf16 v[132:135], a[88:91], a[8:11], v[132:135]
    v_exp_f32 v151, v151
    v_mfma_f32_16x16x32_bf16 v[132:135], a[84:87], a[4:7], v[132:135]
    ds_read_b64_tr_b16 a[188:189], v207 offset:32768
    v_cvt_pk_bf16_f32 v171, v150, v151
    v_mfma_f32_16x16x32_bf16 v[132:135], a[80:83], a[0:3], v[132:135]
    s_waitcnt lgkmcnt(7)
    ds_read_b64_tr_b16 a[190:191], v207 offset:36864
    v_mfma_f32_16x16x32_bf16 v[64:67], v[248:251], a[128:131], v[64:67]
    v_exp_f32 v128, v128
    v_mfma_f32_16x16x32_bf16 v[64:67], v[240:243], a[160:163], v[64:67]
    v_exp_f32 v129, v129
    v_mfma_f32_16x16x32_bf16 v[96:99], v[244:247], a[160:163], v[96:99]
    v_add_f32 v176, v176, v128
    v_add_f32 v177, v177, v129
    v_mfma_f32_16x16x32_bf16 v[96:99], v[252:255], a[128:131], v[96:99]
    v_exp_f32 v130, v130
    v_mfma_f32_16x16x32_bf16 v[100:103], v[252:255], a[132:135], v[100:103]
    v_exp_f32 v131, v131
    v_mfma_f32_16x16x32_bf16 v[100:103], v[244:247], a[164:167], v[100:103]
    v_add_f32 v176, v176, v130
    v_add_f32 v177, v177, v131
    v_mfma_f32_16x16x32_bf16 v[68:71], v[240:243], a[164:167], v[68:71]
    s_waitcnt lgkmcnt(0)
    v_exp_f32 v136, v136
    v_mfma_f32_16x16x32_bf16 v[68:71], v[248:251], a[132:135], v[68:71]
    v_exp_f32 v137, v137
    v_mfma_f32_16x16x32_bf16 v[72:75], v[248:251], a[136:139], v[72:75]
    v_add_f32 v178, v178, v136
    v_add_f32 v179, v179, v137
    v_mfma_f32_16x16x32_bf16 v[72:75], v[240:243], a[168:171], v[72:75]
    v_exp_f32_e64 v138, v138
    v_mfma_f32_16x16x32_bf16 v[104:107], v[244:247], a[168:171], v[104:107]
    s_mov_b32 m0, s16
    v_exp_f32 v139, v139
    v_mfma_f32_16x16x32_bf16 v[104:107], v[252:255], a[136:139], v[104:107]
    s_lshl_b32 s57, s58, 17
    v_add_f32 v178, v178, v138
    v_add_f32 v179, v179, v139
    v_mfma_f32_16x16x32_bf16 v[108:111], v[252:255], a[140:143], v[108:111]
    ds_read_b128 a[96:99], v196 offset:8192
    ds_read_b128 a[100:103], v197 offset:8192
    v_mfma_f32_16x16x32_bf16 v[108:111], v[244:247], a[172:175], v[108:111]
    buffer_load_dwordx4 v216, s[24:27], s57 offen offset:0 lds
    v_mfma_f32_16x16x32_bf16 v[76:79], v[240:243], a[172:175], v[76:79]
    s_add_u32 s55, s55, 8
    v_exp_f32 v140, v140
    v_mfma_f32_16x16x32_bf16 v[76:79], v[248:251], a[140:143], v[76:79]
    s_min_u32 s60, s55, s59
    v_exp_f32 v141, v141
    v_mfma_f32_16x16x32_bf16 v[144:147], a[64:67], a[32:35], 4.0
    s_load_dword s58, s[10:11], s60
    v_add_f32 v178, v178, v140
    v_add_f32 v179, v179, v141
    v_mfma_f32_16x16x32_bf16 v[144:147], a[68:71], a[36:39], v[144:147]
    ds_read_b128 a[104:107], v198 offset:8192
    ds_read_b128 a[108:111], v199 offset:8192
    v_mfma_f32_16x16x32_bf16 v[144:147], a[72:75], a[40:43], v[144:147]
    buffer_load_dwordx4 v217, s[24:27], s57 offen offset:1024 lds
    v_mfma_f32_16x16x32_bf16 v[144:147], a[76:79], a[44:47], v[144:147]
    v_exp_f32 v142, v142
    v_mfma_f32_16x16x32_bf16 v[152:155], a[76:79], a[60:63], 4.0
    v_exp_f32 v143, v143
    v_mfma_f32_16x16x32_bf16 v[152:155], a[72:75], a[56:59], v[152:155]
    v_add_f32 v178, v178, v142
    v_add_f32 v179, v179, v143
    v_mfma_f32_16x16x32_bf16 v[152:155], a[68:71], a[52:55], v[152:155]
    ds_read_b128 a[112:115], v196 offset:12288
    ds_read_b128 a[116:119], v197 offset:12288
    v_mfma_f32_16x16x32_bf16 v[152:155], a[64:67], a[48:51], v[152:155]
    buffer_load_dwordx4 v218, s[24:27], s57 offen offset:2048 lds
    v_mfma_f32_16x16x32_bf16 v[156:159], a[80:83], a[48:51], 4.0
    v_exp_f32 v132, v132
    v_mfma_f32_16x16x32_bf16 v[156:159], a[84:87], a[52:55], v[156:159]
    v_exp_f32 v133, v133
    v_mfma_f32_16x16x32_bf16 v[156:159], a[88:91], a[56:59], v[156:159]
    v_add_f32 v176, v176, v132
    v_add_f32 v177, v177, v133
    v_mfma_f32_16x16x32_bf16 v[156:159], a[92:95], a[60:63], v[156:159]
    ds_read_b128 a[120:123], v198 offset:12288
    ds_read_b128 a[124:127], v199 offset:12288
    v_mfma_f32_16x16x32_bf16 v[148:151], a[92:95], a[44:47], 4.0
    buffer_load_dwordx4 v219, s[24:27], s57 offen offset:3072 lds
    v_mfma_f32_16x16x32_bf16 v[148:151], a[88:91], a[40:43], v[148:151]
    v_exp_f32 v134, v134
    v_mfma_f32_16x16x32_bf16 v[148:151], a[84:87], a[36:39], v[148:151]
    v_exp_f32 v135, v135
    v_mfma_f32_16x16x32_bf16 v[148:151], a[80:83], a[32:35], v[148:151]
    v_add_f32 v176, v176, v134
    v_add_f32 v177, v177, v135
    v_mfma_f32_16x16x32_bf16 v[80:83], v[248:251], a[144:147], v[80:83]
    v_exp_f32 v144, v144
    v_mfma_f32_16x16x32_bf16 v[80:83], v[240:243], a[176:179], v[80:83]
    v_exp_f32 v145, v145
    v_mfma_f32_16x16x32_bf16 v[112:115], v[244:247], a[176:179], v[112:115]
    ds_read_b64_tr_b16 a[128:129], v200 offset:0
    v_cvt_pk_bf16_f32 v160, v128, v129
    v_mfma_f32_16x16x32_bf16 v[112:115], v[252:255], a[144:147], v[112:115]
    s_cmp_le_u32 s55, s59
    v_exp_f32 v146, v146
    v_mfma_f32_16x16x32_bf16 v[116:119], v[252:255], a[148:151], v[116:119]
    ds_read_b64_tr_b16 a[130:131], v200 offset:4096
    v_cvt_pk_bf16_f32 v161, v130, v131
    v_mfma_f32_16x16x32_bf16 v[116:119], v[244:247], a[180:183], v[116:119]
    s_cselect_b32 s26, s26, 0
    v_exp_f32 v147, v147
    v_mfma_f32_16x16x32_bf16 v[84:87], v[240:243], a[180:183], v[84:87]
    ds_read_b64_tr_b16 a[132:133], v201 offset:0
    v_cvt_pk_bf16_f32 v164, v136, v137
    v_mfma_f32_16x16x32_bf16 v[84:87], v[248:251], a[148:151], v[84:87]
    v_exp_f32 v152, v152
    v_mfma_f32_16x16x32_bf16 v[88:91], v[248:251], a[152:155], v[88:91]
    ds_read_b64_tr_b16 a[134:135], v201 offset:4096
    v_cvt_pk_bf16_f32 v165, v138, v139
    v_mfma_f32_16x16x32_bf16 v[88:91], v[240:243], a[184:187], v[88:91]
    v_exp_f32 v153, v153
    v_mfma_f32_16x16x32_bf16 v[120:123], v[244:247], a[184:187], v[120:123]
    ds_read_b64_tr_b16 a[136:137], v202 offset:0
    v_cvt_pk_bf16_f32 v166, v140, v141
    v_mfma_f32_16x16x32_bf16 v[120:123], v[252:255], a[152:155], v[120:123]
    v_exp_f32 v154, v154
    v_mfma_f32_16x16x32_bf16 v[124:127], v[252:255], a[156:159], v[124:127]
    ds_read_b64_tr_b16 a[138:139], v202 offset:4096
    v_cvt_pk_bf16_f32 v167, v142, v143
    v_mfma_f32_16x16x32_bf16 v[124:127], v[244:247], a[188:191], v[124:127]
    v_exp_f32 v155, v155
    v_mfma_f32_16x16x32_bf16 v[92:95], v[240:243], a[188:191], v[92:95]
    s_cmp_eq_u32 s55, s56
    ds_read_b64_tr_b16 a[140:141], v203 offset:0
    v_cvt_pk_bf16_f32 v162, v132, v133
    v_mfma_f32_16x16x32_bf16 v[92:95], v[248:251], a[156:159], v[92:95]
    s_waitcnt lgkmcnt(7)
    v_exp_f32 v156, v156
    v_smfmac_f32_16x16x64_bf16 v[188:191], a[192:195], v[248:255], v192
    s_cbranch_scc0 L_loop2
    s_branch L_tail0
L_tail1:
L_hop4:
    s_cbranch_vccnz L_hop4_1
    ds_read_b64_tr_b16 a[174:175], v211 offset:4096
    ds_read_b64_tr_b16 a[176:177], v212 offset:0
    ds_read_b64_tr_b16 a[178:179], v212 offset:4096
    ds_read_b64_tr_b16 a[180:181], v213 offset:0
    ds_read_b64_tr_b16 a[182:183], v213 offset:4096
    ds_read_b64_tr_b16 a[184:185], v214 offset:0
    ds_read_b64_tr_b16 a[186:187], v214 offset:4096
    ds_read_b64_tr_b16 a[188:189], v215 offset:0
    ds_read_b64_tr_b16 a[190:191], v215 offset:4096
    s_nop 1
    v_add_f32 v176, v176, v184
    v_add_f32 v177, v177, v185
    v_add_f32 v176, v176, v177
    v_mov_b32 v177, v176
    v_cvt_pk_bf16_f32 v168, v144, v145
    v_cvt_pk_bf16_f32 v169, v146, v147
    v_permlane32_swap_b32 v176, v177
    v_add_f32 v176, v176, v177
    v_mov_b32 v177, v176
    v_exp_f32 v148, v148
    s_nop 0
    v_permlane16_swap_b32 v176, v177
    v_add_f32 v176, v176, v177
    ds_bpermute_b32 v232, v229, v176 offset:0
    ds_bpermute_b32 v233, v229, v176 offset:4
    ds_bpermute_b32 v234, v229, v176 offset:8
    ds_bpermute_b32 v235, v229, v176 offset:12
    v_exp_f32 v149, v149
    v_exp_f32 v150, v150
    v_cvt_pk_bf16_f32 v170, v148, v149
    v_exp_f32 v151, v151
    v_exp_f32 v157, v157
    v_cvt_pk_bf16_f32 v171, v150, v151
    v_exp_f32 v158, v158
    s_waitcnt lgkmcnt(14)
    v_mfma_f32_16x16x32_bf16 v[0:3], v[168:171], a[160:163], v[0:3]
    v_cvt_pk_bf16_f32 v172, v152, v153
    v_cvt_pk_bf16_f32 v173, v154, v155
    v_mfma_f32_16x16x32_bf16 v[4:7], v[168:171], a[164:167], v[4:7]
    v_exp_f32 v159, v159
    v_mfma_f32_16x16x32_bf16 v[8:11], v[168:171], a[168:171], v[8:11]
    s_waitcnt lgkmcnt(12)
    v_cvt_pk_bf16_f32 v174, v156, v157
    v_cvt_pk_bf16_f32 v175, v158, v159
    v_mfma_f32_16x16x32_bf16 v[12:15], v[168:171], a[172:175], v[12:15]
    s_waitcnt lgkmcnt(0)
    v_add_f32 v178, v178, v186
    v_add_f32 v179, v179, v187
    v_mfma_f32_16x16x32_bf16 v[232:235], v[168:171], a[232:235], v[232:235]
    v_add_f32 v178, v178, v179
    v_mov_b32 v179, v178
    v_mfma_f32_16x16x32_bf16 v[16:19], v[168:171], a[176:179], v[16:19]
    s_nop 0
    v_permlane32_swap_b32 v178, v179
    v_mfma_f32_16x16x32_bf16 v[20:23], v[168:171], a[180:183], v[20:23]
    v_add_f32 v178, v178, v179
    v_mov_b32 v179, v178
    v_mfma_f32_16x16x32_bf16 v[24:27], v[168:171], a[184:187], v[24:27]
    s_nop 0
    v_permlane16_swap_b32 v178, v179
    v_mfma_f32_16x16x32_bf16 v[28:31], v[168:171], a[188:191], v[28:31]
    ds_read_b128 a[64:67], v196 offset:40960
    v_add_f32 v178, v178, v179
    v_mfma_f32_16x16x32_bf16 v[32:35], v[172:175], a[160:163], v[32:35]
    ds_bpermute_b32 v236, v229, v178 offset:0
    v_mfma_f32_16x16x32_bf16 v[36:39], v[172:175], a[164:167], v[36:39]
    ds_bpermute_b32 v237, v229, v178 offset:4
    v_mfma_f32_16x16x32_bf16 v[40:43], v[172:175], a[168:171], v[40:43]
    ds_bpermute_b32 v238, v229, v178 offset:8
    v_mfma_f32_16x16x32_bf16 v[44:47], v[172:175], a[172:175], v[44:47]
    ds_bpermute_b32 v239, v229, v178 offset:12
    v_mfma_f32_16x16x32_bf16 v[48:51], v[172:175], a[176:179], v[48:51]
    ds_read_b128 a[68:71], v197 offset:40960
    ds_read_b128 a[72:75], v198 offset:40960
    v_mfma_f32_16x16x32_bf16 v[52:55], v[172:175], a[180:183], v[52:55]
    v_rcp_f32 v232, v232
    v_mfma_f32_16x16x32_bf16 v[56:59], v[172:175], a[184:187], v[56:59]
    v_rcp_f32 v233, v233
    v_mfma_f32_16x16x32_bf16 v[60:63], v[172:175], a[188:191], v[60:63]
    ds_read_b128 a[76:79], v199 offset:40960
    v_rcp_f32 v234, v234
    v_rcp_f32 v235, v235
    v_cvt_pk_bf16_f32 v243, v134, v135
    v_pk_mul_f32 v[0:1], v[0:1], v[232:233]
    v_pk_mul_f32 v[2:3], v[2:3], v[234:235]
    v_pk_mul_f32 v[4:5], v[4:5], v[232:233]
    v_pk_mul_f32 v[6:7], v[6:7], v[234:235]
    v_pk_mul_f32 v[8:9], v[8:9], v[232:233]
    v_pk_mul_f32 v[10:11], v[10:11], v[234:235]
    v_pk_mul_f32 v[12:13], v[12:13], v[232:233]
    v_pk_mul_f32 v[14:15], v[14:15], v[234:235]
    s_waitcnt lgkmcnt(3)
    v_mfma_f32_16x16x32_bf16 v[236:239], v[172:175], a[232:235], v[236:239]
    v_cvt_pk_bf16_f32 v0, v0, v1
    v_cvt_pk_bf16_f32 v1, v2, v3
    v_cvt_pk_bf16_f32 v4, v4, v5
    v_cvt_pk_bf16_f32 v5, v6, v7
    v_cvt_pk_bf16_f32 v8, v8, v9
    v_pk_mul_f32 v[16:17], v[16:17], v[232:233]
    v_pk_mul_f32 v[18:19], v[18:19], v[234:235]
    v_pk_mul_f32 v[20:21], v[20:21], v[232:233]
    v_pk_mul_f32 v[22:23], v[22:23], v[234:235]
    v_pk_mul_f32 v[24:25], v[24:25], v[232:233]
    v_pk_mul_f32 v[26:27], v[26:27], v[234:235]
    v_pk_mul_f32 v[28:29], v[28:29], v[232:233]
    v_pk_mul_f32 v[30:31], v[30:31], v[234:235]
    v_cvt_pk_bf16_f32 v9, v10, v11
    v_cvt_pk_bf16_f32 v12, v12, v13
    v_cvt_pk_bf16_f32 v13, v14, v15
    ds_write_b64 v224, v[0:1] offset:0
    ds_write_b64 v224, v[4:5] offset:128
    ds_write_b64 v225, v[8:9] offset:256
    v_cvt_pk_bf16_f32 v16, v16, v17
    v_cvt_pk_bf16_f32 v17, v18, v19
    ds_write_b64 v225, v[12:13] offset:384
    v_cvt_pk_bf16_f32 v20, v20, v21
    ds_read_b64_tr_b16 v[128:129], v226 offset:0
    ds_read_b64_tr_b16 v[130:131], v227 offset:0
    ds_read_b64_tr_b16 v[132:133], v226 offset:2048
    ds_read_b64_tr_b16 v[134:135], v227 offset:2048
    v_cvt_pk_bf16_f32 v21, v22, v23
    v_cvt_pk_bf16_f32 v24, v24, v25
    v_cvt_pk_bf16_f32 v25, v26, v27
    v_cvt_pk_bf16_f32 v28, v28, v29
    v_cvt_pk_bf16_f32 v29, v30, v31
    ds_write_b64 v224, v[16:17] offset:512
    ds_write_b64 v224, v[20:21] offset:640
    v_rcp_f32 v236, v236
    ds_write_b64 v225, v[24:25] offset:768
    v_add_f32 v182, v182, v190
    ds_write_b64 v225, v[28:29] offset:896
    s_waitcnt lgkmcnt(6)
    buffer_store_dwordx4 v[128:131], v228, s[28:31], s50 offen offset:0 sc1 nt
    ds_read_b64_tr_b16 v[136:137], v226 offset:512
    ds_read_b64_tr_b16 v[138:139], v227 offset:512
    v_rcp_f32 v237, v237
    v_add_f32 v183, v183, v191
    ds_read_b64_tr_b16 v[140:141], v226 offset:2560
    ds_read_b64_tr_b16 v[142:143], v227 offset:2560
    v_mfma_f32_16x16x32_bf16 v[96:99], v[252:255], a[128:131], v[96:99]
    ds_read_b128 a[80:83], v196 offset:45056
    ds_read_b128 a[84:87], v197 offset:45056
    v_mfma_f32_16x16x32_bf16 v[96:99], v[244:247], a[160:163], v[96:99]
    ds_read_b128 a[88:91], v198 offset:45056
    v_add_f32 v182, v182, v183
    v_mfma_f32_16x16x32_bf16 v[100:103], v[252:255], a[132:135], v[100:103]
    ds_read_b128 a[92:95], v199 offset:45056
    v_rcp_f32 v238, v238
    v_mov_b32 v183, v182
    v_mfma_f32_16x16x32_bf16 v[100:103], v[244:247], a[164:167], v[100:103]
    ds_read_b128 a[96:99], v196 offset:49152
    ds_read_b128 a[100:103], v197 offset:49152
    v_rcp_f32 v239, v239
    v_mfma_f32_16x16x32_bf16 v[104:107], v[252:255], a[136:139], v[104:107]
L_hop4_1:
    s_cbranch_vccnz L_main
    s_waitcnt lgkmcnt(14)
    buffer_store_dwordx4 v[132:135], v228, s[28:31], s50 offen offset:2048 sc1 nt
    v_permlane32_swap_b32 v182, v183
    v_add_f32 v182, v182, v183
    v_pk_mul_f32 v[32:33], v[32:33], v[236:237]
    v_pk_mul_f32 v[34:35], v[34:35], v[238:239]
    v_pk_mul_f32 v[36:37], v[36:37], v[236:237]
    v_pk_mul_f32 v[38:39], v[38:39], v[238:239]
    v_pk_mul_f32 v[40:41], v[40:41], v[236:237]
    v_pk_mul_f32 v[42:43], v[42:43], v[238:239]
    v_pk_mul_f32 v[44:45], v[44:45], v[236:237]
    v_pk_mul_f32 v[46:47], v[46:47], v[238:239]
    v_mfma_f32_16x16x32_bf16 v[104:107], v[244:247], a[168:171], v[104:107]
    ds_read_b128 a[104:107], v198 offset:49152
    ds_read_b128 a[108:111], v199 offset:49152
    v_mfma_f32_16x16x32_bf16 v[108:111], v[252:255], a[140:143], v[108:111]
    ds_read_b128 a[112:115], v196 offset:53248
    ds_read_b128 a[116:119], v197 offset:53248
    ds_read_b128 a[120:123], v198 offset:53248
    v_mov_b32 v183, v182
    v_cvt_pk_bf16_f32 v32, v32, v33
    v_pk_mul_f32 v[48:49], v[48:49], v[236:237]
    v_pk_mul_f32 v[50:51], v[50:51], v[238:239]
    v_pk_mul_f32 v[52:53], v[52:53], v[236:237]
    v_pk_mul_f32 v[54:55], v[54:55], v[238:239]
    v_pk_mul_f32 v[56:57], v[56:57], v[236:237]
    v_pk_mul_f32 v[58:59], v[58:59], v[238:239]
    v_pk_mul_f32 v[60:61], v[60:61], v[236:237]
    v_pk_mul_f32 v[62:63], v[62:63], v[238:239]
    s_waitcnt lgkmcnt(13)
    buffer_store_dwordx4 v[136:139], v228, s[28:31], s50 offen offset:128 sc1 nt
    ds_read_b128 a[124:127], v199 offset:53248
    ds_read_b64_tr_b16 a[0:1], v200 offset:40960
    ds_read_b64_tr_b16 a[2:3], v200 offset:45056
    ds_read_b64_tr_b16 a[4:5], v201 offset:40960
    ds_read_b64_tr_b16 a[6:7], v201 offset:45056
    ds_read_b64_tr_b16 a[8:9], v202 offset:40960
    ds_read_b64_tr_b16 a[10:11], v202 offset:45056
    v_permlane16_swap_b32 v182, v183
    v_mfma_f32_16x16x32_bf16 v[108:111], v[244:247], a[172:175], v[108:111]
    ds_read_b64_tr_b16 a[12:13], v203 offset:40960
    v_cvt_pk_bf16_f32 v33, v34, v35
    v_mfma_f32_16x16x32_bf16 v[112:115], v[252:255], a[144:147], v[112:115]
    ds_write_b64 v224, v[32:33] offset:4096
    v_add_f32 v182, v182, v183
    v_mfma_f32_16x16x32_bf16 v[112:115], v[244:247], a[176:179], v[112:115]
    s_waitcnt lgkmcnt(14)
    ds_bpermute_b32 v220, v229, v182 offset:0
    ds_bpermute_b32 v221, v229, v182 offset:4
    ds_bpermute_b32 v222, v229, v182 offset:8
    buffer_store_dwordx4 v[140:143], v228, s[28:31], s50 offen offset:2176 sc1 nt
    ds_bpermute_b32 v223, v229, v182 offset:12
    ds_read_b64_tr_b16 a[14:15], v203 offset:45056
    v_cvt_pk_bf16_f32 v36, v36, v37
    v_mfma_f32_16x16x32_bf16 v[116:119], v[252:255], a[148:151], v[116:119]
    ds_read_b64_tr_b16 a[16:17], v204 offset:40960
    ds_read_b64_tr_b16 a[18:19], v204 offset:45056
    v_mfma_f32_16x16x32_bf16 v[116:119], v[244:247], a[180:183], v[116:119]
    v_cvt_pk_bf16_f32 v37, v38, v39
    v_add_f32 v180, v180, v188
    v_mfma_f32_16x16x32_bf16 v[120:123], v[252:255], a[152:155], v[120:123]
    ds_write_b64 v224, v[36:37] offset:4224
    ds_read_b64_tr_b16 a[20:21], v205 offset:40960
    v_add_f32 v181, v181, v189
    v_mfma_f32_16x16x32_bf16 v[120:123], v[244:247], a[184:187], v[120:123]
    v_add_f32 v180, v180, v181
    v_cvt_pk_bf16_f32 v40, v40, v41
    v_mfma_f32_16x16x32_bf16 v[124:127], v[252:255], a[156:159], v[124:127]
    ds_read_b64_tr_b16 a[22:23], v205 offset:45056
    v_mov_b32 v181, v180
    v_mfma_f32_16x16x32_bf16 v[124:127], v[244:247], a[188:191], v[124:127]
    s_waitcnt lgkmcnt(6)
    v_cvt_pk_bf16_f32 v41, v42, v43
    v_permlane32_swap_b32 v180, v181
    v_mfma_f32_16x16x32_bf16 v[220:223], v[252:255], a[232:235], v[220:223]
    ds_write_b64 v225, v[40:41] offset:4352
    v_mfma_f32_16x16x32_bf16 v[64:67], v[248:251], a[128:131], v[64:67]
    ds_read_b64_tr_b16 a[24:25], v206 offset:40960
    v_add_f32 v180, v180, v181
    v_mfma_f32_16x16x32_bf16 v[64:67], v[240:243], a[160:163], v[64:67]
    ds_read_b64_tr_b16 a[26:27], v206 offset:45056
    v_mov_b32 v181, v180
    v_mfma_f32_16x16x32_bf16 v[68:71], v[248:251], a[132:135], v[68:71]
    v_cvt_pk_bf16_f32 v44, v44, v45
    v_permlane16_swap_b32 v180, v181
    v_mfma_f32_16x16x32_bf16 v[68:71], v[240:243], a[164:167], v[68:71]
    ds_read_b64_tr_b16 a[28:29], v207 offset:40960
    v_add_f32 v180, v180, v181
    v_mfma_f32_16x16x32_bf16 v[72:75], v[248:251], a[136:139], v[72:75]
    ds_bpermute_b32 v216, v229, v180 offset:0
    ds_bpermute_b32 v217, v229, v180 offset:4
    ds_bpermute_b32 v218, v229, v180 offset:8
    ds_bpermute_b32 v219, v229, v180 offset:12
    v_cvt_pk_bf16_f32 v45, v46, v47
    v_mfma_f32_16x16x32_bf16 v[72:75], v[240:243], a[168:171], v[72:75]
    ds_write_b64 v225, v[44:45] offset:4480
    v_mfma_f32_16x16x32_bf16 v[76:79], v[248:251], a[140:143], v[76:79]
    ds_read_b64_tr_b16 v[0:1], v226 offset:4096
    ds_read_b64_tr_b16 v[2:3], v227 offset:4096
    v_mfma_f32_16x16x32_bf16 v[76:79], v[240:243], a[172:175], v[76:79]
    ds_read_b64_tr_b16 v[4:5], v226 offset:6144
    ds_read_b64_tr_b16 v[6:7], v227 offset:6144
    v_mfma_f32_16x16x32_bf16 v[80:83], v[248:251], a[144:147], v[80:83]
    ds_read_b64_tr_b16 a[30:31], v207 offset:45056
    ds_read_b128 a[200:203], v196 offset:57344
    v_mfma_f32_16x16x32_bf16 v[80:83], v[240:243], a[176:179], v[80:83]
    ds_read_b128 a[204:207], v197 offset:57344
    ds_read_b128 a[208:211], v198 offset:57344
    v_mfma_f32_16x16x32_bf16 v[84:87], v[248:251], a[148:151], v[84:87]
    s_waitcnt lgkmcnt(9)
    ds_read_b128 a[212:215], v199 offset:57344
    ds_read_b128 a[216:219], v196 offset:61440
    v_mfma_f32_16x16x32_bf16 v[216:219], v[248:251], a[232:235], v[216:219]
    ds_read_b128 a[220:223], v197 offset:61440
    v_cvt_pk_bf16_f32 v48, v48, v49
    v_mfma_f32_16x16x32_bf16 v[84:87], v[240:243], a[180:183], v[84:87]
    ds_read_b128 a[224:227], v198 offset:61440
    v_cvt_pk_bf16_f32 v49, v50, v51
    v_mfma_f32_16x16x32_bf16 v[88:91], v[248:251], a[152:155], v[88:91]
    ds_write_b64 v224, v[48:49] offset:4608
    v_mfma_f32_16x16x32_bf16 v[88:91], v[240:243], a[184:187], v[88:91]
    s_waitcnt lgkmcnt(11)
    buffer_store_dwordx4 v[0:3], v228, s[28:31], s51 offen offset:0 sc1 nt
    v_mfma_f32_16x16x32_bf16 v[92:95], v[248:251], a[156:159], v[92:95]
    ds_read_b128 a[228:231], v199 offset:61440
    v_cvt_pk_bf16_f32 v52, v52, v53
    v_mfma_f32_16x16x32_bf16 v[92:95], v[240:243], a[188:191], v[92:95]
    ds_read_b64_tr_b16 a[128:129], v200 offset:49152
    ds_read_b64_tr_b16 a[130:131], v200 offset:53248
    v_mfma_f32_16x16x32_bf16 v[144:147], a[64:67], a[32:35], 4.0
    ds_read_b64_tr_b16 a[132:133], v201 offset:49152
    v_cvt_pk_bf16_f32 v53, v54, v55
    v_mfma_f32_16x16x32_bf16 v[144:147], a[68:71], a[36:39], v[144:147]
    ds_write_b64 v224, v[52:53] offset:4736
    v_mfma_f32_16x16x32_bf16 v[144:147], a[72:75], a[40:43], v[144:147]
    ds_read_b64_tr_b16 a[134:135], v201 offset:53248
    ds_read_b64_tr_b16 a[136:137], v202 offset:49152
    v_mfma_f32_16x16x32_bf16 v[144:147], a[76:79], a[44:47], v[144:147]
    v_cvt_pk_bf16_f32 v56, v56, v57
    v_cvt_pk_bf16_f32 v57, v58, v59
    v_mfma_f32_16x16x32_bf16 v[148:151], a[92:95], a[44:47], 4.0
    ds_write_b64 v225, v[56:57] offset:4864
    v_mfma_f32_16x16x32_bf16 v[148:151], a[88:91], a[40:43], v[148:151]
    s_waitcnt lgkmcnt(14)
    buffer_store_dwordx4 v[4:7], v228, s[28:31], s51 offen offset:2048 sc1 nt
    v_mfma_f32_16x16x32_bf16 v[148:151], a[84:87], a[36:39], v[148:151]
    ds_read_b64_tr_b16 a[138:139], v202 offset:53248
    ds_read_b64_tr_b16 a[140:141], v203 offset:49152
    v_mfma_f32_16x16x32_bf16 v[148:151], a[80:83], a[32:35], v[148:151]
    ds_read_b64_tr_b16 a[142:143], v203 offset:53248
    v_cvt_pk_bf16_f32 v60, v60, v61
    v_mfma_f32_16x16x32_bf16 v[152:155], a[96:99], a[32:35], 4.0
    ds_read_b64_tr_b16 a[144:145], v204 offset:49152
    v_cvt_pk_bf16_f32 v61, v62, v63
    v_mfma_f32_16x16x32_bf16 v[152:155], a[100:103], a[36:39], v[152:155]
    ds_write_b64 v225, v[60:61] offset:4992
    v_mfma_f32_16x16x32_bf16 v[152:155], a[104:107], a[40:43], v[152:155]
    ds_read_b64_tr_b16 v[8:9], v226 offset:4608
    ds_read_b64_tr_b16 v[10:11], v227 offset:4608
    v_mfma_f32_16x16x32_bf16 v[152:155], a[108:111], a[44:47], v[152:155]
    ds_read_b64_tr_b16 v[12:13], v226 offset:6656
    ds_read_b64_tr_b16 v[14:15], v227 offset:6656
    v_mfma_f32_16x16x32_bf16 v[156:159], a[124:127], a[44:47], 4.0
    ds_read_b64_tr_b16 a[146:147], v204 offset:53248
    ds_read_b64_tr_b16 a[148:149], v205 offset:49152
    v_mfma_f32_16x16x32_bf16 v[156:159], a[120:123], a[40:43], v[156:159]
    ds_read_b64_tr_b16 a[150:151], v205 offset:53248
    ds_read_b64_tr_b16 a[152:153], v206 offset:49152
    v_mfma_f32_16x16x32_bf16 v[156:159], a[116:119], a[36:39], v[156:159]
    ds_read_b64_tr_b16 a[154:155], v206 offset:53248
    ds_read_b64_tr_b16 a[156:157], v207 offset:49152
    v_mfma_f32_16x16x32_bf16 v[156:159], a[112:115], a[32:35], v[156:159]
    ds_read_b64_tr_b16 a[158:159], v207 offset:53248
    ds_read_b64_tr_b16 a[160:161], v200 offset:57344
    ds_read_b64_tr_b16 a[162:163], v200 offset:61440
    ds_read_b64_tr_b16 a[164:165], v201 offset:57344
    v_exp_f32 v144, v144
    v_exp_f32 v145, v145
    s_waitcnt lgkmcnt(12)
    buffer_store_dwordx4 v[8:11], v228, s[28:31], s51 offen offset:128 sc1 nt
    ds_read_b64_tr_b16 a[166:167], v201 offset:61440
    v_cvt_pk_bf16_f32 v160, v144, v145
    v_exp_f32 v146, v146
    v_exp_f32 v147, v147
    v_exp_f32 v148, v148
    v_cvt_pk_bf16_f32 v161, v146, v147
    v_mfma_f32_16x16x32_bf16 v[144:147], a[200:203], a[32:35], 4.0
    ds_read_b64_tr_b16 a[168:169], v202 offset:57344
    ds_read_b64_tr_b16 a[170:171], v202 offset:61440
    v_mfma_f32_16x16x32_bf16 v[144:147], a[204:207], a[36:39], v[144:147]
    v_exp_f32 v149, v149
    v_mfma_f32_16x16x32_bf16 v[144:147], a[208:211], a[40:43], v[144:147]
    v_cvt_pk_bf16_f32 v162, v148, v149
    v_exp_f32 v150, v150
    v_mfma_f32_16x16x32_bf16 v[144:147], a[212:215], a[44:47], v[144:147]
    ds_read_b64_tr_b16 a[172:173], v203 offset:57344
    v_exp_f32 v151, v151
    v_exp_f32 v152, v152
    v_cvt_pk_bf16_f32 v163, v150, v151
    v_mfma_f32_16x16x32_bf16 v[148:151], a[228:231], a[44:47], 4.0
    s_waitcnt lgkmcnt(14)
    buffer_store_dwordx4 v[12:15], v228, s[28:31], s51 offen offset:2176 sc1 nt
    v_mfma_f32_16x16x32_bf16 v[216:219], v[160:163], a[232:235], v[216:219]
    ds_read_b64_tr_b16 a[174:175], v203 offset:61440
    ds_read_b64_tr_b16 a[176:177], v204 offset:57344
    v_mfma_f32_16x16x32_bf16 v[64:67], v[160:163], a[0:3], v[64:67]
    ds_read_b64_tr_b16 a[178:179], v204 offset:61440
    ds_read_b64_tr_b16 a[180:181], v205 offset:57344
    v_mfma_f32_16x16x32_bf16 v[68:71], v[160:163], a[4:7], v[68:71]
    v_exp_f32 v153, v153
    v_mfma_f32_16x16x32_bf16 v[72:75], v[160:163], a[8:11], v[72:75]
    ds_read_b64_tr_b16 a[182:183], v205 offset:61440
    v_cvt_pk_bf16_f32 v164, v152, v153
    v_mfma_f32_16x16x32_bf16 v[76:79], v[160:163], a[12:15], v[76:79]
    ds_read_b64_tr_b16 a[184:185], v206 offset:57344
    v_exp_f32 v154, v154
    v_mfma_f32_16x16x32_bf16 v[80:83], v[160:163], a[16:19], v[80:83]
    v_exp_f32 v155, v155
    v_mfma_f32_16x16x32_bf16 v[84:87], v[160:163], a[20:23], v[84:87]
    ds_read_b64_tr_b16 a[186:187], v206 offset:61440
    v_cvt_pk_bf16_f32 v165, v154, v155
    v_mfma_f32_16x16x32_bf16 v[88:91], v[160:163], a[24:27], v[88:91]
    ds_read_b64_tr_b16 a[188:189], v207 offset:57344
    v_exp_f32 v156, v156
    v_mfma_f32_16x16x32_bf16 v[92:95], v[160:163], a[28:31], v[92:95]
    v_exp_f32 v157, v157
    v_mfma_f32_16x16x32_bf16 v[148:151], a[224:227], a[40:43], v[148:151]
    ds_read_b64_tr_b16 a[190:191], v207 offset:61440
    v_cvt_pk_bf16_f32 v166, v156, v157
    v_mfma_f32_16x16x32_bf16 v[148:151], a[220:223], a[36:39], v[148:151]
    v_exp_f32 v158, v158
    v_mfma_f32_16x16x32_bf16 v[148:151], a[216:219], a[32:35], v[148:151]
    v_exp_f32 v159, v159
    v_exp_f32 v144, v144
    v_cvt_pk_bf16_f32 v167, v158, v159
    v_exp_f32 v145, v145
    s_nop 0
    v_mfma_f32_16x16x32_bf16 v[216:219], v[164:167], a[232:235], v[216:219]
    v_cvt_pk_bf16_f32 v168, v144, v145
    v_minimum3_f32 v230, v232, v233, v232
    v_mfma_f32_16x16x32_bf16 v[64:67], v[164:167], a[128:131], v[64:67]
    v_exp_f32 v146, v146
    v_mfma_f32_16x16x32_bf16 v[68:71], v[164:167], a[132:135], v[68:71]
    v_exp_f32 v147, v147
    v_mfma_f32_16x16x32_bf16 v[72:75], v[164:167], a[136:139], v[72:75]
    v_cvt_pk_bf16_f32 v169, v146, v147
    v_maximum3_f32 v231, v232, v233, v232
    v_mfma_f32_16x16x32_bf16 v[76:79], v[164:167], a[140:143], v[76:79]
    s_waitcnt lgkmcnt(14)
    v_exp_f32 v148, v148
    v_mfma_f32_16x16x32_bf16 v[80:83], v[164:167], a[144:147], v[80:83]
    v_exp_f32 v149, v149
    v_mfma_f32_16x16x32_bf16 v[84:87], v[164:167], a[148:151], v[84:87]
    v_cvt_pk_bf16_f32 v170, v148, v149
    v_minimum3_f32 v230, v234, v235, v230
    v_mfma_f32_16x16x32_bf16 v[88:91], v[164:167], a[152:155], v[88:91]
    v_exp_f32 v150, v150
    v_mfma_f32_16x16x32_bf16 v[92:95], v[164:167], a[156:159], v[92:95]
    v_exp_f32 v151, v151
    v_maximum3_f32 v231, v234, v235, v231
    v_cvt_pk_bf16_f32 v171, v150, v151
    v_minimum3_f32 v230, v236, v237, v230
    v_maximum3_f32 v231, v236, v237, v231
    v_mfma_f32_16x16x32_bf16 v[216:219], v[168:171], a[232:235], v[216:219]
    v_minimum3_f32 v230, v238, v239, v230
    v_maximum3_f32 v231, v238, v239, v231
    v_mfma_f32_16x16x32_bf16 v[64:67], v[168:171], a[160:163], v[64:67]
    s_waitcnt lgkmcnt(12)
    v_mfma_f32_16x16x32_bf16 v[68:71], v[168:171], a[164:167], v[68:71]
    s_waitcnt lgkmcnt(10)
    v_mfma_f32_16x16x32_bf16 v[72:75], v[168:171], a[168:171], v[72:75]
    s_waitcnt lgkmcnt(8)
    v_mfma_f32_16x16x32_bf16 v[76:79], v[168:171], a[172:175], v[76:79]
    s_waitcnt lgkmcnt(6)
    v_rcp_f32 v216, v216
    v_mfma_f32_16x16x32_bf16 v[80:83], v[168:171], a[176:179], v[80:83]
    s_waitcnt lgkmcnt(4)
    v_rcp_f32 v217, v217
    v_mfma_f32_16x16x32_bf16 v[84:87], v[168:171], a[180:183], v[84:87]
    s_waitcnt lgkmcnt(2)
    v_rcp_f32 v218, v218
    v_mfma_f32_16x16x32_bf16 v[88:91], v[168:171], a[184:187], v[88:91]
    s_waitcnt lgkmcnt(0)
    v_rcp_f32 v219, v219
    v_mfma_f32_16x16x32_bf16 v[92:95], v[168:171], a[188:191], v[92:95]
    v_minimum3_f32 v230, v216, v217, v230
    v_maximum3_f32 v231, v216, v217, v231
    v_minimum3_f32 v230, v218, v219, v230
    v_maximum3_f32 v231, v218, v219, v231
    v_pk_mul_f32 v[64:65], v[64:65], v[216:217]
    v_pk_mul_f32 v[66:67], v[66:67], v[218:219]
    v_pk_mul_f32 v[68:69], v[68:69], v[216:217]
    v_pk_mul_f32 v[70:71], v[70:71], v[218:219]
    v_pk_mul_f32 v[72:73], v[72:73], v[216:217]
    v_pk_mul_f32 v[74:75], v[74:75], v[218:219]
    v_pk_mul_f32 v[76:77], v[76:77], v[216:217]
    v_pk_mul_f32 v[78:79], v[78:79], v[218:219]
    v_mfma_f32_16x16x32_bf16 v[152:155], a[64:67], a[48:51], 4.0
    v_cvt_pk_bf16_f32 v64, v64, v65
    v_cvt_pk_bf16_f32 v65, v66, v67
    v_cvt_pk_bf16_f32 v68, v68, v69
    v_cvt_pk_bf16_f32 v69, v70, v71
    v_cvt_pk_bf16_f32 v72, v72, v73
    v_pk_mul_f32 v[80:81], v[80:81], v[216:217]
    v_pk_mul_f32 v[82:83], v[82:83], v[218:219]
    v_pk_mul_f32 v[84:85], v[84:85], v[216:217]
    v_pk_mul_f32 v[86:87], v[86:87], v[218:219]
    v_pk_mul_f32 v[88:89], v[88:89], v[216:217]
    v_pk_mul_f32 v[90:91], v[90:91], v[218:219]
    v_pk_mul_f32 v[92:93], v[92:93], v[216:217]
    v_pk_mul_f32 v[94:95], v[94:95], v[218:219]
    v_mfma_f32_16x16x32_bf16 v[152:155], a[68:71], a[52:55], v[152:155]
    ds_write_b64 v224, v[64:65] offset:0
    v_mfma_f32_16x16x32_bf16 v[152:155], a[72:75], a[56:59], v[152:155]
    ds_write_b64 v224, v[68:69] offset:128
    v_mfma_f32_16x16x32_bf16 v[152:155], a[76:79], a[60:63], v[152:155]
    v_cvt_pk_bf16_f32 v73, v74, v75
    v_cvt_pk_bf16_f32 v76, v76, v77
    v_mfma_f32_16x16x32_bf16 v[156:159], a[92:95], a[60:63], 4.0
    ds_write_b64 v225, v[72:73] offset:256
    v_mfma_f32_16x16x32_bf16 v[156:159], a[88:91], a[56:59], v[156:159]
    v_cvt_pk_bf16_f32 v77, v78, v79
    v_cvt_pk_bf16_f32 v80, v80, v81
    v_mfma_f32_16x16x32_bf16 v[156:159], a[84:87], a[52:55], v[156:159]
    ds_write_b64 v225, v[76:77] offset:384
    v_mfma_f32_16x16x32_bf16 v[156:159], a[80:83], a[48:51], v[156:159]
    ds_read_b64_tr_b16 v[32:33], v226 offset:0
    ds_read_b64_tr_b16 v[34:35], v227 offset:0
    v_mfma_f32_16x16x32_bf16 v[144:147], a[96:99], a[48:51], 4.0
    ds_read_b64_tr_b16 v[36:37], v226 offset:2048
    ds_read_b64_tr_b16 v[38:39], v227 offset:2048
    v_mfma_f32_16x16x32_bf16 v[144:147], a[100:103], a[52:55], v[144:147]
    v_cvt_pk_bf16_f32 v81, v82, v83
    v_cvt_pk_bf16_f32 v84, v84, v85
    v_mfma_f32_16x16x32_bf16 v[144:147], a[104:107], a[56:59], v[144:147]
    ds_write_b64 v224, v[80:81] offset:512
    v_mfma_f32_16x16x32_bf16 v[144:147], a[108:111], a[60:63], v[144:147]
    v_cvt_pk_bf16_f32 v85, v86, v87
    v_cvt_pk_bf16_f32 v88, v88, v89
    v_mfma_f32_16x16x32_bf16 v[148:151], a[124:127], a[60:63], 4.0
    ds_write_b64 v224, v[84:85] offset:640
    v_mfma_f32_16x16x32_bf16 v[148:151], a[120:123], a[56:59], v[148:151]
    v_cvt_pk_bf16_f32 v89, v90, v91
    v_cvt_pk_bf16_f32 v92, v92, v93
    v_mfma_f32_16x16x32_bf16 v[148:151], a[116:119], a[52:55], v[148:151]
    s_waitcnt lgkmcnt(4)
    buffer_store_dwordx4 v[32:35], v228, s[28:31], s52 offen offset:0 sc1 nt
    v_mfma_f32_16x16x32_bf16 v[148:151], a[112:115], a[48:51], v[148:151]
    ds_write_b64 v225, v[88:89] offset:768
    v_cvt_pk_bf16_f32 v93, v94, v95
    ds_write_b64 v225, v[92:93] offset:896
    ds_read_b64_tr_b16 v[40:41], v226 offset:512
    ds_read_b64_tr_b16 v[42:43], v227 offset:512
    ds_read_b64_tr_b16 v[44:45], v226 offset:2560
    ds_read_b64_tr_b16 v[46:47], v227 offset:2560
    v_exp_f32 v152, v152
    v_exp_f32 v153, v153
    v_exp_f32 v154, v154
    v_cvt_pk_bf16_f32 v172, v152, v153
    v_exp_f32 v155, v155
    v_exp_f32 v156, v156
    v_cvt_pk_bf16_f32 v173, v154, v155
    v_mfma_f32_16x16x32_bf16 v[152:155], a[200:203], a[48:51], 4.0
    s_waitcnt lgkmcnt(8)
    buffer_store_dwordx4 v[36:39], v228, s[28:31], s52 offen offset:2048 sc1 nt
    v_mfma_f32_16x16x32_bf16 v[152:155], a[204:207], a[52:55], v[152:155]
    v_exp_f32 v157, v157
    v_mfma_f32_16x16x32_bf16 v[152:155], a[208:211], a[56:59], v[152:155]
    v_cvt_pk_bf16_f32 v174, v156, v157
    v_exp_f32 v158, v158
    v_mfma_f32_16x16x32_bf16 v[152:155], a[212:215], a[60:63], v[152:155]
    v_exp_f32 v159, v159
    v_exp_f32 v144, v144
    v_cvt_pk_bf16_f32 v175, v158, v159
    v_mfma_f32_16x16x32_bf16 v[156:159], a[228:231], a[60:63], 4.0
    v_exp_f32 v145, v145
    v_mfma_f32_16x16x32_bf16 v[220:223], v[172:175], a[232:235], v[220:223]
    v_cvt_pk_bf16_f32 v160, v144, v145
    v_exp_f32 v146, v146
    v_mfma_f32_16x16x32_bf16 v[96:99], v[172:175], a[0:3], v[96:99]
    v_exp_f32 v147, v147
    v_mfma_f32_16x16x32_bf16 v[100:103], v[172:175], a[4:7], v[100:103]
    s_waitcnt lgkmcnt(2)
    buffer_store_dwordx4 v[40:43], v228, s[28:31], s52 offen offset:128 sc1 nt
    v_mfma_f32_16x16x32_bf16 v[104:107], v[172:175], a[8:11], v[104:107]
    v_cvt_pk_bf16_f32 v161, v146, v147
    v_exp_f32 v148, v148
    v_mfma_f32_16x16x32_bf16 v[108:111], v[172:175], a[12:15], v[108:111]
    v_exp_f32 v149, v149
    v_mfma_f32_16x16x32_bf16 v[156:159], a[224:227], a[56:59], v[156:159]
    v_cvt_pk_bf16_f32 v162, v148, v149
    v_exp_f32 v150, v150
    v_mfma_f32_16x16x32_bf16 v[156:159], a[220:223], a[52:55], v[156:159]
    v_exp_f32 v151, v151
    v_mfma_f32_16x16x32_bf16 v[156:159], a[216:219], a[48:51], v[156:159]
    v_cvt_pk_bf16_f32 v163, v150, v151
    v_exp_f32 v152, v152
    s_nop 0
    v_mfma_f32_16x16x32_bf16 v[220:223], v[160:163], a[232:235], v[220:223]
    v_exp_f32 v153, v153
    v_mfma_f32_16x16x32_bf16 v[96:99], v[160:163], a[128:131], v[96:99]
    v_cvt_pk_bf16_f32 v164, v152, v153
    v_exp_f32 v154, v154
    v_mfma_f32_16x16x32_bf16 v[100:103], v[160:163], a[132:135], v[100:103]
    s_waitcnt lgkmcnt(0)
    buffer_store_dwordx4 v[44:47], v228, s[28:31], s52 offen offset:2176 sc1 nt
    v_mfma_f32_16x16x32_bf16 v[104:107], v[160:163], a[136:139], v[104:107]
    v_exp_f32 v155, v155
    v_mfma_f32_16x16x32_bf16 v[108:111], v[160:163], a[140:143], v[108:111]
    v_cvt_pk_bf16_f32 v165, v154, v155
    v_exp_f32 v156, v156
    v_mfma_f32_16x16x32_bf16 v[112:115], v[172:175], a[16:19], v[112:115]
    v_exp_f32 v157, v157
    v_mfma_f32_16x16x32_bf16 v[116:119], v[172:175], a[20:23], v[116:119]
    v_cvt_pk_bf16_f32 v166, v156, v157
    v_exp_f32 v158, v158
    v_mfma_f32_16x16x32_bf16 v[120:123], v[172:175], a[24:27], v[120:123]
    v_exp_f32 v159, v159
    v_mfma_f32_16x16x32_bf16 v[124:127], v[172:175], a[28:31], v[124:127]
    v_cvt_pk_bf16_f32 v167, v158, v159
    v_mfma_f32_16x16x32_bf16 v[112:115], v[160:163], a[144:147], v[112:115]
    s_nop 0
    v_mfma_f32_16x16x32_bf16 v[220:223], v[164:167], a[232:235], v[220:223]
    v_mfma_f32_16x16x32_bf16 v[96:99], v[164:167], a[160:163], v[96:99]
    v_mfma_f32_16x16x32_bf16 v[100:103], v[164:167], a[164:167], v[100:103]
    v_mfma_f32_16x16x32_bf16 v[104:107], v[164:167], a[168:171], v[104:107]
    v_mfma_f32_16x16x32_bf16 v[108:111], v[164:167], a[172:175], v[108:111]
    s_nop 3
    v_rcp_f32 v220, v220
    v_mfma_f32_16x16x32_bf16 v[116:119], v[160:163], a[148:151], v[116:119]
    v_rcp_f32 v221, v221
    v_mfma_f32_16x16x32_bf16 v[120:123], v[160:163], a[152:155], v[120:123]
    v_rcp_f32 v222, v222
    v_mfma_f32_16x16x32_bf16 v[124:127], v[160:163], a[156:159], v[124:127]
    v_rcp_f32 v223, v223
    v_mfma_f32_16x16x32_bf16 v[112:115], v[164:167], a[176:179], v[112:115]
    v_minimum3_f32 v230, v220, v221, v230
    v_maximum3_f32 v231, v220, v221, v231
    v_minimum3_f32 v230, v222, v223, v230
    v_maximum3_f32 v231, v222, v223, v231
    v_mul_f32 v231, 0x23800000, v231
    v_pk_mul_f32 v[96:97], v[96:97], v[220:221]
    v_pk_mul_f32 v[98:99], v[98:99], v[222:223]
    v_pk_mul_f32 v[100:101], v[100:101], v[220:221]
    v_pk_mul_f32 v[102:103], v[102:103], v[222:223]
    v_pk_mul_f32 v[104:105], v[104:105], v[220:221]
    v_pk_mul_f32 v[106:107], v[106:107], v[222:223]
    v_pk_mul_f32 v[108:109], v[108:109], v[220:221]
    v_pk_mul_f32 v[110:111], v[110:111], v[222:223]
    v_mfma_f32_16x16x32_bf16 v[116:119], v[164:167], a[180:183], v[116:119]
    v_cvt_pk_bf16_f32 v96, v96, v97
    v_cvt_pk_bf16_f32 v97, v98, v99
    v_mfma_f32_16x16x32_bf16 v[120:123], v[164:167], a[184:187], v[120:123]
    ds_write_b64 v224, v[96:97] offset:4096
    v_mfma_f32_16x16x32_bf16 v[124:127], v[164:167], a[188:191], v[124:127]
    v_cvt_pk_bf16_f32 v100, v100, v101
    v_cvt_pk_bf16_f32 v101, v102, v103
    v_cvt_pk_bf16_f32 v104, v104, v105
    v_cvt_pk_bf16_f32 v105, v106, v107
    v_cvt_pk_bf16_f32 v108, v108, v109
    v_cvt_pk_bf16_f32 v109, v110, v111
    ds_write_b64 v224, v[100:101] offset:4224
    ds_write_b64 v225, v[104:105] offset:4352
    ds_write_b64 v225, v[108:109] offset:4480
    v_pk_mul_f32 v[112:113], v[112:113], v[220:221]
    v_pk_mul_f32 v[114:115], v[114:115], v[222:223]
    v_pk_mul_f32 v[116:117], v[116:117], v[220:221]
    v_pk_mul_f32 v[118:119], v[118:119], v[222:223]
    v_pk_mul_f32 v[120:121], v[120:121], v[220:221]
    v_pk_mul_f32 v[122:123], v[122:123], v[222:223]
    v_pk_mul_f32 v[124:125], v[124:125], v[220:221]
    v_pk_mul_f32 v[126:127], v[126:127], v[222:223]
    ds_read_b64_tr_b16 v[64:65], v226 offset:4096
    ds_read_b64_tr_b16 v[66:67], v227 offset:4096
    ds_read_b64_tr_b16 v[68:69], v226 offset:6144
    ds_read_b64_tr_b16 v[70:71], v227 offset:6144
    v_mul_f32 v230, 0x5f800000, v230
    v_cmp_nge_f32 s[70:71], 1.0, v231
    v_cmp_nle_f32 s[72:73], 1.0, v230
    v_cvt_pk_bf16_f32 v112, v112, v113
    v_cvt_pk_bf16_f32 v113, v114, v115
    s_or_b64 s[70:71], s[70:71], s[72:73]
    v_cvt_pk_bf16_f32 v116, v116, v117
    v_cvt_pk_bf16_f32 v117, v118, v119
    s_cbranch_scc1 L_general
    v_cvt_pk_bf16_f32 v120, v120, v121
    v_cvt_pk_bf16_f32 v121, v122, v123
    v_cvt_pk_bf16_f32 v124, v124, v125
    v_cvt_pk_bf16_f32 v125, v126, v127
    ds_write_b64 v224, v[112:113] offset:4608
    ds_write_b64 v224, v[116:117] offset:4736
    ds_write_b64 v225, v[120:121] offset:4864
    s_waitcnt lgkmcnt(5)
    buffer_store_dwordx4 v[64:67], v228, s[28:31], s53 offen offset:0 sc1 nt
    ds_write_b64 v225, v[124:125] offset:4992
    ds_read_b64_tr_b16 v[72:73], v226 offset:4608
    ds_read_b64_tr_b16 v[74:75], v227 offset:4608
    ds_read_b64_tr_b16 v[76:77], v226 offset:6656
    ds_read_b64_tr_b16 v[78:79], v227 offset:6656
    s_waitcnt lgkmcnt(8)
    buffer_store_dwordx4 v[68:71], v228, s[28:31], s53 offen offset:2048 sc1 nt
    s_waitcnt lgkmcnt(2)
    buffer_store_dwordx4 v[72:75], v228, s[28:31], s53 offen offset:128 sc1 nt
    s_waitcnt lgkmcnt(0)
    buffer_store_dwordx4 v[76:79], v228, s[28:31], s53 offen offset:2176 sc1 nt
    s_endpgm
L_tail0:
L_hop3:
    s_cbranch_vccnz L_hop3_1
    v_mfma_f32_16x16x32_bf16 v[0:3], v[168:171], a[160:163], v[0:3]
    ds_read_b64_tr_b16 a[142:143], v211 offset:4096
    ds_read_b64_tr_b16 a[144:145], v212 offset:0
    v_mfma_f32_16x16x32_bf16 v[4:7], v[168:171], a[164:167], v[4:7]
    ds_read_b64_tr_b16 a[146:147], v212 offset:4096
    ds_read_b64_tr_b16 a[148:149], v213 offset:0
    v_mfma_f32_16x16x32_bf16 v[8:11], v[168:171], a[168:171], v[8:11]
    ds_read_b64_tr_b16 a[150:151], v213 offset:4096
    ds_read_b64_tr_b16 a[152:153], v214 offset:0
    v_mfma_f32_16x16x32_bf16 v[12:15], v[168:171], a[172:175], v[12:15]
    ds_read_b64_tr_b16 a[154:155], v214 offset:4096
    ds_read_b64_tr_b16 a[156:157], v215 offset:0
    v_mfma_f32_16x16x32_bf16 v[16:19], v[168:171], a[176:179], v[16:19]
    ds_read_b64_tr_b16 a[158:159], v215 offset:4096
    v_add_f32 v176, v176, v184
    v_mfma_f32_16x16x32_bf16 v[20:23], v[168:171], a[180:183], v[20:23]
    v_add_f32 v177, v177, v185
    v_add_f32 v176, v176, v177
    v_mfma_f32_16x16x32_bf16 v[24:27], v[168:171], a[184:187], v[24:27]
    v_mov_b32 v177, v176
    v_cvt_pk_bf16_f32 v163, v134, v135
    v_mfma_f32_16x16x32_bf16 v[28:31], v[168:171], a[188:191], v[28:31]
    s_waitcnt lgkmcnt(14)
    v_permlane32_swap_b32 v176, v177
    v_mfma_f32_16x16x32_bf16 v[0:3], v[160:163], a[128:131], v[0:3]
    s_waitcnt lgkmcnt(12)
    v_add_f32 v176, v176, v177
    v_mov_b32 v177, v176
    v_mfma_f32_16x16x32_bf16 v[4:7], v[160:163], a[132:135], v[4:7]
    s_waitcnt lgkmcnt(10)
    v_permlane16_swap_b32 v176, v177
    v_mfma_f32_16x16x32_bf16 v[8:11], v[160:163], a[136:139], v[8:11]
    s_waitcnt lgkmcnt(8)
    v_add_f32 v176, v176, v177
    v_add_f32 v178, v178, v186
    v_mfma_f32_16x16x32_bf16 v[12:15], v[160:163], a[140:143], v[12:15]
    s_waitcnt lgkmcnt(6)
    ds_bpermute_b32 v232, v229, v176 offset:0
    v_mfma_f32_16x16x32_bf16 v[16:19], v[160:163], a[144:147], v[16:19]
    s_waitcnt lgkmcnt(5)
    ds_bpermute_b32 v233, v229, v176 offset:4
    v_mfma_f32_16x16x32_bf16 v[20:23], v[160:163], a[148:151], v[20:23]
    s_waitcnt lgkmcnt(4)
    ds_bpermute_b32 v234, v229, v176 offset:8
    v_mfma_f32_16x16x32_bf16 v[24:27], v[160:163], a[152:155], v[24:27]
    s_waitcnt lgkmcnt(3)
    ds_bpermute_b32 v235, v229, v176 offset:12
    v_mfma_f32_16x16x32_bf16 v[28:31], v[160:163], a[156:159], v[28:31]
    v_add_f32 v179, v179, v187
    v_add_f32 v178, v178, v179
    v_mfma_f32_16x16x32_bf16 v[32:35], v[172:175], a[160:163], v[32:35]
    v_mov_b32 v179, v178
    v_mfma_f32_16x16x32_bf16 v[32:35], v[164:167], a[128:131], v[32:35]
    s_nop 0
    v_permlane32_swap_b32 v178, v179
    v_mfma_f32_16x16x32_bf16 v[36:39], v[172:175], a[164:167], v[36:39]
    v_add_f32 v178, v178, v179
    v_mov_b32 v179, v178
    v_mfma_f32_16x16x32_bf16 v[36:39], v[164:167], a[132:135], v[36:39]
    s_nop 0
    v_permlane16_swap_b32 v178, v179
    v_mfma_f32_16x16x32_bf16 v[40:43], v[172:175], a[168:171], v[40:43]
    v_add_f32 v178, v178, v179
    v_mfma_f32_16x16x32_bf16 v[40:43], v[164:167], a[136:139], v[40:43]
    s_waitcnt lgkmcnt(0)
    ds_bpermute_b32 v236, v229, v178 offset:0
    v_mfma_f32_16x16x32_bf16 v[232:235], v[168:171], a[232:235], v[232:235]
    ds_bpermute_b32 v237, v229, v178 offset:4
    v_mfma_f32_16x16x32_bf16 v[44:47], v[172:175], a[172:175], v[44:47]
    ds_bpermute_b32 v238, v229, v178 offset:8
    v_mfma_f32_16x16x32_bf16 v[44:47], v[164:167], a[140:143], v[44:47]
L_hop3_1:
    s_cbranch_vccnz L_hop3_2
    ds_bpermute_b32 v239, v229, v178 offset:12
    v_mfma_f32_16x16x32_bf16 v[48:51], v[172:175], a[176:179], v[48:51]
    ds_read_b128 a[64:67], v196 offset:40960
    v_cvt_pk_bf16_f32 v248, v144, v145
    v_mfma_f32_16x16x32_bf16 v[48:51], v[164:167], a[144:147], v[48:51]
    v_rcp_f32 v232, v232
    v_mfma_f32_16x16x32_bf16 v[52:55], v[172:175], a[180:183], v[52:55]
    v_rcp_f32 v233, v233
    v_mfma_f32_16x16x32_bf16 v[52:55], v[164:167], a[148:151], v[52:55]
    v_rcp_f32 v234, v234
    v_mfma_f32_16x16x32_bf16 v[56:59], v[172:175], a[184:187], v[56:59]
    ds_read_b128 a[68:71], v197 offset:40960
    v_cvt_pk_bf16_f32 v249, v146, v147
    v_mfma_f32_16x16x32_bf16 v[56:59], v[164:167], a[152:155], v[56:59]
    v_rcp_f32 v235, v235
    v_mfma_f32_16x16x32_bf16 v[60:63], v[172:175], a[188:191], v[60:63]
    v_exp_f32 v148, v148
    v_exp_f32 v149, v149
    v_pk_mul_f32 v[0:1], v[0:1], v[232:233]
    v_pk_mul_f32 v[2:3], v[2:3], v[234:235]
    v_pk_mul_f32 v[4:5], v[4:5], v[232:233]
    v_pk_mul_f32 v[6:7], v[6:7], v[234:235]
    v_pk_mul_f32 v[8:9], v[8:9], v[232:233]
    v_pk_mul_f32 v[10:11], v[10:11], v[234:235]
    v_pk_mul_f32 v[12:13], v[12:13], v[232:233]
    v_pk_mul_f32 v[14:15], v[14:15], v[234:235]
    v_pk_mul_f32 v[16:17], v[16:17], v[232:233]
    v_pk_mul_f32 v[18:19], v[18:19], v[234:235]
    v_pk_mul_f32 v[20:21], v[20:21], v[232:233]
    v_pk_mul_f32 v[22:23], v[22:23], v[234:235]
    v_pk_mul_f32 v[24:25], v[24:25], v[232:233]
    v_pk_mul_f32 v[26:27], v[26:27], v[234:235]
    v_pk_mul_f32 v[28:29], v[28:29], v[232:233]
    v_pk_mul_f32 v[30:31], v[30:31], v[234:235]
    s_waitcnt lgkmcnt(2)
    v_mfma_f32_16x16x32_bf16 v[236:239], v[172:175], a[232:235], v[236:239]
    v_cvt_pk_bf16_f32 v0, v0, v1
    v_cvt_pk_bf16_f32 v1, v2, v3
    v_mfma_f32_16x16x32_bf16 v[60:63], v[164:167], a[156:159], v[60:63]
    ds_write_b64 v224, v[0:1] offset:0
    ds_read_b128 a[72:75], v198 offset:40960
    ds_read_b128 a[76:79], v199 offset:40960
    v_cvt_pk_bf16_f32 v4, v4, v5
    v_cvt_pk_bf16_f32 v5, v6, v7
    v_cvt_pk_bf16_f32 v8, v8, v9
    v_cvt_pk_bf16_f32 v9, v10, v11
    v_cvt_pk_bf16_f32 v12, v12, v13
    v_cvt_pk_bf16_f32 v13, v14, v15
    ds_write_b64 v224, v[4:5] offset:128
    ds_write_b64 v225, v[8:9] offset:256
    ds_write_b64 v225, v[12:13] offset:384
    v_cvt_pk_bf16_f32 v16, v16, v17
    v_cvt_pk_bf16_f32 v17, v18, v19
    ds_read_b64_tr_b16 v[128:129], v226 offset:0
    ds_read_b64_tr_b16 v[130:131], v227 offset:0
    ds_read_b64_tr_b16 v[132:133], v226 offset:2048
    ds_read_b64_tr_b16 v[134:135], v227 offset:2048
    v_cvt_pk_bf16_f32 v20, v20, v21
    v_cvt_pk_bf16_f32 v21, v22, v23
    v_cvt_pk_bf16_f32 v24, v24, v25
    v_cvt_pk_bf16_f32 v25, v26, v27
    v_cvt_pk_bf16_f32 v28, v28, v29
    v_cvt_pk_bf16_f32 v29, v30, v31
    ds_write_b64 v224, v[16:17] offset:512
    ds_write_b64 v224, v[20:21] offset:640
    ds_write_b64 v225, v[24:25] offset:768
    v_rcp_f32 v236, v236
    v_rcp_f32 v237, v237
    ds_write_b64 v225, v[28:29] offset:896
    s_waitcnt lgkmcnt(6)
    buffer_store_dwordx4 v[128:131], v228, s[28:31], s50 offen offset:0 sc1 nt
    ds_read_b64_tr_b16 v[136:137], v226 offset:512
    ds_read_b64_tr_b16 v[138:139], v227 offset:512
    ds_read_b64_tr_b16 v[140:141], v226 offset:2560
    v_rcp_f32 v238, v238
    ds_read_b64_tr_b16 v[142:143], v227 offset:2560
    ds_read_b128 a[80:83], v196 offset:45056
    ds_read_b128 a[84:87], v197 offset:45056
    v_exp_f32 v150, v150
    v_rcp_f32 v239, v239
    v_cvt_pk_bf16_f32 v250, v148, v149
    v_pk_mul_f32 v[32:33], v[32:33], v[236:237]
    v_pk_mul_f32 v[34:35], v[34:35], v[238:239]
    v_pk_mul_f32 v[36:37], v[36:37], v[236:237]
    v_pk_mul_f32 v[38:39], v[38:39], v[238:239]
    v_pk_mul_f32 v[40:41], v[40:41], v[236:237]
    v_pk_mul_f32 v[42:43], v[42:43], v[238:239]
    v_pk_mul_f32 v[44:45], v[44:45], v[236:237]
    v_pk_mul_f32 v[46:47], v[46:47], v[238:239]
    v_exp_f32 v151, v151
    v_cvt_pk_bf16_f32 v32, v32, v33
    v_cvt_pk_bf16_f32 v251, v150, v151
    v_pk_mul_f32 v[48:49], v[48:49], v[236:237]
    v_pk_mul_f32 v[50:51], v[50:51], v[238:239]
    v_pk_mul_f32 v[52:53], v[52:53], v[236:237]
    v_pk_mul_f32 v[54:55], v[54:55], v[238:239]
    v_pk_mul_f32 v[56:57], v[56:57], v[236:237]
    v_pk_mul_f32 v[58:59], v[58:59], v[238:239]
    v_pk_mul_f32 v[60:61], v[60:61], v[236:237]
    v_pk_mul_f32 v[62:63], v[62:63], v[238:239]
    s_waitcnt lgkmcnt(10)
    buffer_store_dwordx4 v[132:135], v228, s[28:31], s50 offen offset:2048 sc1 nt
    ds_read_b128 a[88:91], v198 offset:45056
    ds_read_b128 a[92:95], v199 offset:45056
    ds_read_b128 a[96:99], v196 offset:49152
    ds_read_b128 a[100:103], v197 offset:49152
    ds_read_b128 a[104:107], v198 offset:49152
    v_exp_f32 v157, v157
    v_cvt_pk_bf16_f32 v33, v34, v35
    v_exp_f32 v158, v158
    v_cvt_pk_bf16_f32 v252, v152, v153
    v_exp_f32 v159, v159
    v_cvt_pk_bf16_f32 v36, v36, v37
    v_cvt_pk_bf16_f32 v253, v154, v155
    v_cvt_pk_bf16_f32 v37, v38, v39
    v_cvt_pk_bf16_f32 v254, v156, v157
    v_cvt_pk_bf16_f32 v255, v158, v159
    v_add_f32 v182, v182, v190
    ds_write_b64 v224, v[32:33] offset:4096
    ds_write_b64 v224, v[36:37] offset:4224
    v_mfma_f32_16x16x32_bf16 v[96:99], v[252:255], a[128:131], v[96:99]
    s_waitcnt lgkmcnt(11)
    buffer_store_dwordx4 v[136:139], v228, s[28:31], s50 offen offset:128 sc1 nt
    ds_read_b128 a[108:111], v199 offset:49152
    ds_read_b128 a[112:115], v196 offset:53248
    ds_read_b128 a[116:119], v197 offset:53248
    v_cvt_pk_bf16_f32 v40, v40, v41
    v_add_f32 v183, v183, v191
    v_mfma_f32_16x16x32_bf16 v[100:103], v[252:255], a[132:135], v[100:103]
    ds_read_b128 a[120:123], v198 offset:53248
    ds_read_b128 a[124:127], v199 offset:53248
    v_add_f32 v182, v182, v183
    v_cvt_pk_bf16_f32 v41, v42, v43
    v_mov_b32 v183, v182
    v_cvt_pk_bf16_f32 v44, v44, v45
    v_cvt_pk_bf16_f32 v45, v46, v47
    v_permlane32_swap_b32 v182, v183
    v_add_f32 v182, v182, v183
    v_mov_b32 v183, v182
    ds_write_b64 v225, v[40:41] offset:4352
    v_mfma_f32_16x16x32_bf16 v[104:107], v[252:255], a[136:139], v[104:107]
    ds_write_b64 v225, v[44:45] offset:4480
    v_mfma_f32_16x16x32_bf16 v[108:111], v[252:255], a[140:143], v[108:111]
    s_waitcnt lgkmcnt(14)
    buffer_store_dwordx4 v[140:143], v228, s[28:31], s50 offen offset:2176 sc1 nt
    v_mfma_f32_16x16x32_bf16 v[112:115], v[252:255], a[144:147], v[112:115]
    ds_read_b64_tr_b16 v[0:1], v226 offset:4096
    ds_read_b64_tr_b16 a[0:1], v200 offset:40960
    v_mfma_f32_16x16x32_bf16 v[116:119], v[252:255], a[148:151], v[116:119]
    ds_read_b64_tr_b16 v[2:3], v227 offset:4096
    ds_read_b64_tr_b16 a[2:3], v200 offset:45056
    ds_read_b64_tr_b16 v[4:5], v226 offset:6144
    ds_read_b64_tr_b16 a[4:5], v201 offset:40960
    ds_read_b64_tr_b16 v[6:7], v227 offset:6144
    ds_read_b64_tr_b16 a[6:7], v201 offset:45056
    ds_read_b64_tr_b16 a[8:9], v202 offset:40960
    ds_read_b64_tr_b16 a[10:11], v202 offset:45056
    ds_read_b64_tr_b16 a[12:13], v203 offset:40960
    ds_read_b64_tr_b16 a[14:15], v203 offset:45056
    ds_read_b64_tr_b16 a[16:17], v204 offset:40960
    ds_read_b64_tr_b16 a[18:19], v204 offset:45056
    ds_read_b64_tr_b16 a[20:21], v205 offset:40960
    ds_read_b64_tr_b16 a[22:23], v205 offset:45056
    ds_read_b64_tr_b16 a[24:25], v206 offset:40960
    ds_read_b64_tr_b16 a[26:27], v206 offset:45056
    ds_read_b64_tr_b16 a[28:29], v207 offset:40960
    ds_read_b64_tr_b16 a[30:31], v207 offset:45056
    v_permlane16_swap_b32 v182, v183
    v_mfma_f32_16x16x32_bf16 v[120:123], v[252:255], a[152:155], v[120:123]
    s_waitcnt lgkmcnt(14)
    buffer_store_dwordx4 v[0:3], v228, s[28:31], s51 offen offset:0 sc1 nt
    v_mfma_f32_16x16x32_bf16 v[124:127], v[252:255], a[156:159], v[124:127]
    v_add_f32 v182, v182, v183
    v_add_f32 v180, v180, v188
    ds_bpermute_b32 v220, v229, v182 offset:0
    v_mfma_f32_16x16x32_bf16 v[64:67], v[248:251], a[128:131], v[64:67]
    ds_bpermute_b32 v221, v229, v182 offset:4
    v_mfma_f32_16x16x32_bf16 v[68:71], v[248:251], a[132:135], v[68:71]
    ds_bpermute_b32 v222, v229, v182 offset:8
    ds_bpermute_b32 v223, v229, v182 offset:12
    v_mfma_f32_16x16x32_bf16 v[72:75], v[248:251], a[136:139], v[72:75]
    ds_read_b128 a[200:203], v196 offset:57344
    ds_read_b128 a[204:207], v197 offset:57344
    v_mfma_f32_16x16x32_bf16 v[76:79], v[248:251], a[140:143], v[76:79]
    ds_read_b128 a[208:211], v198 offset:57344
    ds_read_b128 a[212:215], v199 offset:57344
    v_add_f32 v181, v181, v189
    v_mfma_f32_16x16x32_bf16 v[80:83], v[248:251], a[144:147], v[80:83]
    s_waitcnt lgkmcnt(14)
    buffer_store_dwordx4 v[4:7], v228, s[28:31], s51 offen offset:2048 sc1 nt
    ds_read_b128 a[216:219], v196 offset:61440
    v_add_f32 v180, v180, v181
    v_mfma_f32_16x16x32_bf16 v[84:87], v[248:251], a[148:151], v[84:87]
    v_mov_b32 v181, v180
    v_cvt_pk_bf16_f32 v48, v48, v49
    v_mfma_f32_16x16x32_bf16 v[88:91], v[248:251], a[152:155], v[88:91]
    ds_read_b128 a[220:223], v197 offset:61440
    v_permlane32_swap_b32 v180, v181
    v_mfma_f32_16x16x32_bf16 v[92:95], v[248:251], a[156:159], v[92:95]
    s_waitcnt lgkmcnt(6)
    ds_read_b128 a[224:227], v198 offset:61440
    v_add_f32 v180, v180, v181
    v_mfma_f32_16x16x32_bf16 v[220:223], v[252:255], a[232:235], v[220:223]
    ds_read_b128 a[228:231], v199 offset:61440
    v_mov_b32 v181, v180
    v_mfma_f32_16x16x32_bf16 v[144:147], a[64:67], a[32:35], 4.0
    s_nop 0
    v_permlane16_swap_b32 v180, v181
    v_mfma_f32_16x16x32_bf16 v[144:147], a[68:71], a[36:39], v[144:147]
    v_cvt_pk_bf16_f32 v49, v50, v51
    v_add_f32 v180, v180, v181
    v_mfma_f32_16x16x32_bf16 v[144:147], a[72:75], a[40:43], v[144:147]
    ds_write_b64 v224, v[48:49] offset:4608
    v_mfma_f32_16x16x32_bf16 v[144:147], a[76:79], a[44:47], v[144:147]
    ds_bpermute_b32 v216, v229, v180 offset:0
    v_mfma_f32_16x16x32_bf16 v[148:151], a[92:95], a[44:47], 4.0
    ds_bpermute_b32 v217, v229, v180 offset:4
    v_mfma_f32_16x16x32_bf16 v[148:151], a[88:91], a[40:43], v[148:151]
    ds_bpermute_b32 v218, v229, v180 offset:8
    v_mfma_f32_16x16x32_bf16 v[148:151], a[84:87], a[36:39], v[148:151]
    ds_bpermute_b32 v219, v229, v180 offset:12
    v_mfma_f32_16x16x32_bf16 v[148:151], a[80:83], a[32:35], v[148:151]
    ds_read_b64_tr_b16 a[160:161], v200 offset:49152
    ds_read_b64_tr_b16 a[162:163], v200 offset:53248
    v_cvt_pk_bf16_f32 v52, v52, v53
    v_cvt_pk_bf16_f32 v53, v54, v55
    v_cvt_pk_bf16_f32 v56, v56, v57
    v_cvt_pk_bf16_f32 v57, v58, v59
    ds_write_b64 v224, v[52:53] offset:4736
    v_mfma_f32_16x16x32_bf16 v[152:155], a[96:99], a[32:35], 4.0
    ds_write_b64 v225, v[56:57] offset:4864
    v_mfma_f32_16x16x32_bf16 v[152:155], a[100:103], a[36:39], v[152:155]
    ds_read_b64_tr_b16 a[164:165], v201 offset:49152
    ds_read_b64_tr_b16 a[166:167], v201 offset:53248
    v_mfma_f32_16x16x32_bf16 v[152:155], a[104:107], a[40:43], v[152:155]
    s_waitcnt lgkmcnt(6)
    ds_read_b64_tr_b16 a[168:169], v202 offset:49152
    ds_read_b64_tr_b16 a[170:171], v202 offset:53248
    ds_read_b64_tr_b16 a[172:173], v203 offset:49152
    v_mfma_f32_16x16x32_bf16 v[216:219], v[248:251], a[232:235], v[216:219]
    ds_read_b64_tr_b16 a[174:175], v203 offset:53248
    v_cvt_pk_bf16_f32 v60, v60, v61
    v_mfma_f32_16x16x32_bf16 v[152:155], a[108:111], a[44:47], v[152:155]
    v_cvt_pk_bf16_f32 v61, v62, v63
    v_exp_f32 v144, v144
    v_mfma_f32_16x16x32_bf16 v[156:159], a[124:127], a[44:47], 4.0
    ds_write_b64 v225, v[60:61] offset:4992
    v_mfma_f32_16x16x32_bf16 v[156:159], a[120:123], a[40:43], v[156:159]
    ds_read_b64_tr_b16 v[8:9], v226 offset:4608
    ds_read_b64_tr_b16 v[10:11], v227 offset:4608
    v_mfma_f32_16x16x32_bf16 v[156:159], a[116:119], a[36:39], v[156:159]
    ds_read_b64_tr_b16 v[12:13], v226 offset:6656
    ds_read_b64_tr_b16 v[14:15], v227 offset:6656
    v_mfma_f32_16x16x32_bf16 v[156:159], a[112:115], a[32:35], v[156:159]
    ds_read_b64_tr_b16 a[176:177], v204 offset:49152
    ds_read_b64_tr_b16 a[178:179], v204 offset:53248
    ds_read_b64_tr_b16 a[180:181], v205 offset:49152
    ds_read_b64_tr_b16 a[182:183], v205 offset:53248
    ds_read_b64_tr_b16 a[184:185], v206 offset:49152
    ds_read_b64_tr_b16 a[186:187], v206 offset:53248
    ds_read_b64_tr_b16 a[188:189], v207 offset:49152
    ds_read_b64_tr_b16 a[190:191], v207 offset:53248
    ds_read_b64_tr_b16 a[128:129], v200 offset:57344
    ds_read_b64_tr_b16 a[130:131], v200 offset:61440
    ds_read_b64_tr_b16 a[132:133], v201 offset:57344
    v_exp_f32 v145, v145
    v_exp_f32 v146, v146
    v_cvt_pk_bf16_f32 v160, v144, v145
    v_exp_f32 v147, v147
    s_waitcnt lgkmcnt(13)
    buffer_store_dwordx4 v[8:11], v228, s[28:31], s51 offen offset:128 sc1 nt
    ds_read_b64_tr_b16 a[134:135], v201 offset:61440
    ds_read_b64_tr_b16 a[136:137], v202 offset:57344
    v_cvt_pk_bf16_f32 v161, v146, v147
    v_mfma_f32_16x16x32_bf16 v[144:147], a[200:203], a[32:35], 4.0
    v_exp_f32 v148, v148
    v_mfma_f32_16x16x32_bf16 v[144:147], a[204:207], a[36:39], v[144:147]
    v_exp_f32 v149, v149
    v_mfma_f32_16x16x32_bf16 v[144:147], a[208:211], a[40:43], v[144:147]
    ds_read_b64_tr_b16 a[138:139], v202 offset:61440
    v_cvt_pk_bf16_f32 v162, v148, v149
    v_mfma_f32_16x16x32_bf16 v[144:147], a[212:215], a[44:47], v[144:147]
    v_exp_f32 v150, v150
    v_exp_f32 v151, v151
    v_exp_f32 v152, v152
    v_cvt_pk_bf16_f32 v163, v150, v151
    v_mfma_f32_16x16x32_bf16 v[148:151], a[228:231], a[44:47], 4.0
    ds_read_b64_tr_b16 a[140:141], v203 offset:57344
    ds_read_b64_tr_b16 a[142:143], v203 offset:61440
    v_mfma_f32_16x16x32_bf16 v[216:219], v[160:163], a[232:235], v[216:219]
    s_waitcnt lgkmcnt(14)
    buffer_store_dwordx4 v[12:15], v228, s[28:31], s51 offen offset:2176 sc1 nt
    v_mfma_f32_16x16x32_bf16 v[64:67], v[160:163], a[0:3], v[64:67]
    ds_read_b64_tr_b16 a[144:145], v204 offset:57344
    ds_read_b64_tr_b16 a[146:147], v204 offset:61440
    v_mfma_f32_16x16x32_bf16 v[68:71], v[160:163], a[4:7], v[68:71]
    ds_read_b64_tr_b16 a[148:149], v205 offset:57344
    v_exp_f32 v153, v153
    v_mfma_f32_16x16x32_bf16 v[72:75], v[160:163], a[8:11], v[72:75]
    ds_read_b64_tr_b16 a[150:151], v205 offset:61440
    v_cvt_pk_bf16_f32 v164, v152, v153
    v_mfma_f32_16x16x32_bf16 v[76:79], v[160:163], a[12:15], v[76:79]
    ds_read_b64_tr_b16 a[152:153], v206 offset:57344
    v_exp_f32 v154, v154
    v_mfma_f32_16x16x32_bf16 v[80:83], v[160:163], a[16:19], v[80:83]
    v_exp_f32 v155, v155
    v_mfma_f32_16x16x32_bf16 v[84:87], v[160:163], a[20:23], v[84:87]
    ds_read_b64_tr_b16 a[154:155], v206 offset:61440
    v_cvt_pk_bf16_f32 v165, v154, v155
    v_mfma_f32_16x16x32_bf16 v[88:91], v[160:163], a[24:27], v[88:91]
    ds_read_b64_tr_b16 a[156:157], v207 offset:57344
    v_exp_f32 v156, v156
    v_mfma_f32_16x16x32_bf16 v[92:95], v[160:163], a[28:31], v[92:95]
    v_exp_f32 v157, v157
    v_mfma_f32_16x16x32_bf16 v[148:151], a[224:227], a[40:43], v[148:151]
    ds_read_b64_tr_b16 a[158:159], v207 offset:61440
    v_cvt_pk_bf16_f32 v166, v156, v157
    v_mfma_f32_16x16x32_bf16 v[148:151], a[220:223], a[36:39], v[148:151]
    v_exp_f32 v158, v158
    v_mfma_f32_16x16x32_bf16 v[148:151], a[216:219], a[32:35], v[148:151]
    v_exp_f32 v159, v159
    v_exp_f32 v144, v144
    v_cvt_pk_bf16_f32 v167, v158, v159
    v_exp_f32 v145, v145
    s_nop 0
    v_mfma_f32_16x16x32_bf16 v[216:219], v[164:167], a[232:235], v[216:219]
    v_cvt_pk_bf16_f32 v168, v144, v145
    v_minimum3_f32 v230, v232, v233, v232
    v_mfma_f32_16x16x32_bf16 v[64:67], v[164:167], a[160:163], v[64:67]
    v_exp_f32 v146, v146
    v_mfma_f32_16x16x32_bf16 v[68:71], v[164:167], a[164:167], v[68:71]
    v_exp_f32 v147, v147
    v_mfma_f32_16x16x32_bf16 v[72:75], v[164:167], a[168:171], v[72:75]
    v_cvt_pk_bf16_f32 v169, v146, v147
    v_maximum3_f32 v231, v232, v233, v232
    v_mfma_f32_16x16x32_bf16 v[76:79], v[164:167], a[172:175], v[76:79]
    v_exp_f32 v148, v148
    v_mfma_f32_16x16x32_bf16 v[80:83], v[164:167], a[176:179], v[80:83]
    s_waitcnt lgkmcnt(14)
    v_exp_f32 v149, v149
    v_mfma_f32_16x16x32_bf16 v[84:87], v[164:167], a[180:183], v[84:87]
    v_cvt_pk_bf16_f32 v170, v148, v149
    v_minimum3_f32 v230, v234, v235, v230
    v_mfma_f32_16x16x32_bf16 v[88:91], v[164:167], a[184:187], v[88:91]
    v_exp_f32 v150, v150
    v_mfma_f32_16x16x32_bf16 v[92:95], v[164:167], a[188:191], v[92:95]
    v_exp_f32 v151, v151
    v_maximum3_f32 v231, v234, v235, v231
    v_cvt_pk_bf16_f32 v171, v150, v151
    v_minimum3_f32 v230, v236, v237, v230
    v_maximum3_f32 v231, v236, v237, v231
    v_mfma_f32_16x16x32_bf16 v[216:219], v[168:171], a[232:235], v[216:219]
    v_minimum3_f32 v230, v238, v239, v230
    v_maximum3_f32 v231, v238, v239, v231
    v_mfma_f32_16x16x32_bf16 v[64:67], v[168:171], a[128:131], v[64:67]
    s_waitcnt lgkmcnt(12)
    v_mfma_f32_16x16x32_bf16 v[68:71], v[168:171], a[132:135], v[68:71]
    s_waitcnt lgkmcnt(10)
    v_mfma_f32_16x16x32_bf16 v[72:75], v[168:171], a[136:139], v[72:75]
    s_waitcnt lgkmcnt(8)
    v_mfma_f32_16x16x32_bf16 v[76:79], v[168:171], a[140:143], v[76:79]
    s_waitcnt lgkmcnt(6)
    v_rcp_f32 v216, v216
    v_mfma_f32_16x16x32_bf16 v[80:83], v[168:171], a[144:147], v[80:83]
    s_waitcnt lgkmcnt(4)
    v_rcp_f32 v217, v217
    v_mfma_f32_16x16x32_bf16 v[84:87], v[168:171], a[148:151], v[84:87]
    s_waitcnt lgkmcnt(2)
    v_rcp_f32 v218, v218
    v_mfma_f32_16x16x32_bf16 v[88:91], v[168:171], a[152:155], v[88:91]
    s_waitcnt lgkmcnt(0)
    v_rcp_f32 v219, v219
    v_mfma_f32_16x16x32_bf16 v[92:95], v[168:171], a[156:159], v[92:95]
    v_minimum3_f32 v230, v216, v217, v230
    v_maximum3_f32 v231, v216, v217, v231
    v_minimum3_f32 v230, v218, v219, v230
    v_maximum3_f32 v231, v218, v219, v231
    v_pk_mul_f32 v[64:65], v[64:65], v[216:217]
    v_pk_mul_f32 v[66:67], v[66:67], v[218:219]
    v_pk_mul_f32 v[68:69], v[68:69], v[216:217]
    v_pk_mul_f32 v[70:71], v[70:71], v[218:219]
    v_pk_mul_f32 v[72:73], v[72:73], v[216:217]
    v_pk_mul_f32 v[74:75], v[74:75], v[218:219]
    v_pk_mul_f32 v[76:77], v[76:77], v[216:217]
    v_pk_mul_f32 v[78:79], v[78:79], v[218:219]
    v_mfma_f32_16x16x32_bf16 v[152:155], a[64:67], a[48:51], 4.0
    v_cvt_pk_bf16_f32 v64, v64, v65
    v_cvt_pk_bf16_f32 v65, v66, v67
    v_cvt_pk_bf16_f32 v68, v68, v69
    v_cvt_pk_bf16_f32 v69, v70, v71
    v_cvt_pk_bf16_f32 v72, v72, v73
    v_pk_mul_f32 v[80:81], v[80:81], v[216:217]
    v_pk_mul_f32 v[82:83], v[82:83], v[218:219]
    v_pk_mul_f32 v[84:85], v[84:85], v[216:217]
    v_pk_mul_f32 v[86:87], v[86:87], v[218:219]
    v_pk_mul_f32 v[88:89], v[88:89], v[216:217]
    v_pk_mul_f32 v[90:91], v[90:91], v[218:219]
    v_pk_mul_f32 v[92:93], v[92:93], v[216:217]
    v_pk_mul_f32 v[94:95], v[94:95], v[218:219]
    v_mfma_f32_16x16x32_bf16 v[152:155], a[68:71], a[52:55], v[152:155]
    ds_write_b64 v224, v[64:65] offset:0
    v_mfma_f32_16x16x32_bf16 v[152:155], a[72:75], a[56:59], v[152:155]
    ds_write_b64 v224, v[68:69] offset:128
    v_mfma_f32_16x16x32_bf16 v[152:155], a[76:79], a[60:63], v[152:155]
    v_cvt_pk_bf16_f32 v73, v74, v75
    v_cvt_pk_bf16_f32 v76, v76, v77
    v_mfma_f32_16x16x32_bf16 v[156:159], a[92:95], a[60:63], 4.0
    ds_write_b64 v225, v[72:73] offset:256
    v_mfma_f32_16x16x32_bf16 v[156:159], a[88:91], a[56:59], v[156:159]
    v_cvt_pk_bf16_f32 v77, v78, v79
    v_cvt_pk_bf16_f32 v80, v80, v81
    v_mfma_f32_16x16x32_bf16 v[156:159], a[84:87], a[52:55], v[156:159]
    ds_write_b64 v225, v[76:77] offset:384
    v_mfma_f32_16x16x32_bf16 v[156:159], a[80:83], a[48:51], v[156:159]
    ds_read_b64_tr_b16 v[32:33], v226 offset:0
    ds_read_b64_tr_b16 v[34:35], v227 offset:0
    v_mfma_f32_16x16x32_bf16 v[144:147], a[96:99], a[48:51], 4.0
    ds_read_b64_tr_b16 v[36:37], v226 offset:2048
    ds_read_b64_tr_b16 v[38:39], v227 offset:2048
    v_mfma_f32_16x16x32_bf16 v[144:147], a[100:103], a[52:55], v[144:147]
    v_cvt_pk_bf16_f32 v81, v82, v83
    v_cvt_pk_bf16_f32 v84, v84, v85
    v_mfma_f32_16x16x32_bf16 v[144:147], a[104:107], a[56:59], v[144:147]
    ds_write_b64 v224, v[80:81] offset:512
    v_mfma_f32_16x16x32_bf16 v[144:147], a[108:111], a[60:63], v[144:147]
    v_cvt_pk_bf16_f32 v85, v86, v87
    v_cvt_pk_bf16_f32 v88, v88, v89
    v_mfma_f32_16x16x32_bf16 v[148:151], a[124:127], a[60:63], 4.0
    ds_write_b64 v224, v[84:85] offset:640
    v_mfma_f32_16x16x32_bf16 v[148:151], a[120:123], a[56:59], v[148:151]
    v_cvt_pk_bf16_f32 v89, v90, v91
    v_cvt_pk_bf16_f32 v92, v92, v93
    v_mfma_f32_16x16x32_bf16 v[148:151], a[116:119], a[52:55], v[148:151]
    s_waitcnt lgkmcnt(4)
    buffer_store_dwordx4 v[32:35], v228, s[28:31], s52 offen offset:0 sc1 nt
    v_mfma_f32_16x16x32_bf16 v[148:151], a[112:115], a[48:51], v[148:151]
    ds_write_b64 v225, v[88:89] offset:768
    v_cvt_pk_bf16_f32 v93, v94, v95
    ds_write_b64 v225, v[92:93] offset:896
    ds_read_b64_tr_b16 v[40:41], v226 offset:512
    ds_read_b64_tr_b16 v[42:43], v227 offset:512
    ds_read_b64_tr_b16 v[44:45], v226 offset:2560
    ds_read_b64_tr_b16 v[46:47], v227 offset:2560
    v_exp_f32 v152, v152
    v_exp_f32 v153, v153
    v_exp_f32 v154, v154
    v_cvt_pk_bf16_f32 v172, v152, v153
    v_exp_f32 v155, v155
    v_exp_f32 v156, v156
    v_cvt_pk_bf16_f32 v173, v154, v155
    v_mfma_f32_16x16x32_bf16 v[152:155], a[200:203], a[48:51], 4.0
    s_waitcnt lgkmcnt(8)
    buffer_store_dwordx4 v[36:39], v228, s[28:31], s52 offen offset:2048 sc1 nt
    v_mfma_f32_16x16x32_bf16 v[152:155], a[204:207], a[52:55], v[152:155]
    v_exp_f32 v157, v157
    v_mfma_f32_16x16x32_bf16 v[152:155], a[208:211], a[56:59], v[152:155]
    v_cvt_pk_bf16_f32 v174, v156, v157
    v_exp_f32 v158, v158
    v_mfma_f32_16x16x32_bf16 v[152:155], a[212:215], a[60:63], v[152:155]
    v_exp_f32 v159, v159
    v_exp_f32 v144, v144
    v_cvt_pk_bf16_f32 v175, v158, v159
    v_mfma_f32_16x16x32_bf16 v[156:159], a[228:231], a[60:63], 4.0
    v_exp_f32 v145, v145
    v_mfma_f32_16x16x32_bf16 v[220:223], v[172:175], a[232:235], v[220:223]
    v_cvt_pk_bf16_f32 v160, v144, v145
    v_exp_f32 v146, v146
    v_mfma_f32_16x16x32_bf16 v[96:99], v[172:175], a[0:3], v[96:99]
    v_exp_f32 v147, v147
    v_mfma_f32_16x16x32_bf16 v[100:103], v[172:175], a[4:7], v[100:103]
    s_waitcnt lgkmcnt(2)
    buffer_store_dwordx4 v[40:43], v228, s[28:31], s52 offen offset:128 sc1 nt
    v_mfma_f32_16x16x32_bf16 v[104:107], v[172:175], a[8:11], v[104:107]
    v_cvt_pk_bf16_f32 v161, v146, v147
    v_exp_f32 v148, v148
    v_mfma_f32_16x16x32_bf16 v[108:111], v[172:175], a[12:15], v[108:111]
    v_exp_f32 v149, v149
    v_mfma_f32_16x16x32_bf16 v[156:159], a[224:227], a[56:59], v[156:159]
    v_cvt_pk_bf16_f32 v162, v148, v149
    v_exp_f32 v150, v150
    v_mfma_f32_16x16x32_bf16 v[156:159], a[220:223], a[52:55], v[156:159]
    v_exp_f32 v151, v151
    v_mfma_f32_16x16x32_bf16 v[156:159], a[216:219], a[48:51], v[156:159]
    v_cvt_pk_bf16_f32 v163, v150, v151
    v_exp_f32 v152, v152
    s_nop 0
    v_mfma_f32_16x16x32_bf16 v[220:223], v[160:163], a[232:235], v[220:223]
    v_exp_f32 v153, v153
    v_mfma_f32_16x16x32_bf16 v[96:99], v[160:163], a[160:163], v[96:99]
    v_cvt_pk_bf16_f32 v164, v152, v153
    v_exp_f32 v154, v154
    v_mfma_f32_16x16x32_bf16 v[100:103], v[160:163], a[164:167], v[100:103]
    s_waitcnt lgkmcnt(0)
    buffer_store_dwordx4 v[44:47], v228, s[28:31], s52 offen offset:2176 sc1 nt
    v_mfma_f32_16x16x32_bf16 v[104:107], v[160:163], a[168:171], v[104:107]
    v_exp_f32 v155, v155
    v_mfma_f32_16x16x32_bf16 v[108:111], v[160:163], a[172:175], v[108:111]
    v_cvt_pk_bf16_f32 v165, v154, v155
    v_exp_f32 v156, v156
    v_mfma_f32_16x16x32_bf16 v[112:115], v[172:175], a[16:19], v[112:115]
    v_exp_f32 v157, v157
    v_mfma_f32_16x16x32_bf16 v[116:119], v[172:175], a[20:23], v[116:119]
    v_cvt_pk_bf16_f32 v166, v156, v157
    v_exp_f32 v158, v158
    v_mfma_f32_16x16x32_bf16 v[120:123], v[172:175], a[24:27], v[120:123]
    v_exp_f32 v159, v159
    v_mfma_f32_16x16x32_bf16 v[124:127], v[172:175], a[28:31], v[124:127]
    v_cvt_pk_bf16_f32 v167, v158, v159
    v_mfma_f32_16x16x32_bf16 v[112:115], v[160:163], a[176:179], v[112:115]
    s_nop 0
    v_mfma_f32_16x16x32_bf16 v[220:223], v[164:167], a[232:235], v[220:223]
    v_mfma_f32_16x16x32_bf16 v[96:99], v[164:167], a[128:131], v[96:99]
    v_mfma_f32_16x16x32_bf16 v[100:103], v[164:167], a[132:135], v[100:103]
    v_mfma_f32_16x16x32_bf16 v[104:107], v[164:167], a[136:139], v[104:107]
    v_mfma_f32_16x16x32_bf16 v[108:111], v[164:167], a[140:143], v[108:111]
    s_nop 3
    v_rcp_f32 v220, v220
    v_mfma_f32_16x16x32_bf16 v[116:119], v[160:163], a[180:183], v[116:119]
    v_rcp_f32 v221, v221
    v_mfma_f32_16x16x32_bf16 v[120:123], v[160:163], a[184:187], v[120:123]
    v_rcp_f32 v222, v222
    v_mfma_f32_16x16x32_bf16 v[124:127], v[160:163], a[188:191], v[124:127]
    v_rcp_f32 v223, v223
    v_mfma_f32_16x16x32_bf16 v[112:115], v[164:167], a[144:147], v[112:115]
    v_minimum3_f32 v230, v220, v221, v230
    v_maximum3_f32 v231, v220, v221, v231
    v_minimum3_f32 v230, v222, v223, v230
    v_maximum3_f32 v231, v222, v223, v231
    v_mul_f32 v231, 0x23800000, v231
    v_pk_mul_f32 v[96:97], v[96:97], v[220:221]
    v_pk_mul_f32 v[98:99], v[98:99], v[222:223]
    v_pk_mul_f32 v[100:101], v[100:101], v[220:221]
    v_pk_mul_f32 v[102:103], v[102:103], v[222:223]
    v_pk_mul_f32 v[104:105], v[104:105], v[220:221]
    v_pk_mul_f32 v[106:107], v[106:107], v[222:223]
    v_pk_mul_f32 v[108:109], v[108:109], v[220:221]
    v_pk_mul_f32 v[110:111], v[110:111], v[222:223]
    v_mfma_f32_16x16x32_bf16 v[116:119], v[164:167], a[148:151], v[116:119]
    v_cvt_pk_bf16_f32 v96, v96, v97
    v_cvt_pk_bf16_f32 v97, v98, v99
    v_mfma_f32_16x16x32_bf16 v[120:123], v[164:167], a[152:155], v[120:123]
    ds_write_b64 v224, v[96:97] offset:4096
    v_mfma_f32_16x16x32_bf16 v[124:127], v[164:167], a[156:159], v[124:127]
    v_cvt_pk_bf16_f32 v100, v100, v101
    v_cvt_pk_bf16_f32 v101, v102, v103
    v_cvt_pk_bf16_f32 v104, v104, v105
    v_cvt_pk_bf16_f32 v105, v106, v107
    v_cvt_pk_bf16_f32 v108, v108, v109
    v_cvt_pk_bf16_f32 v109, v110, v111
    ds_write_b64 v224, v[100:101] offset:4224
    ds_write_b64 v225, v[104:105] offset:4352
    ds_write_b64 v225, v[108:109] offset:4480
    v_pk_mul_f32 v[112:113], v[112:113], v[220:221]
    v_pk_mul_f32 v[114:115], v[114:115], v[222:223]
    v_pk_mul_f32 v[116:117], v[116:117], v[220:221]
    v_pk_mul_f32 v[118:119], v[118:119], v[222:223]
    v_pk_mul_f32 v[120:121], v[120:121], v[220:221]
    v_pk_mul_f32 v[122:123], v[122:123], v[222:223]
    v_pk_mul_f32 v[124:125], v[124:125], v[220:221]
    v_pk_mul_f32 v[126:127], v[126:127], v[222:223]
    ds_read_b64_tr_b16 v[64:65], v226 offset:4096
    ds_read_b64_tr_b16 v[66:67], v227 offset:4096
    ds_read_b64_tr_b16 v[68:69], v226 offset:6144
    ds_read_b64_tr_b16 v[70:71], v227 offset:6144
    v_mul_f32 v230, 0x5f800000, v230
    v_cmp_nge_f32 s[70:71], 1.0, v231
    v_cmp_nle_f32 s[72:73], 1.0, v230
    v_cvt_pk_bf16_f32 v112, v112, v113
    v_cvt_pk_bf16_f32 v113, v114, v115
L_hop3_2:
    s_cbranch_vccnz L_main
    s_or_b64 s[70:71], s[70:71], s[72:73]
    v_cvt_pk_bf16_f32 v116, v116, v117
    v_cvt_pk_bf16_f32 v117, v118, v119
    s_cbranch_scc1 L_general
    v_cvt_pk_bf16_f32 v120, v120, v121
    v_cvt_pk_bf16_f32 v121, v122, v123
    v_cvt_pk_bf16_f32 v124, v124, v125
    v_cvt_pk_bf16_f32 v125, v126, v127
    ds_write_b64 v224, v[112:113] offset:4608
    ds_write_b64 v224, v[116:117] offset:4736
    ds_write_b64 v225, v[120:121] offset:4864
    s_waitcnt lgkmcnt(5)
    buffer_store_dwordx4 v[64:67], v228, s[28:31], s53 offen offset:0 sc1 nt
    ds_write_b64 v225, v[124:125] offset:4992
    ds_read_b64_tr_b16 v[72:73], v226 offset:4608
    ds_read_b64_tr_b16 v[74:75], v227 offset:4608
    ds_read_b64_tr_b16 v[76:77], v226 offset:6656
    ds_read_b64_tr_b16 v[78:79], v227 offset:6656
    s_waitcnt lgkmcnt(8)
    buffer_store_dwordx4 v[68:71], v228, s[28:31], s53 offen offset:2048 sc1 nt
    s_waitcnt lgkmcnt(2)
    buffer_store_dwordx4 v[72:75], v228, s[28:31], s53 offen offset:128 sc1 nt
    s_waitcnt lgkmcnt(0)
    buffer_store_dwordx4 v[76:79], v228, s[28:31], s53 offen offset:2176 sc1 nt
L_end:
    s_endpgm
L_general:
    s_nop 15
    s_waitcnt vmcnt(0) lgkmcnt(0)
    buffer_load_dwordx4 v[64:67], v194, s[20:23], s50 offen offset:0 nt
    buffer_load_dwordx4 v[68:71], v194, s[20:23], s50 offen offset:1024 nt
    buffer_load_dwordx4 v[72:75], v194, s[20:23], s50 offen offset:2048 nt
    buffer_load_dwordx4 v[76:79], v194, s[20:23], s50 offen offset:3072 nt
    buffer_load_dwordx4 v[80:83], v194, s[20:23], s51 offen offset:0 nt
    buffer_load_dwordx4 v[84:87], v194, s[20:23], s51 offen offset:1024 nt
    buffer_load_dwordx4 v[88:91], v194, s[20:23], s51 offen offset:2048 nt
    buffer_load_dwordx4 v[92:95], v194, s[20:23], s51 offen offset:3072 nt
    buffer_load_dwordx4 v[96:99], v194, s[20:23], s52 offen offset:0 nt
    buffer_load_dwordx4 v[100:103], v194, s[20:23], s52 offen offset:1024 nt
    buffer_load_dwordx4 v[104:107], v194, s[20:23], s52 offen offset:2048 nt
    buffer_load_dwordx4 v[108:111], v194, s[20:23], s52 offen offset:3072 nt
    buffer_load_dwordx4 v[112:115], v194, s[20:23], s53 offen offset:0 nt
    buffer_load_dwordx4 v[116:119], v194, s[20:23], s53 offen offset:1024 nt
    buffer_load_dwordx4 v[120:123], v194, s[20:23], s53 offen offset:2048 nt
    buffer_load_dwordx4 v[124:127], v194, s[20:23], s53 offen offset:3072 nt
    v_and_b32 v232, 15, v193
    v_lshrrev_b32 v233, 4, v193
    v_xor_b32 v234, v232, v233
    v_lshlrev_b32 v234, 4, v234
    v_lshl_add_u32 v220, v233, 8, v234
    v_add_u32 v220, s63, v220
    v_xor_b32 v221, 64, v220
    v_xor_b32 v222, 128, v220
    v_xor_b32 v223, 192, v220
    v_add_u32 v232, s63, v196
    v_add_u32 v233, s63, v197
    v_add_u32 v234, s63, v198
    v_add_u32 v235, s63, v199
    s_mov_b32 s70, s61
    s_mov_b32 s71, s61
    s_waitcnt vmcnt(0)
    v_lshlrev_b32 v240, 16, v64
    v_and_b32 v241, 0xffff0000, v64
    v_lshlrev_b32 v242, 16, v65
    v_and_b32 v243, 0xffff0000, v65
    v_lshlrev_b32 v244, 16, v66
    v_and_b32 v245, 0xffff0000, v66
    v_lshlrev_b32 v246, 16, v67
    v_and_b32 v247, 0xffff0000, v67
    v_pk_mul_f32 v[240:241], v[240:241], s[70:71]
    v_pk_mul_f32 v[242:243], v[242:243], s[70:71]
    v_pk_mul_f32 v[244:245], v[244:245], s[70:71]
    v_pk_mul_f32 v[246:247], v[246:247], s[70:71]
    v_cvt_pk_bf16_f32 v64, v240, v241
    v_cvt_pk_bf16_f32 v65, v242, v243
    v_cvt_pk_bf16_f32 v66, v244, v245
    v_cvt_pk_bf16_f32 v67, v246, v247
    ds_write_b128 v220, v[64:67] offset:0
    v_lshlrev_b32 v240, 16, v68
    v_and_b32 v241, 0xffff0000, v68
    v_lshlrev_b32 v242, 16, v69
    v_and_b32 v243, 0xffff0000, v69
    v_lshlrev_b32 v244, 16, v70
    v_and_b32 v245, 0xffff0000, v70
    v_lshlrev_b32 v246, 16, v71
    v_and_b32 v247, 0xffff0000, v71
    v_pk_mul_f32 v[240:241], v[240:241], s[70:71]
    v_pk_mul_f32 v[242:243], v[242:243], s[70:71]
    v_pk_mul_f32 v[244:245], v[244:245], s[70:71]
    v_pk_mul_f32 v[246:247], v[246:247], s[70:71]
    v_cvt_pk_bf16_f32 v68, v240, v241
    v_cvt_pk_bf16_f32 v69, v242, v243
    v_cvt_pk_bf16_f32 v70, v244, v245
    v_cvt_pk_bf16_f32 v71, v246, v247
    ds_write_b128 v221, v[68:71] offset:1024
    v_lshlrev_b32 v240, 16, v72
    v_and_b32 v241, 0xffff0000, v72
    v_lshlrev_b32 v242, 16, v73
    v_and_b32 v243, 0xffff0000, v73
    v_lshlrev_b32 v244, 16, v74
    v_and_b32 v245, 0xffff0000, v74
    v_lshlrev_b32 v246, 16, v75
    v_and_b32 v247, 0xffff0000, v75
    v_pk_mul_f32 v[240:241], v[240:241], s[70:71]
    v_pk_mul_f32 v[242:243], v[242:243], s[70:71]
    v_pk_mul_f32 v[244:245], v[244:245], s[70:71]
    v_pk_mul_f32 v[246:247], v[246:247], s[70:71]
    v_cvt_pk_bf16_f32 v72, v240, v241
    v_cvt_pk_bf16_f32 v73, v242, v243
    v_cvt_pk_bf16_f32 v74, v244, v245
    v_cvt_pk_bf16_f32 v75, v246, v247
    ds_write_b128 v222, v[72:75] offset:2048
    v_lshlrev_b32 v240, 16, v76
    v_and_b32 v241, 0xffff0000, v76
    v_lshlrev_b32 v242, 16, v77
    v_and_b32 v243, 0xffff0000, v77
    v_lshlrev_b32 v244, 16, v78
    v_and_b32 v245, 0xffff0000, v78
    v_lshlrev_b32 v246, 16, v79
    v_and_b32 v247, 0xffff0000, v79
    v_pk_mul_f32 v[240:241], v[240:241], s[70:71]
    v_pk_mul_f32 v[242:243], v[242:243], s[70:71]
    v_pk_mul_f32 v[244:245], v[244:245], s[70:71]
    v_pk_mul_f32 v[246:247], v[246:247], s[70:71]
    v_cvt_pk_bf16_f32 v76, v240, v241
    v_cvt_pk_bf16_f32 v77, v242, v243
    v_cvt_pk_bf16_f32 v78, v244, v245
    v_cvt_pk_bf16_f32 v79, v246, v247
    ds_write_b128 v223, v[76:79] offset:3072
    ds_read_b128 a[0:3], v232 offset:0
    ds_read_b128 a[4:7], v233 offset:0
    ds_read_b128 a[8:11], v234 offset:0
    ds_read_b128 a[12:15], v235 offset:0
    v_lshlrev_b32 v240, 16, v80
    v_and_b32 v241, 0xffff0000, v80
    v_lshlrev_b32 v242, 16, v81
    v_and_b32 v243, 0xffff0000, v81
    v_lshlrev_b32 v244, 16, v82
    v_and_b32 v245, 0xffff0000, v82
    v_lshlrev_b32 v246, 16, v83
    v_and_b32 v247, 0xffff0000, v83
    v_pk_mul_f32 v[240:241], v[240:241], s[70:71]
    v_pk_mul_f32 v[242:243], v[242:243], s[70:71]
    v_pk_mul_f32 v[244:245], v[244:245], s[70:71]
    v_pk_mul_f32 v[246:247], v[246:247], s[70:71]
    v_cvt_pk_bf16_f32 v80, v240, v241
    v_cvt_pk_bf16_f32 v81, v242, v243
    v_cvt_pk_bf16_f32 v82, v244, v245
    v_cvt_pk_bf16_f32 v83, v246, v247
    ds_write_b128 v220, v[80:83] offset:4096
    v_lshlrev_b32 v240, 16, v84
    v_and_b32 v241, 0xffff0000, v84
    v_lshlrev_b32 v242, 16, v85
    v_and_b32 v243, 0xffff0000, v85
    v_lshlrev_b32 v244, 16, v86
    v_and_b32 v245, 0xffff0000, v86
    v_lshlrev_b32 v246, 16, v87
    v_and_b32 v247, 0xffff0000, v87
    v_pk_mul_f32 v[240:241], v[240:241], s[70:71]
    v_pk_mul_f32 v[242:243], v[242:243], s[70:71]
    v_pk_mul_f32 v[244:245], v[244:245], s[70:71]
    v_pk_mul_f32 v[246:247], v[246:247], s[70:71]
    v_cvt_pk_bf16_f32 v84, v240, v241
    v_cvt_pk_bf16_f32 v85, v242, v243
    v_cvt_pk_bf16_f32 v86, v244, v245
    v_cvt_pk_bf16_f32 v87, v246, v247
    ds_write_b128 v221, v[84:87] offset:5120
    v_lshlrev_b32 v240, 16, v88
    v_and_b32 v241, 0xffff0000, v88
    v_lshlrev_b32 v242, 16, v89
    v_and_b32 v243, 0xffff0000, v89
    v_lshlrev_b32 v244, 16, v90
    v_and_b32 v245, 0xffff0000, v90
    v_lshlrev_b32 v246, 16, v91
    v_and_b32 v247, 0xffff0000, v91
    v_pk_mul_f32 v[240:241], v[240:241], s[70:71]
    v_pk_mul_f32 v[242:243], v[242:243], s[70:71]
    v_pk_mul_f32 v[244:245], v[244:245], s[70:71]
    v_pk_mul_f32 v[246:247], v[246:247], s[70:71]
    v_cvt_pk_bf16_f32 v88, v240, v241
    v_cvt_pk_bf16_f32 v89, v242, v243
    v_cvt_pk_bf16_f32 v90, v244, v245
    v_cvt_pk_bf16_f32 v91, v246, v247
    ds_write_b128 v222, v[88:91] offset:6144
    v_lshlrev_b32 v240, 16, v92
    v_and_b32 v241, 0xffff0000, v92
    v_lshlrev_b32 v242, 16, v93
    v_and_b32 v243, 0xffff0000, v93
    v_lshlrev_b32 v244, 16, v94
    v_and_b32 v245, 0xffff0000, v94
    v_lshlrev_b32 v246, 16, v95
    v_and_b32 v247, 0xffff0000, v95
    v_pk_mul_f32 v[240:241], v[240:241], s[70:71]
    v_pk_mul_f32 v[242:243], v[242:243], s[70:71]
    v_pk_mul_f32 v[244:245], v[244:245], s[70:71]
    v_pk_mul_f32 v[246:247], v[246:247], s[70:71]
    v_cvt_pk_bf16_f32 v92, v240, v241
    v_cvt_pk_bf16_f32 v93, v242, v243
    v_cvt_pk_bf16_f32 v94, v244, v245
    v_cvt_pk_bf16_f32 v95, v246, v247
    ds_write_b128 v223, v[92:95] offset:7168
    ds_read_b128 a[16:19], v232 offset:4096
    ds_read_b128 a[20:23], v233 offset:4096
    ds_read_b128 a[24:27], v234 offset:4096
    ds_read_b128 a[28:31], v235 offset:4096
    v_lshlrev_b32 v240, 16, v96
    v_and_b32 v241, 0xffff0000, v96
    v_lshlrev_b32 v242, 16, v97
    v_and_b32 v243, 0xffff0000, v97
    v_lshlrev_b32 v244, 16, v98
    v_and_b32 v245, 0xffff0000, v98
    v_lshlrev_b32 v246, 16, v99
    v_and_b32 v247, 0xffff0000, v99
    v_pk_mul_f32 v[240:241], v[240:241], s[70:71]
    v_pk_mul_f32 v[242:243], v[242:243], s[70:71]
    v_pk_mul_f32 v[244:245], v[244:245], s[70:71]
    v_pk_mul_f32 v[246:247], v[246:247], s[70:71]
    v_cvt_pk_bf16_f32 v96, v240, v241
    v_cvt_pk_bf16_f32 v97, v242, v243
    v_cvt_pk_bf16_f32 v98, v244, v245
    v_cvt_pk_bf16_f32 v99, v246, v247
    ds_write_b128 v220, v[96:99] offset:0
    v_lshlrev_b32 v240, 16, v100
    v_and_b32 v241, 0xffff0000, v100
    v_lshlrev_b32 v242, 16, v101
    v_and_b32 v243, 0xffff0000, v101
    v_lshlrev_b32 v244, 16, v102
    v_and_b32 v245, 0xffff0000, v102
    v_lshlrev_b32 v246, 16, v103
    v_and_b32 v247, 0xffff0000, v103
    v_pk_mul_f32 v[240:241], v[240:241], s[70:71]
    v_pk_mul_f32 v[242:243], v[242:243], s[70:71]
    v_pk_mul_f32 v[244:245], v[244:245], s[70:71]
    v_pk_mul_f32 v[246:247], v[246:247], s[70:71]
    v_cvt_pk_bf16_f32 v100, v240, v241
    v_cvt_pk_bf16_f32 v101, v242, v243
    v_cvt_pk_bf16_f32 v102, v244, v245
    v_cvt_pk_bf16_f32 v103, v246, v247
    ds_write_b128 v221, v[100:103] offset:1024
    v_lshlrev_b32 v240, 16, v104
    v_and_b32 v241, 0xffff0000, v104
    v_lshlrev_b32 v242, 16, v105
    v_and_b32 v243, 0xffff0000, v105
    v_lshlrev_b32 v244, 16, v106
    v_and_b32 v245, 0xffff0000, v106
    v_lshlrev_b32 v246, 16, v107
    v_and_b32 v247, 0xffff0000, v107
    v_pk_mul_f32 v[240:241], v[240:241], s[70:71]
    v_pk_mul_f32 v[242:243], v[242:243], s[70:71]
    v_pk_mul_f32 v[244:245], v[244:245], s[70:71]
    v_pk_mul_f32 v[246:247], v[246:247], s[70:71]
    v_cvt_pk_bf16_f32 v104, v240, v241
    v_cvt_pk_bf16_f32 v105, v242, v243
    v_cvt_pk_bf16_f32 v106, v244, v245
    v_cvt_pk_bf16_f32 v107, v246, v247
    ds_write_b128 v222, v[104:107] offset:2048
    v_lshlrev_b32 v240, 16, v108
    v_and_b32 v241, 0xffff0000, v108
    v_lshlrev_b32 v242, 16, v109
    v_and_b32 v243, 0xffff0000, v109
    v_lshlrev_b32 v244, 16, v110
    v_and_b32 v245, 0xffff0000, v110
    v_lshlrev_b32 v246, 16, v111
    v_and_b32 v247, 0xffff0000, v111
    v_pk_mul_f32 v[240:241], v[240:241], s[70:71]
    v_pk_mul_f32 v[242:243], v[242:243], s[70:71]
    v_pk_mul_f32 v[244:245], v[244:245], s[70:71]
    v_pk_mul_f32 v[246:247], v[246:247], s[70:71]
    v_cvt_pk_bf16_f32 v108, v240, v241
    v_cvt_pk_bf16_f32 v109, v242, v243
    v_cvt_pk_bf16_f32 v110, v244, v245
    v_cvt_pk_bf16_f32 v111, v246, v247
    ds_write_b128 v223, v[108:111] offset:3072
    ds_read_b128 a[32:35], v232 offset:0
    ds_read_b128 a[36:39], v233 offset:0
    ds_read_b128 a[40:43], v234 offset:0
    ds_read_b128 a[44:47], v235 offset:0
    v_lshlrev_b32 v240, 16, v112
    v_and_b32 v241, 0xffff0000, v112
    v_lshlrev_b32 v242, 16, v113
    v_and_b32 v243, 0xffff0000, v113
    v_lshlrev_b32 v244, 16, v114
    v_and_b32 v245, 0xffff0000, v114
    v_lshlrev_b32 v246, 16, v115
    v_and_b32 v247, 0xffff0000, v115
    v_pk_mul_f32 v[240:241], v[240:241], s[70:71]
    v_pk_mul_f32 v[242:243], v[242:243], s[70:71]
    v_pk_mul_f32 v[244:245], v[244:245], s[70:71]
    v_pk_mul_f32 v[246:247], v[246:247], s[70:71]
    v_cvt_pk_bf16_f32 v112, v240, v241
    v_cvt_pk_bf16_f32 v113, v242, v243
    v_cvt_pk_bf16_f32 v114, v244, v245
    v_cvt_pk_bf16_f32 v115, v246, v247
    ds_write_b128 v220, v[112:115] offset:4096
    v_lshlrev_b32 v240, 16, v116
    v_and_b32 v241, 0xffff0000, v116
    v_lshlrev_b32 v242, 16, v117
    v_and_b32 v243, 0xffff0000, v117
    v_lshlrev_b32 v244, 16, v118
    v_and_b32 v245, 0xffff0000, v118
    v_lshlrev_b32 v246, 16, v119
    v_and_b32 v247, 0xffff0000, v119
    v_pk_mul_f32 v[240:241], v[240:241], s[70:71]
    v_pk_mul_f32 v[242:243], v[242:243], s[70:71]
    v_pk_mul_f32 v[244:245], v[244:245], s[70:71]
    v_pk_mul_f32 v[246:247], v[246:247], s[70:71]
    v_cvt_pk_bf16_f32 v116, v240, v241
    v_cvt_pk_bf16_f32 v117, v242, v243
    v_cvt_pk_bf16_f32 v118, v244, v245
    v_cvt_pk_bf16_f32 v119, v246, v247
    ds_write_b128 v221, v[116:119] offset:5120
    v_lshlrev_b32 v240, 16, v120
    v_and_b32 v241, 0xffff0000, v120
    v_lshlrev_b32 v242, 16, v121
    v_and_b32 v243, 0xffff0000, v121
    v_lshlrev_b32 v244, 16, v122
    v_and_b32 v245, 0xffff0000, v122
    v_lshlrev_b32 v246, 16, v123
    v_and_b32 v247, 0xffff0000, v123
    v_pk_mul_f32 v[240:241], v[240:241], s[70:71]
    v_pk_mul_f32 v[242:243], v[242:243], s[70:71]
    v_pk_mul_f32 v[244:245], v[244:245], s[70:71]
    v_pk_mul_f32 v[246:247], v[246:247], s[70:71]
    v_cvt_pk_bf16_f32 v120, v240, v241
    v_cvt_pk_bf16_f32 v121, v242, v243
    v_cvt_pk_bf16_f32 v122, v244, v245
    v_cvt_pk_bf16_f32 v123, v246, v247
    ds_write_b128 v222, v[120:123] offset:6144
    v_lshlrev_b32 v240, 16, v124
    v_and_b32 v241, 0xffff0000, v124
    v_lshlrev_b32 v242, 16, v125
    v_and_b32 v243, 0xffff0000, v125
    v_lshlrev_b32 v244, 16, v126
    v_and_b32 v245, 0xffff0000, v126
    v_lshlrev_b32 v246, 16, v127
    v_and_b32 v247, 0xffff0000, v127
    v_pk_mul_f32 v[240:241], v[240:241], s[70:71]
    v_pk_mul_f32 v[242:243], v[242:243], s[70:71]
    v_pk_mul_f32 v[244:245], v[244:245], s[70:71]
    v_pk_mul_f32 v[246:247], v[246:247], s[70:71]
    v_cvt_pk_bf16_f32 v124, v240, v241
    v_cvt_pk_bf16_f32 v125, v242, v243
    v_cvt_pk_bf16_f32 v126, v244, v245
    v_cvt_pk_bf16_f32 v127, v246, v247
    ds_write_b128 v223, v[124:127] offset:7168
    ds_read_b128 a[48:51], v232 offset:4096
    ds_read_b128 a[52:55], v233 offset:4096
    ds_read_b128 a[56:59], v234 offset:4096
    ds_read_b128 a[60:63], v235 offset:4096
    s_waitcnt lgkmcnt(0)
    s_mov_b32 s32, s6
    s_and_b32 s33, s7, 0xffff
    s_mov_b32 s34, 17301504
    s_mov_b32 s35, 0x20000
    s_mov_b32 s36, s8
    s_and_b32 s37, s9, 0xffff
    s_mov_b32 s38, 17301504
    s_mov_b32 s39, 0x20000
    v_and_b32 v232, 15, v193
    v_lshrrev_b32 v233, 4, v193
    v_xor_b32 v235, v232, v233
    v_lshlrev_b32 v235, 4, v235
    v_lshl_add_u32 v208, v233, 13, v235
    v_lshlrev_b32 v235, 1, v233
    v_xor_b32 v235, v232, v235
    v_lshlrev_b32 v235, 4, v235
    v_lshl_add_u32 v212, v233, 13, v235
    v_xor_b32 v209, 64, v208
    v_add_u32 v209, 31744, v209
    v_xor_b32 v213, 128, v212
    v_add_u32 v213, 31744, v213
    v_xor_b32 v210, 128, v208
    v_add_u32 v210, 63488, v210
    v_xor_b32 v214, 0, v212
    v_add_u32 v214, 63488, v214
    v_xor_b32 v211, 192, v208
    v_add_u32 v211, 95232, v211
    v_xor_b32 v215, 128, v212
    v_add_u32 v215, 95232, v215
    v_add_u32 v196, s63, v196
    v_add_u32 v197, s63, v197
    v_add_u32 v198, s63, v198
    v_add_u32 v199, s63, v199
    s_sub_u32 s64, s63, 65536
    v_add_u32 v200, s64, v200
    v_add_u32 v201, s64, v201
    v_add_u32 v202, s64, v202
    v_add_u32 v203, s64, v203
    v_add_u32 v204, s64, v204
    v_add_u32 v205, s64, v205
    v_add_u32 v206, s64, v206
    v_add_u32 v207, s64, v207
    v_mfma_f32_32x32x16_bf16 v[0:15], a[196:199], a[196:199], 0
    v_mfma_f32_32x32x16_bf16 v[16:31], a[196:199], a[196:199], 0
    v_mfma_f32_32x32x16_bf16 v[32:47], a[196:199], a[196:199], 0
    v_mfma_f32_32x32x16_bf16 v[48:63], a[196:199], a[196:199], 0
    v_mfma_f32_32x32x16_bf16 v[64:79], a[196:199], a[196:199], 0
    v_mfma_f32_32x32x16_bf16 v[80:95], a[196:199], a[196:199], 0
    v_mfma_f32_32x32x16_bf16 v[96:111], a[196:199], a[196:199], 0
    v_mfma_f32_32x32x16_bf16 v[112:127], a[196:199], a[196:199], 0
    v_mfma_f32_32x32x16_bf16 v[176:191], a[196:199], a[196:199], 0
    v_mov_b32 v238, 0xf149f2ca
    v_mov_b32 v240, v238
    v_mov_b32 v241, v238
    v_mov_b32 v242, v238
    v_mov_b32 v243, v238
    s_mov_b32 s42, 0
L_general_loop:
    s_lshl_b32 s64, s42, 3
    s_load_dwordx2 s[40:41], s[10:11], s64
    s_lshl_b32 s65, s42, 5
    s_sub_u32 s3, s62, s65
    s_waitcnt lgkmcnt(0)
    s_lshl_b32 s57, s40, 17
    s_add_u32 s57, s57, s49
    s_add_u32 m0, s63, 0
    s_nop 0
    buffer_load_dwordx4 v208, s[32:35], s57 offen offset:0 lds
    buffer_load_dwordx4 v209, s[32:35], s57 offen offset:1024 lds
    buffer_load_dwordx4 v210, s[32:35], s57 offen offset:2048 lds
    buffer_load_dwordx4 v211, s[32:35], s57 offen offset:3072 lds
    s_lshl_b32 s57, s41, 17
    s_add_u32 s57, s57, s49
    s_add_u32 m0, s63, 4096
    s_nop 0
    buffer_load_dwordx4 v208, s[32:35], s57 offen offset:0 lds
    buffer_load_dwordx4 v209, s[32:35], s57 offen offset:1024 lds
    buffer_load_dwordx4 v210, s[32:35], s57 offen offset:2048 lds
    buffer_load_dwordx4 v211, s[32:35], s57 offen offset:3072 lds
    v_lshlrev_b32 v237, 2, v233
    v_sub_u32 v237, s3, v237
    v_cmp_lt_i32 s[70:71], 0, v237
    v_cmp_lt_i32 s[72:73], 1, v237
    v_cmp_lt_i32 s[74:75], 2, v237
    v_cmp_lt_i32 s[76:77], 3, v237
    v_cndmask_b32 v248, v238, 4.0, s[70:71]
    v_cndmask_b32 v249, v238, 4.0, s[72:73]
    v_cndmask_b32 v250, v238, 4.0, s[74:75]
    v_cndmask_b32 v251, v238, 4.0, s[76:77]
    v_cmp_lt_i32 s[70:71], 16, v237
    v_cmp_lt_i32 s[72:73], 17, v237
    v_cmp_lt_i32 s[74:75], 18, v237
    v_cmp_lt_i32 s[76:77], 19, v237
    v_cndmask_b32 v252, v238, 4.0, s[70:71]
    v_cndmask_b32 v253, v238, 4.0, s[72:73]
    v_cndmask_b32 v254, v238, 4.0, s[74:75]
    v_cndmask_b32 v255, v238, 4.0, s[76:77]
    s_waitcnt vmcnt(0)
    ds_read_b128 a[64:67], v196 offset:0
    ds_read_b128 a[68:71], v197 offset:0
    ds_read_b128 a[72:75], v198 offset:0
    ds_read_b128 a[76:79], v199 offset:0
    ds_read_b128 a[80:83], v196 offset:4096
    ds_read_b128 a[84:87], v197 offset:4096
    ds_read_b128 a[88:91], v198 offset:4096
    ds_read_b128 a[92:95], v199 offset:4096
    s_waitcnt lgkmcnt(0)
    s_lshl_b32 s57, s40, 17
    s_add_u32 s57, s57, s49
    s_add_u32 m0, s63, 0
    s_nop 0
    buffer_load_dwordx4 v212, s[36:39], s57 offen offset:0 lds
    buffer_load_dwordx4 v213, s[36:39], s57 offen offset:1024 lds
    buffer_load_dwordx4 v214, s[36:39], s57 offen offset:2048 lds
    buffer_load_dwordx4 v215, s[36:39], s57 offen offset:3072 lds
    s_lshl_b32 s57, s41, 17
    s_add_u32 s57, s57, s49
    s_add_u32 m0, s63, 4096
    s_nop 0
    buffer_load_dwordx4 v212, s[36:39], s57 offen offset:0 lds
    buffer_load_dwordx4 v213, s[36:39], s57 offen offset:1024 lds
    buffer_load_dwordx4 v214, s[36:39], s57 offen offset:2048 lds
    buffer_load_dwordx4 v215, s[36:39], s57 offen offset:3072 lds
    v_mfma_f32_16x16x32_bf16 v[128:131], a[64:67], a[0:3], v[248:251]
    v_mfma_f32_16x16x32_bf16 v[128:131], a[68:71], a[4:7], v[128:131]
    v_mfma_f32_16x16x32_bf16 v[128:131], a[72:75], a[8:11], v[128:131]
    v_mfma_f32_16x16x32_bf16 v[128:131], a[76:79], a[12:15], v[128:131]
    v_mfma_f32_16x16x32_bf16 v[136:139], a[76:79], a[28:31], v[248:251]
    v_mfma_f32_16x16x32_bf16 v[136:139], a[72:75], a[24:27], v[136:139]
    v_mfma_f32_16x16x32_bf16 v[136:139], a[68:71], a[20:23], v[136:139]
    v_mfma_f32_16x16x32_bf16 v[136:139], a[64:67], a[16:19], v[136:139]
    v_mfma_f32_16x16x32_bf16 v[140:143], a[80:83], a[16:19], v[252:255]
    v_mfma_f32_16x16x32_bf16 v[140:143], a[84:87], a[20:23], v[140:143]
    v_mfma_f32_16x16x32_bf16 v[140:143], a[88:91], a[24:27], v[140:143]
    v_mfma_f32_16x16x32_bf16 v[140:143], a[92:95], a[28:31], v[140:143]
    v_mfma_f32_16x16x32_bf16 v[132:135], a[92:95], a[12:15], v[252:255]
    v_mfma_f32_16x16x32_bf16 v[132:135], a[88:91], a[8:11], v[132:135]
    v_mfma_f32_16x16x32_bf16 v[132:135], a[84:87], a[4:7], v[132:135]
    v_mfma_f32_16x16x32_bf16 v[132:135], a[80:83], a[0:3], v[132:135]
    v_mfma_f32_16x16x32_bf16 v[144:147], a[64:67], a[32:35], v[248:251]
    v_mfma_f32_16x16x32_bf16 v[144:147], a[68:71], a[36:39], v[144:147]
    v_mfma_f32_16x16x32_bf16 v[144:147], a[72:75], a[40:43], v[144:147]
    v_mfma_f32_16x16x32_bf16 v[144:147], a[76:79], a[44:47], v[144:147]
    v_mfma_f32_16x16x32_bf16 v[152:155], a[76:79], a[60:63], v[248:251]
    v_mfma_f32_16x16x32_bf16 v[152:155], a[72:75], a[56:59], v[152:155]
    v_mfma_f32_16x16x32_bf16 v[152:155], a[68:71], a[52:55], v[152:155]
    v_mfma_f32_16x16x32_bf16 v[152:155], a[64:67], a[48:51], v[152:155]
    v_mfma_f32_16x16x32_bf16 v[156:159], a[80:83], a[48:51], v[252:255]
    v_mfma_f32_16x16x32_bf16 v[156:159], a[84:87], a[52:55], v[156:159]
    v_mfma_f32_16x16x32_bf16 v[156:159], a[88:91], a[56:59], v[156:159]
    v_mfma_f32_16x16x32_bf16 v[156:159], a[92:95], a[60:63], v[156:159]
    v_mfma_f32_16x16x32_bf16 v[148:151], a[92:95], a[44:47], v[252:255]
    v_mfma_f32_16x16x32_bf16 v[148:151], a[88:91], a[40:43], v[148:151]
    v_mfma_f32_16x16x32_bf16 v[148:151], a[84:87], a[36:39], v[148:151]
    v_mfma_f32_16x16x32_bf16 v[148:151], a[80:83], a[32:35], v[148:151]
    v_max3_f32 v244, v128, v129, v240
    v_max3_f32 v244, v130, v131, v244
    v_max3_f32 v244, v132, v133, v244
    v_max3_f32 v244, v134, v135, v244
    v_mov_b32 v245, v244
    s_nop 1
    v_permlane32_swap_b32 v244, v245
    v_max_f32 v244, v244, v245
    v_mov_b32 v245, v244
    s_nop 1
    v_permlane16_swap_b32 v244, v245
    v_max_f32 v244, v244, v245
    v_sub_f32 v245, v240, v244
    v_exp_f32 v245, v245
    v_mov_b32 v240, v244
    v_mul_f32 v176, v176, v245
    ds_bpermute_b32 v216, v229, v245 offset:0
    ds_bpermute_b32 v217, v229, v245 offset:4
    ds_bpermute_b32 v218, v229, v245 offset:8
    ds_bpermute_b32 v219, v229, v245 offset:12
    s_waitcnt lgkmcnt(0)
    v_mul_f32 v0, v0, v216
    v_mul_f32 v1, v1, v217
    v_mul_f32 v2, v2, v218
    v_mul_f32 v3, v3, v219
    v_mul_f32 v4, v4, v216
    v_mul_f32 v5, v5, v217
    v_mul_f32 v6, v6, v218
    v_mul_f32 v7, v7, v219
    v_mul_f32 v8, v8, v216
    v_mul_f32 v9, v9, v217
    v_mul_f32 v10, v10, v218
    v_mul_f32 v11, v11, v219
    v_mul_f32 v12, v12, v216
    v_mul_f32 v13, v13, v217
    v_mul_f32 v14, v14, v218
    v_mul_f32 v15, v15, v219
    v_mul_f32 v16, v16, v216
    v_mul_f32 v17, v17, v217
    v_mul_f32 v18, v18, v218
    v_mul_f32 v19, v19, v219
    v_mul_f32 v20, v20, v216
    v_mul_f32 v21, v21, v217
    v_mul_f32 v22, v22, v218
    v_mul_f32 v23, v23, v219
    v_mul_f32 v24, v24, v216
    v_mul_f32 v25, v25, v217
    v_mul_f32 v26, v26, v218
    v_mul_f32 v27, v27, v219
    v_mul_f32 v28, v28, v216
    v_mul_f32 v29, v29, v217
    v_mul_f32 v30, v30, v218
    v_mul_f32 v31, v31, v219
    v_sub_f32 v128, v128, v240
    v_sub_f32 v129, v129, v240
    v_sub_f32 v130, v130, v240
    v_sub_f32 v131, v131, v240
    v_sub_f32 v132, v132, v240
    v_sub_f32 v133, v133, v240
    v_sub_f32 v134, v134, v240
    v_sub_f32 v135, v135, v240
    v_exp_f32 v128, v128
    v_exp_f32 v129, v129
    v_exp_f32 v130, v130
    v_exp_f32 v131, v131
    v_exp_f32 v132, v132
    v_exp_f32 v133, v133
    v_exp_f32 v134, v134
    v_exp_f32 v135, v135
    v_add_f32 v176, v176, v128
    v_add_f32 v176, v176, v129
    v_add_f32 v176, v176, v130
    v_add_f32 v176, v176, v131
    v_add_f32 v176, v176, v132
    v_add_f32 v176, v176, v133
    v_add_f32 v176, v176, v134
    v_add_f32 v176, v176, v135
    v_cvt_pk_bf16_f32 v160, v128, v129
    v_cvt_pk_bf16_f32 v161, v130, v131
    v_cvt_pk_bf16_f32 v162, v132, v133
    v_cvt_pk_bf16_f32 v163, v134, v135
    v_max3_f32 v244, v136, v137, v241
    v_max3_f32 v244, v138, v139, v244
    v_max3_f32 v244, v140, v141, v244
    v_max3_f32 v244, v142, v143, v244
    v_mov_b32 v245, v244
    s_nop 1
    v_permlane32_swap_b32 v244, v245
    v_max_f32 v244, v244, v245
    v_mov_b32 v245, v244
    s_nop 1
    v_permlane16_swap_b32 v244, v245
    v_max_f32 v244, v244, v245
    v_sub_f32 v245, v241, v244
    v_exp_f32 v245, v245
    v_mov_b32 v241, v244
    v_mul_f32 v178, v178, v245
    ds_bpermute_b32 v216, v229, v245 offset:0
    ds_bpermute_b32 v217, v229, v245 offset:4
    ds_bpermute_b32 v218, v229, v245 offset:8
    ds_bpermute_b32 v219, v229, v245 offset:12
    s_waitcnt lgkmcnt(0)
    v_mul_f32 v32, v32, v216
    v_mul_f32 v33, v33, v217
    v_mul_f32 v34, v34, v218
    v_mul_f32 v35, v35, v219
    v_mul_f32 v36, v36, v216
    v_mul_f32 v37, v37, v217
    v_mul_f32 v38, v38, v218
    v_mul_f32 v39, v39, v219
    v_mul_f32 v40, v40, v216
    v_mul_f32 v41, v41, v217
    v_mul_f32 v42, v42, v218
    v_mul_f32 v43, v43, v219
    v_mul_f32 v44, v44, v216
    v_mul_f32 v45, v45, v217
    v_mul_f32 v46, v46, v218
    v_mul_f32 v47, v47, v219
    v_mul_f32 v48, v48, v216
    v_mul_f32 v49, v49, v217
    v_mul_f32 v50, v50, v218
    v_mul_f32 v51, v51, v219
    v_mul_f32 v52, v52, v216
    v_mul_f32 v53, v53, v217
    v_mul_f32 v54, v54, v218
    v_mul_f32 v55, v55, v219
    v_mul_f32 v56, v56, v216
    v_mul_f32 v57, v57, v217
    v_mul_f32 v58, v58, v218
    v_mul_f32 v59, v59, v219
    v_mul_f32 v60, v60, v216
    v_mul_f32 v61, v61, v217
    v_mul_f32 v62, v62, v218
    v_mul_f32 v63, v63, v219
    v_sub_f32 v136, v136, v241
    v_sub_f32 v137, v137, v241
    v_sub_f32 v138, v138, v241
    v_sub_f32 v139, v139, v241
    v_sub_f32 v140, v140, v241
    v_sub_f32 v141, v141, v241
    v_sub_f32 v142, v142, v241
    v_sub_f32 v143, v143, v241
    v_exp_f32 v136, v136
    v_exp_f32 v137, v137
    v_exp_f32 v138, v138
    v_exp_f32 v139, v139
    v_exp_f32 v140, v140
    v_exp_f32 v141, v141
    v_exp_f32 v142, v142
    v_exp_f32 v143, v143
    v_add_f32 v178, v178, v136
    v_add_f32 v178, v178, v137
    v_add_f32 v178, v178, v138
    v_add_f32 v178, v178, v139
    v_add_f32 v178, v178, v140
    v_add_f32 v178, v178, v141
    v_add_f32 v178, v178, v142
    v_add_f32 v178, v178, v143
    v_cvt_pk_bf16_f32 v164, v136, v137
    v_cvt_pk_bf16_f32 v165, v138, v139
    v_cvt_pk_bf16_f32 v166, v140, v141
    v_cvt_pk_bf16_f32 v167, v142, v143
    v_max3_f32 v244, v144, v145, v242
    v_max3_f32 v244, v146, v147, v244
    v_max3_f32 v244, v148, v149, v244
    v_max3_f32 v244, v150, v151, v244
    v_mov_b32 v245, v244
    s_nop 1
    v_permlane32_swap_b32 v244, v245
    v_max_f32 v244, v244, v245
    v_mov_b32 v245, v244
    s_nop 1
    v_permlane16_swap_b32 v244, v245
    v_max_f32 v244, v244, v245
    v_sub_f32 v245, v242, v244
    v_exp_f32 v245, v245
    v_mov_b32 v242, v244
    v_mul_f32 v180, v180, v245
    ds_bpermute_b32 v216, v229, v245 offset:0
    ds_bpermute_b32 v217, v229, v245 offset:4
    ds_bpermute_b32 v218, v229, v245 offset:8
    ds_bpermute_b32 v219, v229, v245 offset:12
    s_waitcnt lgkmcnt(0)
    v_mul_f32 v64, v64, v216
    v_mul_f32 v65, v65, v217
    v_mul_f32 v66, v66, v218
    v_mul_f32 v67, v67, v219
    v_mul_f32 v68, v68, v216
    v_mul_f32 v69, v69, v217
    v_mul_f32 v70, v70, v218
    v_mul_f32 v71, v71, v219
    v_mul_f32 v72, v72, v216
    v_mul_f32 v73, v73, v217
    v_mul_f32 v74, v74, v218
    v_mul_f32 v75, v75, v219
    v_mul_f32 v76, v76, v216
    v_mul_f32 v77, v77, v217
    v_mul_f32 v78, v78, v218
    v_mul_f32 v79, v79, v219
    v_mul_f32 v80, v80, v216
    v_mul_f32 v81, v81, v217
    v_mul_f32 v82, v82, v218
    v_mul_f32 v83, v83, v219
    v_mul_f32 v84, v84, v216
    v_mul_f32 v85, v85, v217
    v_mul_f32 v86, v86, v218
    v_mul_f32 v87, v87, v219
    v_mul_f32 v88, v88, v216
    v_mul_f32 v89, v89, v217
    v_mul_f32 v90, v90, v218
    v_mul_f32 v91, v91, v219
    v_mul_f32 v92, v92, v216
    v_mul_f32 v93, v93, v217
    v_mul_f32 v94, v94, v218
    v_mul_f32 v95, v95, v219
    v_sub_f32 v144, v144, v242
    v_sub_f32 v145, v145, v242
    v_sub_f32 v146, v146, v242
    v_sub_f32 v147, v147, v242
    v_sub_f32 v148, v148, v242
    v_sub_f32 v149, v149, v242
    v_sub_f32 v150, v150, v242
    v_sub_f32 v151, v151, v242
    v_exp_f32 v144, v144
    v_exp_f32 v145, v145
    v_exp_f32 v146, v146
    v_exp_f32 v147, v147
    v_exp_f32 v148, v148
    v_exp_f32 v149, v149
    v_exp_f32 v150, v150
    v_exp_f32 v151, v151
    v_add_f32 v180, v180, v144
    v_add_f32 v180, v180, v145
    v_add_f32 v180, v180, v146
    v_add_f32 v180, v180, v147
    v_add_f32 v180, v180, v148
    v_add_f32 v180, v180, v149
    v_add_f32 v180, v180, v150
    v_add_f32 v180, v180, v151
    v_cvt_pk_bf16_f32 v168, v144, v145
    v_cvt_pk_bf16_f32 v169, v146, v147
    v_cvt_pk_bf16_f32 v170, v148, v149
    v_cvt_pk_bf16_f32 v171, v150, v151
    v_max3_f32 v244, v152, v153, v243
    v_max3_f32 v244, v154, v155, v244
    v_max3_f32 v244, v156, v157, v244
    v_max3_f32 v244, v158, v159, v244
    v_mov_b32 v245, v244
    s_nop 1
    v_permlane32_swap_b32 v244, v245
    v_max_f32 v244, v244, v245
    v_mov_b32 v245, v244
    s_nop 1
    v_permlane16_swap_b32 v244, v245
    v_max_f32 v244, v244, v245
    v_sub_f32 v245, v243, v244
    v_exp_f32 v245, v245
    v_mov_b32 v243, v244
    v_mul_f32 v182, v182, v245
    ds_bpermute_b32 v216, v229, v245 offset:0
    ds_bpermute_b32 v217, v229, v245 offset:4
    ds_bpermute_b32 v218, v229, v245 offset:8
    ds_bpermute_b32 v219, v229, v245 offset:12
    s_waitcnt lgkmcnt(0)
    v_mul_f32 v96, v96, v216
    v_mul_f32 v97, v97, v217
    v_mul_f32 v98, v98, v218
    v_mul_f32 v99, v99, v219
    v_mul_f32 v100, v100, v216
    v_mul_f32 v101, v101, v217
    v_mul_f32 v102, v102, v218
    v_mul_f32 v103, v103, v219
    v_mul_f32 v104, v104, v216
    v_mul_f32 v105, v105, v217
    v_mul_f32 v106, v106, v218
    v_mul_f32 v107, v107, v219
    v_mul_f32 v108, v108, v216
    v_mul_f32 v109, v109, v217
    v_mul_f32 v110, v110, v218
    v_mul_f32 v111, v111, v219
    v_mul_f32 v112, v112, v216
    v_mul_f32 v113, v113, v217
    v_mul_f32 v114, v114, v218
    v_mul_f32 v115, v115, v219
    v_mul_f32 v116, v116, v216
    v_mul_f32 v117, v117, v217
    v_mul_f32 v118, v118, v218
    v_mul_f32 v119, v119, v219
    v_mul_f32 v120, v120, v216
    v_mul_f32 v121, v121, v217
    v_mul_f32 v122, v122, v218
    v_mul_f32 v123, v123, v219
    v_mul_f32 v124, v124, v216
    v_mul_f32 v125, v125, v217
    v_mul_f32 v126, v126, v218
    v_mul_f32 v127, v127, v219
    v_sub_f32 v152, v152, v243
    v_sub_f32 v153, v153, v243
    v_sub_f32 v154, v154, v243
    v_sub_f32 v155, v155, v243
    v_sub_f32 v156, v156, v243
    v_sub_f32 v157, v157, v243
    v_sub_f32 v158, v158, v243
    v_sub_f32 v159, v159, v243
    v_exp_f32 v152, v152
    v_exp_f32 v153, v153
    v_exp_f32 v154, v154
    v_exp_f32 v155, v155
    v_exp_f32 v156, v156
    v_exp_f32 v157, v157
    v_exp_f32 v158, v158
    v_exp_f32 v159, v159
    v_add_f32 v182, v182, v152
    v_add_f32 v182, v182, v153
    v_add_f32 v182, v182, v154
    v_add_f32 v182, v182, v155
    v_add_f32 v182, v182, v156
    v_add_f32 v182, v182, v157
    v_add_f32 v182, v182, v158
    v_add_f32 v182, v182, v159
    v_cvt_pk_bf16_f32 v172, v152, v153
    v_cvt_pk_bf16_f32 v173, v154, v155
    v_cvt_pk_bf16_f32 v174, v156, v157
    v_cvt_pk_bf16_f32 v175, v158, v159
    s_waitcnt vmcnt(0)
    ds_read_b64_tr_b16 a[128:129], v200 offset:0
    ds_read_b64_tr_b16 a[130:131], v200 offset:4096
    ds_read_b64_tr_b16 a[132:133], v201 offset:0
    ds_read_b64_tr_b16 a[134:135], v201 offset:4096
    ds_read_b64_tr_b16 a[136:137], v202 offset:0
    ds_read_b64_tr_b16 a[138:139], v202 offset:4096
    ds_read_b64_tr_b16 a[140:141], v203 offset:0
    ds_read_b64_tr_b16 a[142:143], v203 offset:4096
    ds_read_b64_tr_b16 a[144:145], v204 offset:0
    ds_read_b64_tr_b16 a[146:147], v204 offset:4096
    ds_read_b64_tr_b16 a[148:149], v205 offset:0
    ds_read_b64_tr_b16 a[150:151], v205 offset:4096
    ds_read_b64_tr_b16 a[152:153], v206 offset:0
    ds_read_b64_tr_b16 a[154:155], v206 offset:4096
    ds_read_b64_tr_b16 a[156:157], v207 offset:0
    ds_read_b64_tr_b16 a[158:159], v207 offset:4096
    s_waitcnt lgkmcnt(0)
    v_mfma_f32_16x16x32_bf16 v[0:3], v[160:163], a[128:131], v[0:3]
    v_mfma_f32_16x16x32_bf16 v[4:7], v[160:163], a[132:135], v[4:7]
    v_mfma_f32_16x16x32_bf16 v[8:11], v[160:163], a[136:139], v[8:11]
    v_mfma_f32_16x16x32_bf16 v[12:15], v[160:163], a[140:143], v[12:15]
    v_mfma_f32_16x16x32_bf16 v[16:19], v[160:163], a[144:147], v[16:19]
    v_mfma_f32_16x16x32_bf16 v[20:23], v[160:163], a[148:151], v[20:23]
    v_mfma_f32_16x16x32_bf16 v[24:27], v[160:163], a[152:155], v[24:27]
    v_mfma_f32_16x16x32_bf16 v[28:31], v[160:163], a[156:159], v[28:31]
    v_mfma_f32_16x16x32_bf16 v[32:35], v[164:167], a[128:131], v[32:35]
    v_mfma_f32_16x16x32_bf16 v[36:39], v[164:167], a[132:135], v[36:39]
    v_mfma_f32_16x16x32_bf16 v[40:43], v[164:167], a[136:139], v[40:43]
    v_mfma_f32_16x16x32_bf16 v[44:47], v[164:167], a[140:143], v[44:47]
    v_mfma_f32_16x16x32_bf16 v[48:51], v[164:167], a[144:147], v[48:51]
    v_mfma_f32_16x16x32_bf16 v[52:55], v[164:167], a[148:151], v[52:55]
    v_mfma_f32_16x16x32_bf16 v[56:59], v[164:167], a[152:155], v[56:59]
    v_mfma_f32_16x16x32_bf16 v[60:63], v[164:167], a[156:159], v[60:63]
    v_mfma_f32_16x16x32_bf16 v[64:67], v[168:171], a[128:131], v[64:67]
    v_mfma_f32_16x16x32_bf16 v[68:71], v[168:171], a[132:135], v[68:71]
    v_mfma_f32_16x16x32_bf16 v[72:75], v[168:171], a[136:139], v[72:75]
    v_mfma_f32_16x16x32_bf16 v[76:79], v[168:171], a[140:143], v[76:79]
    v_mfma_f32_16x16x32_bf16 v[80:83], v[168:171], a[144:147], v[80:83]
    v_mfma_f32_16x16x32_bf16 v[84:87], v[168:171], a[148:151], v[84:87]
    v_mfma_f32_16x16x32_bf16 v[88:91], v[168:171], a[152:155], v[88:91]
    v_mfma_f32_16x16x32_bf16 v[92:95], v[168:171], a[156:159], v[92:95]
    v_mfma_f32_16x16x32_bf16 v[96:99], v[172:175], a[128:131], v[96:99]
    v_mfma_f32_16x16x32_bf16 v[100:103], v[172:175], a[132:135], v[100:103]
    v_mfma_f32_16x16x32_bf16 v[104:107], v[172:175], a[136:139], v[104:107]
    v_mfma_f32_16x16x32_bf16 v[108:111], v[172:175], a[140:143], v[108:111]
    v_mfma_f32_16x16x32_bf16 v[112:115], v[172:175], a[144:147], v[112:115]
    v_mfma_f32_16x16x32_bf16 v[116:119], v[172:175], a[148:151], v[116:119]
    v_mfma_f32_16x16x32_bf16 v[120:123], v[172:175], a[152:155], v[120:123]
    v_mfma_f32_16x16x32_bf16 v[124:127], v[172:175], a[156:159], v[124:127]
    s_nop 15
    s_add_u32 s42, s42, 1
    s_cmp_lt_u32 s42, s54
    s_cbranch_scc1 L_general_loop
    v_add_f32 v176, v176, v177
    v_mov_b32 v177, v176
    s_nop 1
    v_permlane32_swap_b32 v176, v177
    v_add_f32 v176, v176, v177
    v_mov_b32 v177, v176
    s_nop 1
    v_permlane16_swap_b32 v176, v177
    v_add_f32 v176, v176, v177
    ds_bpermute_b32 v232, v229, v176 offset:0
    ds_bpermute_b32 v233, v229, v176 offset:4
    ds_bpermute_b32 v234, v229, v176 offset:8
    ds_bpermute_b32 v235, v229, v176 offset:12
    v_add_f32 v178, v178, v179
    v_mov_b32 v179, v178
    s_nop 1
    v_permlane32_swap_b32 v178, v179
    v_add_f32 v178, v178, v179
    v_mov_b32 v179, v178
    s_nop 1
    v_permlane16_swap_b32 v178, v179
    v_add_f32 v178, v178, v179
    ds_bpermute_b32 v236, v229, v178 offset:0
    ds_bpermute_b32 v237, v229, v178 offset:4
    ds_bpermute_b32 v238, v229, v178 offset:8
    ds_bpermute_b32 v239, v229, v178 offset:12
    v_add_f32 v180, v180, v181
    v_mov_b32 v181, v180
    s_nop 1
    v_permlane32_swap_b32 v180, v181
    v_add_f32 v180, v180, v181
    v_mov_b32 v181, v180
    s_nop 1
    v_permlane16_swap_b32 v180, v181
    v_add_f32 v180, v180, v181
    ds_bpermute_b32 v216, v229, v180 offset:0
    ds_bpermute_b32 v217, v229, v180 offset:4
    ds_bpermute_b32 v218, v229, v180 offset:8
    ds_bpermute_b32 v219, v229, v180 offset:12
    v_add_f32 v182, v182, v183
    v_mov_b32 v183, v182
    s_nop 1
    v_permlane32_swap_b32 v182, v183
    v_add_f32 v182, v182, v183
    v_mov_b32 v183, v182
    s_nop 1
    v_permlane16_swap_b32 v182, v183
    v_add_f32 v182, v182, v183
    ds_bpermute_b32 v220, v229, v182 offset:0
    ds_bpermute_b32 v221, v229, v182 offset:4
    ds_bpermute_b32 v222, v229, v182 offset:8
    ds_bpermute_b32 v223, v229, v182 offset:12
    s_waitcnt lgkmcnt(0)
    v_rcp_f32 v232, v232
    v_rcp_f32 v233, v233
    v_rcp_f32 v234, v234
    v_rcp_f32 v235, v235
    v_mul_f32 v0, v232, v0
    v_mul_f32 v1, v233, v1
    v_mul_f32 v2, v234, v2
    v_mul_f32 v3, v235, v3
    v_cvt_pk_bf16_f32 v0, v0, v1
    v_cvt_pk_bf16_f32 v1, v2, v3
    ds_write_b64 v224, v[0:1] offset:0
    v_mul_f32 v4, v232, v4
    v_mul_f32 v5, v233, v5
    v_mul_f32 v6, v234, v6
    v_mul_f32 v7, v235, v7
    v_cvt_pk_bf16_f32 v4, v4, v5
    v_cvt_pk_bf16_f32 v5, v6, v7
    ds_write_b64 v224, v[4:5] offset:128
    v_mul_f32 v8, v232, v8
    v_mul_f32 v9, v233, v9
    v_mul_f32 v10, v234, v10
    v_mul_f32 v11, v235, v11
    v_cvt_pk_bf16_f32 v8, v8, v9
    v_cvt_pk_bf16_f32 v9, v10, v11
    ds_write_b64 v225, v[8:9] offset:256
    v_mul_f32 v12, v232, v12
    v_mul_f32 v13, v233, v13
    v_mul_f32 v14, v234, v14
    v_mul_f32 v15, v235, v15
    v_cvt_pk_bf16_f32 v12, v12, v13
    v_cvt_pk_bf16_f32 v13, v14, v15
    ds_write_b64 v225, v[12:13] offset:384
    v_mul_f32 v16, v232, v16
    v_mul_f32 v17, v233, v17
    v_mul_f32 v18, v234, v18
    v_mul_f32 v19, v235, v19
    v_cvt_pk_bf16_f32 v16, v16, v17
    v_cvt_pk_bf16_f32 v17, v18, v19
    ds_write_b64 v224, v[16:17] offset:512
    v_mul_f32 v20, v232, v20
    v_mul_f32 v21, v233, v21
    v_mul_f32 v22, v234, v22
    v_mul_f32 v23, v235, v23
    v_cvt_pk_bf16_f32 v20, v20, v21
    v_cvt_pk_bf16_f32 v21, v22, v23
    ds_write_b64 v224, v[20:21] offset:640
    v_mul_f32 v24, v232, v24
    v_mul_f32 v25, v233, v25
    v_mul_f32 v26, v234, v26
    v_mul_f32 v27, v235, v27
    v_cvt_pk_bf16_f32 v24, v24, v25
    v_cvt_pk_bf16_f32 v25, v26, v27
    ds_write_b64 v225, v[24:25] offset:768
    v_mul_f32 v28, v232, v28
    v_mul_f32 v29, v233, v29
    v_mul_f32 v30, v234, v30
    v_mul_f32 v31, v235, v31
    v_cvt_pk_bf16_f32 v28, v28, v29
    v_cvt_pk_bf16_f32 v29, v30, v31
    ds_write_b64 v225, v[28:29] offset:896
    ds_read_b64_tr_b16 v[128:129], v226 offset:0
    ds_read_b64_tr_b16 v[130:131], v227 offset:0
    ds_read_b64_tr_b16 v[132:133], v226 offset:2048
    ds_read_b64_tr_b16 v[134:135], v227 offset:2048
    ds_read_b64_tr_b16 v[136:137], v226 offset:512
    ds_read_b64_tr_b16 v[138:139], v227 offset:512
    ds_read_b64_tr_b16 v[140:141], v226 offset:2560
    ds_read_b64_tr_b16 v[142:143], v227 offset:2560
    s_waitcnt lgkmcnt(0)
    buffer_store_dwordx4 v[128:131], v228, s[28:31], s50 offen offset:0 sc1 nt
    buffer_store_dwordx4 v[132:135], v228, s[28:31], s50 offen offset:2048 sc1 nt
    buffer_store_dwordx4 v[136:139], v228, s[28:31], s50 offen offset:128 sc1 nt
    buffer_store_dwordx4 v[140:143], v228, s[28:31], s50 offen offset:2176 sc1 nt
    s_waitcnt lgkmcnt(0)
    v_rcp_f32 v236, v236
    v_rcp_f32 v237, v237
    v_rcp_f32 v238, v238
    v_rcp_f32 v239, v239
    v_mul_f32 v32, v236, v32
    v_mul_f32 v33, v237, v33
    v_mul_f32 v34, v238, v34
    v_mul_f32 v35, v239, v35
    v_cvt_pk_bf16_f32 v32, v32, v33
    v_cvt_pk_bf16_f32 v33, v34, v35
    ds_write_b64 v224, v[32:33] offset:4096
    v_mul_f32 v36, v236, v36
    v_mul_f32 v37, v237, v37
    v_mul_f32 v38, v238, v38
    v_mul_f32 v39, v239, v39
    v_cvt_pk_bf16_f32 v36, v36, v37
    v_cvt_pk_bf16_f32 v37, v38, v39
    ds_write_b64 v224, v[36:37] offset:4224
    v_mul_f32 v40, v236, v40
    v_mul_f32 v41, v237, v41
    v_mul_f32 v42, v238, v42
    v_mul_f32 v43, v239, v43
    v_cvt_pk_bf16_f32 v40, v40, v41
    v_cvt_pk_bf16_f32 v41, v42, v43
    ds_write_b64 v225, v[40:41] offset:4352
    v_mul_f32 v44, v236, v44
    v_mul_f32 v45, v237, v45
    v_mul_f32 v46, v238, v46
    v_mul_f32 v47, v239, v47
    v_cvt_pk_bf16_f32 v44, v44, v45
    v_cvt_pk_bf16_f32 v45, v46, v47
    ds_write_b64 v225, v[44:45] offset:4480
    v_mul_f32 v48, v236, v48
    v_mul_f32 v49, v237, v49
    v_mul_f32 v50, v238, v50
    v_mul_f32 v51, v239, v51
    v_cvt_pk_bf16_f32 v48, v48, v49
    v_cvt_pk_bf16_f32 v49, v50, v51
    ds_write_b64 v224, v[48:49] offset:4608
    v_mul_f32 v52, v236, v52
    v_mul_f32 v53, v237, v53
    v_mul_f32 v54, v238, v54
    v_mul_f32 v55, v239, v55
    v_cvt_pk_bf16_f32 v52, v52, v53
    v_cvt_pk_bf16_f32 v53, v54, v55
    ds_write_b64 v224, v[52:53] offset:4736
    v_mul_f32 v56, v236, v56
    v_mul_f32 v57, v237, v57
    v_mul_f32 v58, v238, v58
    v_mul_f32 v59, v239, v59
    v_cvt_pk_bf16_f32 v56, v56, v57
    v_cvt_pk_bf16_f32 v57, v58, v59
    ds_write_b64 v225, v[56:57] offset:4864
    v_mul_f32 v60, v236, v60
    v_mul_f32 v61, v237, v61
    v_mul_f32 v62, v238, v62
    v_mul_f32 v63, v239, v63
    v_cvt_pk_bf16_f32 v60, v60, v61
    v_cvt_pk_bf16_f32 v61, v62, v63
    ds_write_b64 v225, v[60:61] offset:4992
    ds_read_b64_tr_b16 v[0:1], v226 offset:4096
    ds_read_b64_tr_b16 v[2:3], v227 offset:4096
    ds_read_b64_tr_b16 v[4:5], v226 offset:6144
    ds_read_b64_tr_b16 v[6:7], v227 offset:6144
    ds_read_b64_tr_b16 v[8:9], v226 offset:4608
    ds_read_b64_tr_b16 v[10:11], v227 offset:4608
    ds_read_b64_tr_b16 v[12:13], v226 offset:6656
    ds_read_b64_tr_b16 v[14:15], v227 offset:6656
    s_waitcnt lgkmcnt(0)
    buffer_store_dwordx4 v[0:3], v228, s[28:31], s51 offen offset:0 sc1 nt
    buffer_store_dwordx4 v[4:7], v228, s[28:31], s51 offen offset:2048 sc1 nt
    buffer_store_dwordx4 v[8:11], v228, s[28:31], s51 offen offset:128 sc1 nt
    buffer_store_dwordx4 v[12:15], v228, s[28:31], s51 offen offset:2176 sc1 nt
    s_waitcnt lgkmcnt(0)
    v_rcp_f32 v216, v216
    v_rcp_f32 v217, v217
    v_rcp_f32 v218, v218
    v_rcp_f32 v219, v219
    v_mul_f32 v64, v216, v64
    v_mul_f32 v65, v217, v65
    v_mul_f32 v66, v218, v66
    v_mul_f32 v67, v219, v67
    v_cvt_pk_bf16_f32 v64, v64, v65
    v_cvt_pk_bf16_f32 v65, v66, v67
    ds_write_b64 v224, v[64:65] offset:0
    v_mul_f32 v68, v216, v68
    v_mul_f32 v69, v217, v69
    v_mul_f32 v70, v218, v70
    v_mul_f32 v71, v219, v71
    v_cvt_pk_bf16_f32 v68, v68, v69
    v_cvt_pk_bf16_f32 v69, v70, v71
    ds_write_b64 v224, v[68:69] offset:128
    v_mul_f32 v72, v216, v72
    v_mul_f32 v73, v217, v73
    v_mul_f32 v74, v218, v74
    v_mul_f32 v75, v219, v75
    v_cvt_pk_bf16_f32 v72, v72, v73
    v_cvt_pk_bf16_f32 v73, v74, v75
    ds_write_b64 v225, v[72:73] offset:256
    v_mul_f32 v76, v216, v76
    v_mul_f32 v77, v217, v77
    v_mul_f32 v78, v218, v78
    v_mul_f32 v79, v219, v79
    v_cvt_pk_bf16_f32 v76, v76, v77
    v_cvt_pk_bf16_f32 v77, v78, v79
    ds_write_b64 v225, v[76:77] offset:384
    v_mul_f32 v80, v216, v80
    v_mul_f32 v81, v217, v81
    v_mul_f32 v82, v218, v82
    v_mul_f32 v83, v219, v83
    v_cvt_pk_bf16_f32 v80, v80, v81
    v_cvt_pk_bf16_f32 v81, v82, v83
    ds_write_b64 v224, v[80:81] offset:512
    v_mul_f32 v84, v216, v84
    v_mul_f32 v85, v217, v85
    v_mul_f32 v86, v218, v86
    v_mul_f32 v87, v219, v87
    v_cvt_pk_bf16_f32 v84, v84, v85
    v_cvt_pk_bf16_f32 v85, v86, v87
    ds_write_b64 v224, v[84:85] offset:640
    v_mul_f32 v88, v216, v88
    v_mul_f32 v89, v217, v89
    v_mul_f32 v90, v218, v90
    v_mul_f32 v91, v219, v91
    v_cvt_pk_bf16_f32 v88, v88, v89
    v_cvt_pk_bf16_f32 v89, v90, v91
    ds_write_b64 v225, v[88:89] offset:768
    v_mul_f32 v92, v216, v92
    v_mul_f32 v93, v217, v93
    v_mul_f32 v94, v218, v94
    v_mul_f32 v95, v219, v95
    v_cvt_pk_bf16_f32 v92, v92, v93
    v_cvt_pk_bf16_f32 v93, v94, v95
    ds_write_b64 v225, v[92:93] offset:896
    ds_read_b64_tr_b16 v[32:33], v226 offset:0
    ds_read_b64_tr_b16 v[34:35], v227 offset:0
    ds_read_b64_tr_b16 v[36:37], v226 offset:2048
    ds_read_b64_tr_b16 v[38:39], v227 offset:2048
    ds_read_b64_tr_b16 v[40:41], v226 offset:512
    ds_read_b64_tr_b16 v[42:43], v227 offset:512
    ds_read_b64_tr_b16 v[44:45], v226 offset:2560
    ds_read_b64_tr_b16 v[46:47], v227 offset:2560
    s_waitcnt lgkmcnt(0)
    buffer_store_dwordx4 v[32:35], v228, s[28:31], s52 offen offset:0 sc1 nt
    buffer_store_dwordx4 v[36:39], v228, s[28:31], s52 offen offset:2048 sc1 nt
    buffer_store_dwordx4 v[40:43], v228, s[28:31], s52 offen offset:128 sc1 nt
    buffer_store_dwordx4 v[44:47], v228, s[28:31], s52 offen offset:2176 sc1 nt
    s_waitcnt lgkmcnt(0)
    v_rcp_f32 v220, v220
    v_rcp_f32 v221, v221
    v_rcp_f32 v222, v222
    v_rcp_f32 v223, v223
    v_mul_f32 v96, v220, v96
    v_mul_f32 v97, v221, v97
    v_mul_f32 v98, v222, v98
    v_mul_f32 v99, v223, v99
    v_cvt_pk_bf16_f32 v96, v96, v97
    v_cvt_pk_bf16_f32 v97, v98, v99
    ds_write_b64 v224, v[96:97] offset:4096
    v_mul_f32 v100, v220, v100
    v_mul_f32 v101, v221, v101
    v_mul_f32 v102, v222, v102
    v_mul_f32 v103, v223, v103
    v_cvt_pk_bf16_f32 v100, v100, v101
    v_cvt_pk_bf16_f32 v101, v102, v103
    ds_write_b64 v224, v[100:101] offset:4224
    v_mul_f32 v104, v220, v104
    v_mul_f32 v105, v221, v105
    v_mul_f32 v106, v222, v106
    v_mul_f32 v107, v223, v107
    v_cvt_pk_bf16_f32 v104, v104, v105
    v_cvt_pk_bf16_f32 v105, v106, v107
    ds_write_b64 v225, v[104:105] offset:4352
    v_mul_f32 v108, v220, v108
    v_mul_f32 v109, v221, v109
    v_mul_f32 v110, v222, v110
    v_mul_f32 v111, v223, v111
    v_cvt_pk_bf16_f32 v108, v108, v109
    v_cvt_pk_bf16_f32 v109, v110, v111
    ds_write_b64 v225, v[108:109] offset:4480
    v_mul_f32 v112, v220, v112
    v_mul_f32 v113, v221, v113
    v_mul_f32 v114, v222, v114
    v_mul_f32 v115, v223, v115
    v_cvt_pk_bf16_f32 v112, v112, v113
    v_cvt_pk_bf16_f32 v113, v114, v115
    ds_write_b64 v224, v[112:113] offset:4608
    v_mul_f32 v116, v220, v116
    v_mul_f32 v117, v221, v117
    v_mul_f32 v118, v222, v118
    v_mul_f32 v119, v223, v119
    v_cvt_pk_bf16_f32 v116, v116, v117
    v_cvt_pk_bf16_f32 v117, v118, v119
    ds_write_b64 v224, v[116:117] offset:4736
    v_mul_f32 v120, v220, v120
    v_mul_f32 v121, v221, v121
    v_mul_f32 v122, v222, v122
    v_mul_f32 v123, v223, v123
    v_cvt_pk_bf16_f32 v120, v120, v121
    v_cvt_pk_bf16_f32 v121, v122, v123
    ds_write_b64 v225, v[120:121] offset:4864
    v_mul_f32 v124, v220, v124
    v_mul_f32 v125, v221, v125
    v_mul_f32 v126, v222, v126
    v_mul_f32 v127, v223, v127
    v_cvt_pk_bf16_f32 v124, v124, v125
    v_cvt_pk_bf16_f32 v125, v126, v127
    ds_write_b64 v225, v[124:125] offset:4992
    ds_read_b64_tr_b16 v[64:65], v226 offset:4096
    ds_read_b64_tr_b16 v[66:67], v227 offset:4096
    ds_read_b64_tr_b16 v[68:69], v226 offset:6144
    ds_read_b64_tr_b16 v[70:71], v227 offset:6144
    ds_read_b64_tr_b16 v[72:73], v226 offset:4608
    ds_read_b64_tr_b16 v[74:75], v227 offset:4608
    ds_read_b64_tr_b16 v[76:77], v226 offset:6656
    ds_read_b64_tr_b16 v[78:79], v227 offset:6656
    s_waitcnt lgkmcnt(0)
    buffer_store_dwordx4 v[64:67], v228, s[28:31], s53 offen offset:0 sc1 nt
    buffer_store_dwordx4 v[68:71], v228, s[28:31], s53 offen offset:2048 sc1 nt
    buffer_store_dwordx4 v[72:75], v228, s[28:31], s53 offen offset:128 sc1 nt
    buffer_store_dwordx4 v[76:79], v228, s[28:31], s53 offen offset:2176 sc1 nt
    s_endpgm
.section .rodata,"a"
.p2align 6
.amdhsa_kernel standalone__paged_block_table_kv_pagedattention__prompt_kernel
  .amdhsa_next_free_vgpr 492
  .amdhsa_next_free_sgpr 102
  .amdhsa_accum_offset 256
  .amdhsa_group_segment_fixed_size 0
  .amdhsa_kernarg_size 64
  .amdhsa_user_sgpr_count 2
  .amdhsa_user_sgpr_kernarg_segment_ptr 1
  .amdhsa_system_sgpr_workgroup_id_x 1
  .amdhsa_float_denorm_mode_32 3
.end_amdhsa_kernel
```
